```python
import torch

def _softmax(x, axis=-1):
    return torch.softmax(x, dim=axis)
def _gelu(x):
    return torch.nn.functional.gelu(x, approximate="tanh")
def _silu(x):
    return torch.nn.functional.silu(x)
def _sigmoid(x):
    return torch.sigmoid(x)
def _layernorm(x, axis=-1, eps=1e-5):
    m = x.mean(dim=axis, keepdim=True)
    v = x.var(dim=axis, keepdim=True, unbiased=False)
    return (x - m) / torch.sqrt(v + eps)
def _scatter_add(tgt, idx, src, axis=0):
    return tgt.clone().index_add_(axis, idx, src)
def _segment_sum(src, seg, n):
    out = torch.zeros((n,) + src.shape[1:], dtype=src.dtype)
    return out.index_add_(0, seg, src)
def _pad(x, pw):
    flat = tuple(v for pair in reversed(pw) for v in pair)
    return torch.nn.functional.pad(x, flat)

kernel_name = 'gated_mix__sliding_block_cached__gqa_block_cached__decode'

def setup_inputs():

    _w = (lambda a: (lambda t: t.to(torch.bfloat16) if t.is_floating_point() else t)(torch.as_tensor(a)))
    def _A_setup():
        B, Sq, D = 2, 1, 1024
        Hq, Hkv, Sk, Dh = 32, 4, 32768, 128
        assert Hq % Hkv == 0, (Hq, Hkv)
        return {
            "x": _w((lambda *s: torch.randn(*s, dtype=torch.bfloat16) * 0.05)(B, Sq, D)),
            "k_cache": _w((lambda *s: torch.randn(*s, dtype=torch.bfloat16) * 6.4)(B, Hkv, Sk, Dh)),
            "v_cache": _w((lambda *s: torch.randn(*s, dtype=torch.bfloat16) * 0.05)(B, Hkv, Sk, Dh)),
            "wq": _w((lambda *s: torch.randn(*s, dtype=torch.bfloat16) * 6.4)(D, Hq * Dh) * (D ** -0.5)),
            "wo": _w((lambda *s: torch.randn(*s, dtype=torch.bfloat16) * 0.05)(Hq * Dh, D) * ((Hq * Dh) ** -0.5)),
        }
    _A_in = _A_setup()

    def _B_setup():
        B, Sq, D = 2, 1, 1024
        Hq, Hkv, Sk, Dh = 32, 4, 32768, 128
        assert Hq % Hkv == 0, (Hq, Hkv)
        return {
            "x": _w((lambda *s: torch.randn(*s, dtype=torch.bfloat16) * 0.05)(B, Sq, D)),
            "k_cache": _w((lambda *s: torch.randn(*s, dtype=torch.bfloat16) * 6.4)(B, Hkv, Sk, Dh)),
            "v_cache": _w((lambda *s: torch.randn(*s, dtype=torch.bfloat16) * 0.05)(B, Hkv, Sk, Dh)),
            "wq": _w((lambda *s: torch.randn(*s, dtype=torch.bfloat16) * 6.4)(D, Hq * Dh) * (D ** -0.5)),
            "wo": _w((lambda *s: torch.randn(*s, dtype=torch.bfloat16) * 0.05)(Hq * Dh, D) * ((Hq * Dh) ** -0.5)),
        }
    _B_in = _B_setup()

    return {
        "A_x": _A_in["x"],
        "A_k_cache": _A_in["k_cache"],
        "A_v_cache": _A_in["v_cache"],
        "A_wq": _A_in["wq"],
        "A_wo": _A_in["wo"],
        "B_x": _B_in["x"],
        "B_k_cache": _B_in["k_cache"],
        "B_v_cache": _B_in["v_cache"],
        "B_wq": _B_in["wq"],
        "B_wo": _B_in["wo"],
        "gate_w": _w((lambda *s: torch.randn(*s, dtype=torch.bfloat16) * 0.05)(1024) * 16.0),
    }

def reference(A_x, A_k_cache, A_v_cache, A_wq, A_wo, B_x, B_k_cache, B_v_cache, B_wq, B_wo, gate_w):
    def _A_ref(x, k_cache, v_cache, wq, wo):
        B, Sq, D = x.shape
        Hq, Dh = 32, 128
        Hkv, Sk = k_cache.shape[1], k_cache.shape[2]
        W = min(4096, max(256, Sk // 4))
        rep = Hq // Hkv
        q = (lambda x, *d: x.permute(*d))((x @ wq).reshape(B, Sq, Hq, Dh), 0, 2, 1, 3)
        k = (lambda x, n, axis: torch.repeat_interleave(x, n, dim=axis))(k_cache[:, :, Sk - W:, :], rep, axis=1)
        v = (lambda x, n, axis: torch.repeat_interleave(x, n, dim=axis))(v_cache[:, :, Sk - W:, :], rep, axis=1)
        scores = torch.einsum("bhqd,bhkd->bhqk", q, k) * (Dh ** -0.5)
        p = _softmax(scores, axis=-1)
        o = torch.einsum("bhqk,bhkd->bhqd", p, v)
        return (lambda x, *d: x.permute(*d))(o, 0, 2, 1, 3).reshape(B, Sq, Hq * Dh) @ wo

    def _B_ref(x, k_cache, v_cache, wq, wo):
        B, Sq, D = x.shape
        Hq, Dh = 32, 128
        Hkv = k_cache.shape[1]
        rep = Hq // Hkv
        q = (lambda x, *d: x.permute(*d))((x @ wq).reshape(B, Sq, Hq, Dh), 0, 2, 1, 3)
        k = (lambda x, n, axis: torch.repeat_interleave(x, n, dim=axis))(k_cache, rep, axis=1)
        v = (lambda x, n, axis: torch.repeat_interleave(x, n, dim=axis))(v_cache, rep, axis=1)
        scores = torch.einsum("bhqd,bhkd->bhqk", q, k) * (Dh ** -0.5)
        p = _softmax(scores, axis=-1)
        o = torch.einsum("bhqk,bhkd->bhqd", p, v)
        return (lambda x, *d: x.permute(*d))(o, 0, 2, 1, 3).reshape(B, Sq, Hq * Dh) @ wo

    x = A_x
    g = _sigmoid((x * gate_w).sum(-1, keepdims=True))
    a = _A_ref(x, A_k_cache, A_v_cache, A_wq, A_wo)
    b = _B_ref(x, B_k_cache, B_v_cache, B_wq, B_wo)
    return g * a + (1 - g) * b
```

```asm
; @launch grid=(256,1,1) block=(512,1,1) lds=74240
.amdgcn_target "amdgcn-amd-amdhsa--gfx950"
.text
.globl gated_mix__sliding_block_cached__gqa_block_cached__decode_kernel
.p2align 8
.type gated_mix__sliding_block_cached__gqa_block_cached__decode_kernel,@function
gated_mix__sliding_block_cached__gqa_block_cached__decode_kernel:
    s_cmp_ge_u32 s2, 256
    s_cbranch_scc1 L_end
    s_load_dwordx16 s[48:63], s[0:1], 0
    s_load_dwordx8 s[64:71], s[0:1], 64
    s_load_dwordx4 s[72:75], s[0:1], 96
    s_memrealtime s[96:97]
    v_lshrrev_b32 v1, 6, v0
    v_and_b32 v0, 63, v0
    v_readfirstlane_b32 s3, v1
    v_mov_b32 v10, 1792
    v_mov_b32 v28, 0
    v_mov_b32 v29, 0
    v_mov_b32 v30, 0
    v_mov_b32 v31, 0
    s_cmp_lg_u32 s3, 0
    s_cbranch_scc1 L_noinit
    ds_write_b128 v10, v[28:31]
    ds_write_b128 v10, v[28:31] offset:16
L_noinit:
    v_and_b32 v24, 15, v0
    v_lshrrev_b32 v25, 4, v0
    v_and_b32 v26, 3, v24
    v_lshlrev_b32 v26, 10, v26
    v_lshrrev_b32 v27, 2, v24
    v_lshl_add_u32 v26, v27, 8, v26
    v_lshl_add_u32 v1, v25, 4, v26
    v_add_u32 v2, 4096, v1
    v_lshlrev_b32 v3, 4, v0
    v_add_u32 v4, 4096, v3
    s_lshr_b32 s80, s2, 5
    s_and_b32 s81, s2, 15
    s_and_b32 s82, s2, 31
    s_lshl_b32 s90, s80, 4
    s_add_u32 s90, s90, s81
    s_lshl_b32 s85, s80, 23
    s_lshl_b32 s83, s82, 3
    s_add_u32 s83, s83, s3
    s_lshl_b32 s83, s83, 13
    s_add_u32 s83, s83, s85
    s_bitcmp1_b32 s2, 4
    s_cbranch_scc1 L_roleO
    v_and_b32 v26, 1, v24
    v_lshlrev_b32 v12, 11, v26
    v_lshl_add_u32 v12, v25, 5, v12
    v_bfe_u32 v26, v24, 2, 1
    v_lshl_add_u32 v12, v26, 4, v12
    v_lshrrev_b32 v26, 3, v0
    v_lshlrev_b32 v13, 16, v26
    v_and_b32 v26, 7, v0
    v_lshl_add_u32 v13, v26, 4, v13
    s_and_b32 s95, s90, 63
    s_lshl_b32 s91, s95, 7
    s_lshl_b32 s86, s3, 20
    s_add_u32 s91, s91, s86
    s_lshl_b32 s86, s3, 8
    s_waitcnt lgkmcnt(0)
    s_cmp_ge_u32 s2, 128
    s_cselect_b32 s20, s64, s54
    s_cselect_b32 s21, s65, s55
    s_mov_b32 s22, 0x800000
    s_mov_b32 s23, 0x20000
    s_mov_b32 s32, s48
    s_mov_b32 s33, s49
    s_mov_b32 s34, 0x1000
    s_mov_b32 s35, 0x20000
    s_mov_b32 s44, s72
    s_mov_b32 s45, s73
    s_mov_b32 s46, 0x100
    s_mov_b32 s47, 0x20000
    buffer_load_dwordx4 v[64:67], v12, s[32:35], s86 offen
    buffer_load_dwordx4 v[68:71], v12, s[32:35], s86 offen offset:128
    s_add_u32 s85, s91, 0
    buffer_load_dwordx4 v[96:99], v13, s[20:23], s85 offen nt
    s_add_u32 s85, s91, 8192
    buffer_load_dwordx4 v[100:103], v13, s[20:23], s85 offen nt
    s_add_u32 s85, s91, 16384
    buffer_load_dwordx4 v[104:107], v13, s[20:23], s85 offen nt
    s_add_u32 s85, s91, 24576
    buffer_load_dwordx4 v[108:111], v13, s[20:23], s85 offen nt
    s_add_u32 s85, s91, 32768
    buffer_load_dwordx4 v[112:115], v13, s[20:23], s85 offen nt
    s_add_u32 s85, s91, 40960
    buffer_load_dwordx4 v[116:119], v13, s[20:23], s85 offen nt
    s_add_u32 s85, s91, 49152
    buffer_load_dwordx4 v[120:123], v13, s[20:23], s85 offen nt
    s_add_u32 s85, s91, 57344
    buffer_load_dwordx4 v[124:127], v13, s[20:23], s85 offen nt
    s_add_u32 s85, s91, 524288
    buffer_load_dwordx4 v[128:131], v13, s[20:23], s85 offen nt
    s_add_u32 s85, s91, 532480
    buffer_load_dwordx4 v[132:135], v13, s[20:23], s85 offen nt
    s_add_u32 s85, s91, 540672
    buffer_load_dwordx4 v[136:139], v13, s[20:23], s85 offen nt
    s_add_u32 s85, s91, 548864
    buffer_load_dwordx4 v[140:143], v13, s[20:23], s85 offen nt
    s_add_u32 s85, s91, 557056
    buffer_load_dwordx4 v[144:147], v13, s[20:23], s85 offen nt
    s_add_u32 s85, s91, 565248
    buffer_load_dwordx4 v[148:151], v13, s[20:23], s85 offen nt
    s_add_u32 s85, s91, 573440
    buffer_load_dwordx4 v[152:155], v13, s[20:23], s85 offen nt
    s_add_u32 s85, s91, 581632
    buffer_load_dwordx4 v[156:159], v13, s[20:23], s85 offen nt
    buffer_load_dword v95, off, s[44:47], 0 sc1
    s_mov_b32 s4, s60
    s_mov_b32 s5, s61
    s_mov_b32 s6, 0x4000000
    s_mov_b32 s7, 0x20000
    s_mov_b32 s8, s62
    s_mov_b32 s9, s63
    s_mov_b32 s10, 0x4000000
    s_mov_b32 s11, 0x20000
    s_mov_b32 s28, s74
    s_mov_b32 s29, s75
    s_mov_b32 s30, 0x1000000
    s_mov_b32 s31, 0x20000
    s_mov_b32 s40, s70
    s_mov_b32 s41, s71
    s_mov_b32 s42, 0x1000
    s_mov_b32 s43, 0x20000
    s_mov_b32 s12, s50
    s_mov_b32 s13, s51
    s_mov_b32 s14, 0x4000000
    s_mov_b32 s15, 0x20000
    s_mov_b32 s16, s52
    s_mov_b32 s17, s53
    s_mov_b32 s18, 0x4000000
    s_mov_b32 s19, 0x20000
    s_mov_b32 s24, s66
    s_mov_b32 s25, s67
    s_mov_b32 s26, 0x800000
    s_mov_b32 s27, 0x20000
    s_cmp_ge_u32 s3, 4
    s_cselect_b32 s36, s56, s68
    s_cselect_b32 s37, s57, s69
    s_movk_i32 s38, 2048
    s_cselect_b32 s38, 0x800000, s38
    s_mov_b32 s39, 0x20000
    s_lshl_b32 s84, s81, 4
    s_add_u32 s84, s84, s3
    s_add_u32 s84, s84, 12
    s_lshl_b32 s84, s84, 12
    s_lshl_b32 s85, s80, 23
    s_add_u32 s84, s84, s85
    s_add_u32 s84, s84, 0x700000
    s_mov_b32 s76, 0x05040100
    s_mov_b32 s77, 0x07060302
    s_mov_b32 s78, 0x3e0293ee
    s_mul_i32 s85, s3, 4224
    s_add_u32 s85, s85, 6656
    v_mul_u32_u24 v5, 528, v24
    v_lshl_add_u32 v5, v25, 7, v5
    v_add_u32 v5, s85, v5
    s_lshl_b32 s85, s3, 2
    v_lshlrev_b32 v6, 5, v24
    v_add_u32 v6, s85, v6
    v_and_b32 v26, 7, v24
    v_lshlrev_b32 v94, 5, v26
    v_mul_u32_u24 v7, 272, v26
    v_lshl_add_u32 v7, v25, 4, v7
    v_add_u32 v7, 2048, v7
    s_mul_i32 s85, s3, 528
    s_add_u32 s85, s85, 6656
    v_and_b32 v26, 31, v0
    v_lshlrev_b32 v8, 4, v26
    v_add_u32 v8, s85, v8
    s_lshl_b32 s85, s3, 5
    v_mov_b32 v9, s85
    v_lshrrev_b32 v26, 5, v0
    v_mul_u32_u24 v11, 272, v26
    v_and_b32 v26, 31, v0
    v_lshl_add_u32 v11, v26, 3, v11
    v_add_u32 v11, 2048, v11
    s_lshl_b32 s92, s80, 3
    s_add_u32 s92, s92, s3
    s_lshl_b32 s92, s92, 14
    s_add_u32 s92, s92, 0x100000
    s_lshl_b32 s86, s81, 7
    s_add_u32 s93, s92, s86
    s_add_u32 s94, s93, 65536
    s_lshl_b32 s86, s82, 7
    s_add_u32 s92, s92, s86
    s_add_u32 s92, s92, 0x100000
    s_barrier
    s_waitcnt vmcnt(9)
    v_perm_b32 v16, v100, v96, s76
    v_perm_b32 v17, v108, v104, s76
    v_perm_b32 v18, v116, v112, s76
    v_perm_b32 v19, v124, v120, s76
    v_perm_b32 v20, v100, v96, s77
    v_perm_b32 v21, v108, v104, s77
    v_perm_b32 v22, v116, v112, s77
    v_perm_b32 v23, v124, v120, s77
    v_mfma_f32_16x16x32_bf16 v[32:35], v[64:67], v[16:19], 0
    v_perm_b32 v16, v101, v97, s76
    v_perm_b32 v17, v109, v105, s76
    v_perm_b32 v18, v117, v113, s76
    v_perm_b32 v19, v125, v121, s76
    v_mfma_f32_16x16x32_bf16 v[36:39], v[64:67], v[20:23], 0
    v_perm_b32 v20, v101, v97, s77
    v_perm_b32 v21, v109, v105, s77
    v_perm_b32 v22, v117, v113, s77
    v_perm_b32 v23, v125, v121, s77
    v_mfma_f32_16x16x32_bf16 v[40:43], v[64:67], v[16:19], 0
    v_perm_b32 v16, v102, v98, s76
    v_perm_b32 v17, v110, v106, s76
    v_perm_b32 v18, v118, v114, s76
    v_perm_b32 v19, v126, v122, s76
    v_mfma_f32_16x16x32_bf16 v[44:47], v[64:67], v[20:23], 0
    v_perm_b32 v20, v102, v98, s77
    v_perm_b32 v21, v110, v106, s77
    v_perm_b32 v22, v118, v114, s77
    v_perm_b32 v23, v126, v122, s77
    v_mfma_f32_16x16x32_bf16 v[48:51], v[64:67], v[16:19], 0
    v_perm_b32 v16, v103, v99, s76
    v_perm_b32 v17, v111, v107, s76
    v_perm_b32 v18, v119, v115, s76
    v_perm_b32 v19, v127, v123, s76
    v_mfma_f32_16x16x32_bf16 v[52:55], v[64:67], v[20:23], 0
    v_perm_b32 v20, v103, v99, s77
    v_perm_b32 v21, v111, v107, s77
    v_perm_b32 v22, v119, v115, s77
    v_perm_b32 v23, v127, v123, s77
    v_mfma_f32_16x16x32_bf16 v[56:59], v[64:67], v[16:19], 0
    s_nop 0
    v_mfma_f32_16x16x32_bf16 v[60:63], v[64:67], v[20:23], 0
    v_bfe_u32 v26, v0, 3, 1
    v_lshlrev_b32 v27, 9, v26
    v_and_b32 v26, 7, v0
    v_lshl_add_u32 v27, v26, 6, v27
    s_lshl_b32 s85, s3, 10
    s_add_u32 s85, s85, 6656
    v_add_u32 v27, s85, v27
    v_mov_b32 v28, 1
    s_waitcnt vmcnt(1)
    v_perm_b32 v16, v132, v128, s76
    v_perm_b32 v17, v140, v136, s76
    v_perm_b32 v18, v148, v144, s76
    v_perm_b32 v19, v156, v152, s76
    v_perm_b32 v20, v132, v128, s77
    v_perm_b32 v21, v140, v136, s77
    v_perm_b32 v22, v148, v144, s77
    v_perm_b32 v23, v156, v152, s77
    v_mfma_f32_16x16x32_bf16 v[32:35], v[68:71], v[16:19], v[32:35]
    v_perm_b32 v16, v133, v129, s76
    v_perm_b32 v17, v141, v137, s76
    v_perm_b32 v18, v149, v145, s76
    v_perm_b32 v19, v157, v153, s76
    v_mfma_f32_16x16x32_bf16 v[36:39], v[68:71], v[20:23], v[36:39]
    v_perm_b32 v20, v133, v129, s77
    v_perm_b32 v21, v141, v137, s77
    v_perm_b32 v22, v149, v145, s77
    v_perm_b32 v23, v157, v153, s77
    v_mfma_f32_16x16x32_bf16 v[40:43], v[68:71], v[16:19], v[40:43]
    v_perm_b32 v16, v134, v130, s76
    v_perm_b32 v17, v142, v138, s76
    v_perm_b32 v18, v150, v146, s76
    v_perm_b32 v19, v158, v154, s76
    v_mfma_f32_16x16x32_bf16 v[44:47], v[68:71], v[20:23], v[44:47]
    v_perm_b32 v20, v134, v130, s77
    v_perm_b32 v21, v142, v138, s77
    v_perm_b32 v22, v150, v146, s77
    v_perm_b32 v23, v158, v154, s77
    v_mfma_f32_16x16x32_bf16 v[48:51], v[68:71], v[16:19], v[48:51]
    v_perm_b32 v16, v135, v131, s76
    v_perm_b32 v17, v143, v139, s76
    v_perm_b32 v18, v151, v147, s76
    v_perm_b32 v19, v159, v155, s76
    v_mfma_f32_16x16x32_bf16 v[52:55], v[68:71], v[20:23], v[52:55]
    v_perm_b32 v20, v135, v131, s77
    v_perm_b32 v21, v143, v139, s77
    v_perm_b32 v22, v151, v147, s77
    v_perm_b32 v23, v159, v155, s77
    v_mfma_f32_16x16x32_bf16 v[56:59], v[68:71], v[16:19], v[56:59]
    s_nop 0
    v_mfma_f32_16x16x32_bf16 v[60:63], v[68:71], v[20:23], v[60:63]
    s_mov_b32 exec_lo, 0xff0000ff
    s_mov_b32 exec_hi, 0
    s_nop 1
    ds_write_b64 v27, v[32:33] offset:0
    ds_write_b64 v27, v[36:37] offset:8
    ds_write_b64 v27, v[40:41] offset:16
    ds_write_b64 v27, v[44:45] offset:24
    ds_write_b64 v27, v[48:49] offset:32
    ds_write_b64 v27, v[52:53] offset:40
    ds_write_b64 v27, v[56:57] offset:48
    ds_write_b64 v27, v[60:61] offset:56
    s_mov_b64 exec, 1
    ds_add_u32 v10, v28 offset:0
    s_mov_b64 exec, -1
    s_cmp_ge_u32 s3, 4
    s_cbranch_scc1 L_q_y
    s_and_b32 s86, s3, 1
    s_lshl_b32 s86, s86, 11
    v_lshlrev_b32 v12, 5, v0
    buffer_load_dwordx4 v[64:67], v12, s[32:35], s86 offen
    buffer_load_dwordx4 v[68:71], v12, s[32:35], s86 offen offset:16
    buffer_load_dwordx4 v[72:75], v12, s[36:39], 0 offen
    buffer_load_dwordx4 v[76:79], v12, s[36:39], 0 offen offset:16
    s_add_u32 s85, s83, 0x0
    buffer_load_dwordx4 v[160:163], v1, s[4:7], s85 offen offset:0 nt
    buffer_load_dwordx4 v[164:167], v1, s[4:7], s85 offen offset:64 nt
    buffer_load_dwordx4 v[168:171], v1, s[4:7], s85 offen offset:128 nt
    buffer_load_dwordx4 v[172:175], v1, s[4:7], s85 offen offset:192 nt
    buffer_load_dwordx4 v[176:179], v2, s[4:7], s85 offen offset:0 nt
    buffer_load_dwordx4 v[180:183], v2, s[4:7], s85 offen offset:64 nt
    buffer_load_dwordx4 v[184:187], v2, s[4:7], s85 offen offset:128 nt
    buffer_load_dwordx4 v[188:191], v2, s[4:7], s85 offen offset:192 nt
    s_add_u32 s85, s83, 0x0
    buffer_load_dwordx4 v[192:195], v3, s[8:11], s85 offen offset:0 nt
    buffer_load_dwordx4 v[196:199], v3, s[8:11], s85 offen offset:1024 nt
    buffer_load_dwordx4 v[200:203], v3, s[8:11], s85 offen offset:2048 nt
    buffer_load_dwordx4 v[204:207], v3, s[8:11], s85 offen offset:3072 nt
    buffer_load_dwordx4 v[208:211], v4, s[8:11], s85 offen offset:0 nt
    buffer_load_dwordx4 v[212:215], v4, s[8:11], s85 offen offset:1024 nt
    buffer_load_dwordx4 v[216:219], v4, s[8:11], s85 offen offset:2048 nt
    buffer_load_dwordx4 v[220:223], v4, s[8:11], s85 offen offset:3072 nt
    s_add_u32 s85, s83, 0x200000
    buffer_load_dwordx4 v[224:227], v1, s[4:7], s85 offen offset:0 nt
    buffer_load_dwordx4 v[228:231], v1, s[4:7], s85 offen offset:64 nt
    buffer_load_dwordx4 v[232:235], v1, s[4:7], s85 offen offset:128 nt
    buffer_load_dwordx4 v[236:239], v1, s[4:7], s85 offen offset:192 nt
    buffer_load_dwordx4 v[240:243], v2, s[4:7], s85 offen offset:0 nt
    buffer_load_dwordx4 v[244:247], v2, s[4:7], s85 offen offset:64 nt
    buffer_load_dwordx4 v[248:251], v2, s[4:7], s85 offen offset:128 nt
    buffer_load_dwordx4 v[252:255], v2, s[4:7], s85 offen offset:192 nt
    s_add_u32 s85, s83, 0x200000
    buffer_load_dwordx4 v[96:99], v3, s[8:11], s85 offen offset:0 nt
    buffer_load_dwordx4 v[100:103], v3, s[8:11], s85 offen offset:1024 nt
    buffer_load_dwordx4 v[104:107], v3, s[8:11], s85 offen offset:2048 nt
    buffer_load_dwordx4 v[108:111], v3, s[8:11], s85 offen offset:3072 nt
    buffer_load_dwordx4 v[112:115], v4, s[8:11], s85 offen offset:0 nt
    buffer_load_dwordx4 v[116:119], v4, s[8:11], s85 offen offset:1024 nt
    buffer_load_dwordx4 v[120:123], v4, s[8:11], s85 offen offset:2048 nt
    buffer_load_dwordx4 v[124:127], v4, s[8:11], s85 offen offset:3072 nt
    s_add_u32 s85, s83, 0x400000
    buffer_load_dwordx4 v[128:131], v1, s[4:7], s85 offen offset:0 nt
    buffer_load_dwordx4 v[132:135], v1, s[4:7], s85 offen offset:64 nt
    buffer_load_dwordx4 v[136:139], v1, s[4:7], s85 offen offset:128 nt
    buffer_load_dwordx4 v[140:143], v1, s[4:7], s85 offen offset:192 nt
    buffer_load_dwordx4 v[144:147], v2, s[4:7], s85 offen offset:0 nt
    buffer_load_dwordx4 v[148:151], v2, s[4:7], s85 offen offset:64 nt
    buffer_load_dwordx4 v[152:155], v2, s[4:7], s85 offen offset:128 nt
    buffer_load_dwordx4 v[156:159], v2, s[4:7], s85 offen offset:192 nt
    s_waitcnt vmcnt(40)
    v_mov_b32 v24, 0
    s_mov_b32 s85, 0xffff0000
    v_lshlrev_b32 v25, 16, v64
    v_lshlrev_b32 v26, 16, v72
    v_and_b32 v27, s85, v64
    v_and_b32 v28, s85, v72
    v_mul_f32 v25, v25, v26
    v_mul_f32 v27, v27, v28
    v_cvt_pk_bf16_f32 v25, v25, v27
    v_lshlrev_b32 v26, 16, v25
    v_and_b32 v27, s85, v25
    v_add_f32 v24, v24, v26
    v_add_f32 v24, v24, v27
    v_lshlrev_b32 v25, 16, v65
    v_lshlrev_b32 v26, 16, v73
    v_and_b32 v27, s85, v65
    v_and_b32 v28, s85, v73
    v_mul_f32 v25, v25, v26
    v_mul_f32 v27, v27, v28
    v_cvt_pk_bf16_f32 v25, v25, v27
    v_lshlrev_b32 v26, 16, v25
    v_and_b32 v27, s85, v25
    v_add_f32 v24, v24, v26
    v_add_f32 v24, v24, v27
    v_lshlrev_b32 v25, 16, v66
    v_lshlrev_b32 v26, 16, v74
    v_and_b32 v27, s85, v66
    v_and_b32 v28, s85, v74
    v_mul_f32 v25, v25, v26
    v_mul_f32 v27, v27, v28
    v_cvt_pk_bf16_f32 v25, v25, v27
    v_lshlrev_b32 v26, 16, v25
    v_and_b32 v27, s85, v25
    v_add_f32 v24, v24, v26
    v_add_f32 v24, v24, v27
    v_lshlrev_b32 v25, 16, v67
    v_lshlrev_b32 v26, 16, v75
    v_and_b32 v27, s85, v67
    v_and_b32 v28, s85, v75
    v_mul_f32 v25, v25, v26
    v_mul_f32 v27, v27, v28
    v_cvt_pk_bf16_f32 v25, v25, v27
    v_lshlrev_b32 v26, 16, v25
    v_and_b32 v27, s85, v25
    v_add_f32 v24, v24, v26
    v_add_f32 v24, v24, v27
    v_lshlrev_b32 v25, 16, v68
    v_lshlrev_b32 v26, 16, v76
    v_and_b32 v27, s85, v68
    v_and_b32 v28, s85, v76
    v_mul_f32 v25, v25, v26
    v_mul_f32 v27, v27, v28
    v_cvt_pk_bf16_f32 v25, v25, v27
    v_lshlrev_b32 v26, 16, v25
    v_and_b32 v27, s85, v25
    v_add_f32 v24, v24, v26
    v_add_f32 v24, v24, v27
    v_lshlrev_b32 v25, 16, v69
    v_lshlrev_b32 v26, 16, v77
    v_and_b32 v27, s85, v69
    v_and_b32 v28, s85, v77
    v_mul_f32 v25, v25, v26
    v_mul_f32 v27, v27, v28
    v_cvt_pk_bf16_f32 v25, v25, v27
    v_lshlrev_b32 v26, 16, v25
    v_and_b32 v27, s85, v25
    v_add_f32 v24, v24, v26
    v_add_f32 v24, v24, v27
    v_lshlrev_b32 v25, 16, v70
    v_lshlrev_b32 v26, 16, v78
    v_and_b32 v27, s85, v70
    v_and_b32 v28, s85, v78
    v_mul_f32 v25, v25, v26
    v_mul_f32 v27, v27, v28
    v_cvt_pk_bf16_f32 v25, v25, v27
    v_lshlrev_b32 v26, 16, v25
    v_and_b32 v27, s85, v25
    v_add_f32 v24, v24, v26
    v_add_f32 v24, v24, v27
    v_lshlrev_b32 v25, 16, v71
    v_lshlrev_b32 v26, 16, v79
    v_and_b32 v27, s85, v71
    v_and_b32 v28, s85, v79
    v_mul_f32 v25, v25, v26
    v_mul_f32 v27, v27, v28
    v_cvt_pk_bf16_f32 v25, v25, v27
    v_lshlrev_b32 v26, 16, v25
    v_and_b32 v27, s85, v25
    v_add_f32 v24, v24, v26
    v_add_f32 v24, v24, v27
    s_nop 1
    v_add_f32_dpp v24, v24, v24 row_ror:1 row_mask:0xf bank_mask:0xf
    s_nop 1
    v_add_f32_dpp v24, v24, v24 row_ror:2 row_mask:0xf bank_mask:0xf
    s_nop 1
    v_add_f32_dpp v24, v24, v24 row_ror:4 row_mask:0xf bank_mask:0xf
    s_nop 1
    v_add_f32_dpp v24, v24, v24 row_ror:8 row_mask:0xf bank_mask:0xf
    v_mov_b32 v25, v24
    s_nop 1
    v_permlane16_swap_b32 v24, v25
    v_add_f32 v24, v24, v25
    v_mov_b32 v25, v24
    s_nop 1
    v_permlane32_swap_b32 v24, v25
    v_add_f32 v24, v24, v25
    v_cvt_pk_bf16_f32 v24, v24, v24
    v_lshlrev_b32 v24, 16, v24
    v_mul_f32 v24, 0xbfb8aa3b, v24
    v_exp_f32 v24, v24
    s_nop 0
    v_add_f32 v24, 1.0, v24
    v_rcp_f32 v24, v24
    s_nop 0
    v_cvt_pk_bf16_f32 v24, v24, v24
    v_lshlrev_b32 v14, 16, v24
    v_sub_f32 v24, 1.0, v14
    v_cvt_pk_bf16_f32 v24, v24, v24
    v_lshlrev_b32 v15, 16, v24
    s_mov_b32 s89, 0
L_ls1:
    ds_read_b32 v31, v10 offset:4
    s_waitcnt lgkmcnt(0)
    v_readfirstlane_b32 s88, v31
    s_add_u32 s89, s89, 1
    s_cmp_eq_u32 s88, 4
    s_cbranch_scc1 L_lsok2
    s_cmp_gt_u32 s89, 1000000
    s_cbranch_scc1 L_lsok2
    s_sleep 1
    s_branch L_ls1
L_lsok2:
    ds_read_b32 v31, v10 offset:8
    s_waitcnt lgkmcnt(0)
    v_readfirstlane_b32 s79, v31
    ds_read_b128 v[64:67], v7 offset:2176
    ds_read_b128 v[68:71], v7 offset:2240
    ds_read_b128 v[72:75], v7 offset:2304
    ds_read_b128 v[76:79], v7 offset:2368
    v_lshrrev_b32 v24, 3, v0
    v_lshlrev_b32 v12, 12, v24
    v_and_b32 v24, 7, v0
    v_lshl_add_u32 v12, v24, 4, v12
    s_waitcnt lgkmcnt(0)
    s_waitcnt vmcnt(32)
    v_mfma_f32_16x16x32_bf16 v[80:83], v[160:163], v[64:67], 0
    v_mfma_f32_16x16x32_bf16 v[84:87], v[176:179], v[64:67], 0
    v_mfma_f32_16x16x32_bf16 v[80:83], v[164:167], v[68:71], v[80:83]
    v_mfma_f32_16x16x32_bf16 v[84:87], v[180:183], v[68:71], v[84:87]
    v_mfma_f32_16x16x32_bf16 v[80:83], v[168:171], v[72:75], v[80:83]
    v_mfma_f32_16x16x32_bf16 v[84:87], v[184:187], v[72:75], v[84:87]
    v_mfma_f32_16x16x32_bf16 v[80:83], v[172:175], v[76:79], v[80:83]
    v_mfma_f32_16x16x32_bf16 v[84:87], v[188:191], v[76:79], v[84:87]
    s_add_u32 s85, s83, 0x400000
    buffer_load_dwordx4 v[160:163], v3, s[8:11], s85 offen offset:0 nt
    buffer_load_dwordx4 v[164:167], v3, s[8:11], s85 offen offset:1024 nt
    buffer_load_dwordx4 v[168:171], v3, s[8:11], s85 offen offset:2048 nt
    buffer_load_dwordx4 v[172:175], v3, s[8:11], s85 offen offset:3072 nt
    buffer_load_dwordx4 v[176:179], v4, s[8:11], s85 offen offset:0 nt
    buffer_load_dwordx4 v[180:183], v4, s[8:11], s85 offen offset:1024 nt
    buffer_load_dwordx4 v[184:187], v4, s[8:11], s85 offen offset:2048 nt
    buffer_load_dwordx4 v[188:191], v4, s[8:11], s85 offen offset:3072 nt
    v_max3_f32 v24, v80, v81, v82
    v_max3_f32 v24, v24, v83, v84
    v_max3_f32 v24, v24, v85, v86
    v_max_f32 v24, v24, v87
    v_mov_b32 v25, v24
    s_nop 1
    v_permlane16_swap_b32 v24, v25
    v_max_f32 v24, v24, v25
    v_mov_b32 v25, v24
    s_nop 1
    v_permlane32_swap_b32 v24, v25
    v_max_f32 v24, v24, v25
    v_mul_f32 v26, s78, v24
    v_mov_b32 v92, v24
    v_fma_f32 v80, v80, s78, -v26
    v_fma_f32 v81, v81, s78, -v26
    v_fma_f32 v82, v82, s78, -v26
    v_fma_f32 v83, v83, s78, -v26
    v_fma_f32 v84, v84, s78, -v26
    v_fma_f32 v85, v85, s78, -v26
    v_fma_f32 v86, v86, s78, -v26
    v_fma_f32 v87, v87, s78, -v26
    v_exp_f32 v80, v80
    v_exp_f32 v81, v81
    v_exp_f32 v82, v82
    v_exp_f32 v83, v83
    v_exp_f32 v84, v84
    v_exp_f32 v85, v85
    v_exp_f32 v86, v86
    v_exp_f32 v87, v87
    s_nop 0
    v_add_f32 v24, v80, v81
    v_add_f32 v25, v82, v83
    v_add_f32 v24, v24, v84
    v_add_f32 v25, v25, v85
    v_add_f32 v24, v24, v86
    v_add_f32 v25, v25, v87
    v_cvt_pk_bf16_f32 v88, v80, v81
    v_cvt_pk_bf16_f32 v89, v82, v83
    v_cvt_pk_bf16_f32 v90, v84, v85
    v_cvt_pk_bf16_f32 v91, v86, v87
    v_add_f32 v24, v24, v25
    v_mov_b32 v93, v24
    s_waitcnt vmcnt(32)
    v_perm_b32 v16, v196, v192, s76
    v_perm_b32 v17, v204, v200, s76
    v_perm_b32 v18, v212, v208, s76
    v_perm_b32 v19, v220, v216, s76
    v_perm_b32 v20, v196, v192, s77
    v_perm_b32 v21, v204, v200, s77
    v_perm_b32 v22, v212, v208, s77
    v_perm_b32 v23, v220, v216, s77
    v_mfma_f32_16x16x32_bf16 v[32:35], v[16:19], v[88:91], 0
    v_perm_b32 v16, v197, v193, s76
    v_perm_b32 v17, v205, v201, s76
    v_perm_b32 v18, v213, v209, s76
    v_perm_b32 v19, v221, v217, s76
    v_mfma_f32_16x16x32_bf16 v[36:39], v[20:23], v[88:91], 0
    v_perm_b32 v20, v197, v193, s77
    v_perm_b32 v21, v205, v201, s77
    v_perm_b32 v22, v213, v209, s77
    v_perm_b32 v23, v221, v217, s77
    v_mfma_f32_16x16x32_bf16 v[40:43], v[16:19], v[88:91], 0
    v_perm_b32 v16, v198, v194, s76
    v_perm_b32 v17, v206, v202, s76
    v_perm_b32 v18, v214, v210, s76
    v_perm_b32 v19, v222, v218, s76
    v_mfma_f32_16x16x32_bf16 v[44:47], v[20:23], v[88:91], 0
    v_perm_b32 v20, v198, v194, s77
    v_perm_b32 v21, v206, v202, s77
    v_perm_b32 v22, v214, v210, s77
    v_perm_b32 v23, v222, v218, s77
    v_mfma_f32_16x16x32_bf16 v[48:51], v[16:19], v[88:91], 0
    v_perm_b32 v16, v199, v195, s76
    v_perm_b32 v17, v207, v203, s76
    v_perm_b32 v18, v215, v211, s76
    v_perm_b32 v19, v223, v219, s76
    v_mfma_f32_16x16x32_bf16 v[52:55], v[20:23], v[88:91], 0
    v_perm_b32 v20, v199, v195, s77
    v_perm_b32 v21, v207, v203, s77
    v_perm_b32 v22, v215, v211, s77
    v_perm_b32 v23, v223, v219, s77
    v_mfma_f32_16x16x32_bf16 v[56:59], v[16:19], v[88:91], 0
    s_nop 0
    v_mfma_f32_16x16x32_bf16 v[60:63], v[20:23], v[88:91], 0
    s_add_u32 s85, s83, 0x600000
    buffer_load_dwordx4 v[192:195], v1, s[4:7], s85 offen offset:0 nt
    buffer_load_dwordx4 v[196:199], v1, s[4:7], s85 offen offset:64 nt
    buffer_load_dwordx4 v[200:203], v1, s[4:7], s85 offen offset:128 nt
    buffer_load_dwordx4 v[204:207], v1, s[4:7], s85 offen offset:192 nt
    buffer_load_dwordx4 v[208:211], v2, s[4:7], s85 offen offset:0 nt
    buffer_load_dwordx4 v[212:215], v2, s[4:7], s85 offen offset:64 nt
    buffer_load_dwordx4 v[216:219], v2, s[4:7], s85 offen offset:128 nt
    buffer_load_dwordx4 v[220:223], v2, s[4:7], s85 offen offset:192 nt
    s_waitcnt vmcnt(32)
    v_mfma_f32_16x16x32_bf16 v[80:83], v[224:227], v[64:67], 0
    v_mfma_f32_16x16x32_bf16 v[84:87], v[240:243], v[64:67], 0
    v_mfma_f32_16x16x32_bf16 v[80:83], v[228:231], v[68:71], v[80:83]
    v_mfma_f32_16x16x32_bf16 v[84:87], v[244:247], v[68:71], v[84:87]
    v_mfma_f32_16x16x32_bf16 v[80:83], v[232:235], v[72:75], v[80:83]
    v_mfma_f32_16x16x32_bf16 v[84:87], v[248:251], v[72:75], v[84:87]
    v_mfma_f32_16x16x32_bf16 v[80:83], v[236:239], v[76:79], v[80:83]
    v_mfma_f32_16x16x32_bf16 v[84:87], v[252:255], v[76:79], v[84:87]
    s_add_u32 s85, s83, 0x600000
    buffer_load_dwordx4 v[224:227], v3, s[8:11], s85 offen offset:0 nt
    buffer_load_dwordx4 v[228:231], v3, s[8:11], s85 offen offset:1024 nt
    buffer_load_dwordx4 v[232:235], v3, s[8:11], s85 offen offset:2048 nt
    buffer_load_dwordx4 v[236:239], v3, s[8:11], s85 offen offset:3072 nt
    buffer_load_dwordx4 v[240:243], v4, s[8:11], s85 offen offset:0 nt
    buffer_load_dwordx4 v[244:247], v4, s[8:11], s85 offen offset:1024 nt
    buffer_load_dwordx4 v[248:251], v4, s[8:11], s85 offen offset:2048 nt
    buffer_load_dwordx4 v[252:255], v4, s[8:11], s85 offen offset:3072 nt
    v_max3_f32 v24, v80, v81, v82
    v_max3_f32 v24, v24, v83, v84
    v_max3_f32 v24, v24, v85, v86
    v_max3_f32 v24, v24, v87, v92
    v_mov_b32 v25, v24
    s_nop 1
    v_permlane16_swap_b32 v24, v25
    v_max_f32 v24, v24, v25
    v_mov_b32 v25, v24
    s_nop 1
    v_permlane32_swap_b32 v24, v25
    v_max_f32 v24, v24, v25
    v_mul_f32 v26, s78, v24
    v_fma_f32 v28, v92, s78, -v26
    v_exp_f32 v28, v28
    v_mov_b32 v92, v24
    v_fma_f32 v80, v80, s78, -v26
    v_fma_f32 v81, v81, s78, -v26
    v_fma_f32 v82, v82, s78, -v26
    v_fma_f32 v83, v83, s78, -v26
    v_fma_f32 v84, v84, s78, -v26
    v_fma_f32 v85, v85, s78, -v26
    v_fma_f32 v86, v86, s78, -v26
    v_fma_f32 v87, v87, s78, -v26
    v_exp_f32 v80, v80
    v_exp_f32 v81, v81
    v_exp_f32 v82, v82
    v_exp_f32 v83, v83
    v_exp_f32 v84, v84
    v_exp_f32 v85, v85
    v_exp_f32 v86, v86
    v_exp_f32 v87, v87
    v_pk_mul_f32 v[32:33], v[32:33], v[28:29] op_sel_hi:[1,0]
    v_pk_mul_f32 v[34:35], v[34:35], v[28:29] op_sel_hi:[1,0]
    v_pk_mul_f32 v[36:37], v[36:37], v[28:29] op_sel_hi:[1,0]
    v_pk_mul_f32 v[38:39], v[38:39], v[28:29] op_sel_hi:[1,0]
    v_pk_mul_f32 v[40:41], v[40:41], v[28:29] op_sel_hi:[1,0]
    v_pk_mul_f32 v[42:43], v[42:43], v[28:29] op_sel_hi:[1,0]
    v_pk_mul_f32 v[44:45], v[44:45], v[28:29] op_sel_hi:[1,0]
    v_pk_mul_f32 v[46:47], v[46:47], v[28:29] op_sel_hi:[1,0]
    v_pk_mul_f32 v[48:49], v[48:49], v[28:29] op_sel_hi:[1,0]
    v_pk_mul_f32 v[50:51], v[50:51], v[28:29] op_sel_hi:[1,0]
    v_pk_mul_f32 v[52:53], v[52:53], v[28:29] op_sel_hi:[1,0]
    v_pk_mul_f32 v[54:55], v[54:55], v[28:29] op_sel_hi:[1,0]
    v_pk_mul_f32 v[56:57], v[56:57], v[28:29] op_sel_hi:[1,0]
    v_pk_mul_f32 v[58:59], v[58:59], v[28:29] op_sel_hi:[1,0]
    v_pk_mul_f32 v[60:61], v[60:61], v[28:29] op_sel_hi:[1,0]
    v_pk_mul_f32 v[62:63], v[62:63], v[28:29] op_sel_hi:[1,0]
    v_add_f32 v24, v80, v81
    v_add_f32 v25, v82, v83
    v_add_f32 v24, v24, v84
    v_add_f32 v25, v25, v85
    v_add_f32 v24, v24, v86
    v_add_f32 v25, v25, v87
    v_cvt_pk_bf16_f32 v88, v80, v81
    v_cvt_pk_bf16_f32 v89, v82, v83
    v_cvt_pk_bf16_f32 v90, v84, v85
    v_cvt_pk_bf16_f32 v91, v86, v87
    v_add_f32 v24, v24, v25
    v_fma_f32 v93, v93, v28, v24
    s_waitcnt vmcnt(32)
    v_perm_b32 v16, v100, v96, s76
    v_perm_b32 v17, v108, v104, s76
    v_perm_b32 v18, v116, v112, s76
    v_perm_b32 v19, v124, v120, s76
    v_perm_b32 v20, v100, v96, s77
    v_perm_b32 v21, v108, v104, s77
    v_perm_b32 v22, v116, v112, s77
    v_perm_b32 v23, v124, v120, s77
    v_mfma_f32_16x16x32_bf16 v[32:35], v[16:19], v[88:91], v[32:35]
    v_perm_b32 v16, v101, v97, s76
    v_perm_b32 v17, v109, v105, s76
    v_perm_b32 v18, v117, v113, s76
    v_perm_b32 v19, v125, v121, s76
    v_mfma_f32_16x16x32_bf16 v[36:39], v[20:23], v[88:91], v[36:39]
    v_perm_b32 v20, v101, v97, s77
    v_perm_b32 v21, v109, v105, s77
    v_perm_b32 v22, v117, v113, s77
    v_perm_b32 v23, v125, v121, s77
    v_mfma_f32_16x16x32_bf16 v[40:43], v[16:19], v[88:91], v[40:43]
    v_perm_b32 v16, v102, v98, s76
    v_perm_b32 v17, v110, v106, s76
    v_perm_b32 v18, v118, v114, s76
    v_perm_b32 v19, v126, v122, s76
    v_mfma_f32_16x16x32_bf16 v[44:47], v[20:23], v[88:91], v[44:47]
    v_perm_b32 v20, v102, v98, s77
    v_perm_b32 v21, v110, v106, s77
    v_perm_b32 v22, v118, v114, s77
    v_perm_b32 v23, v126, v122, s77
    v_mfma_f32_16x16x32_bf16 v[48:51], v[16:19], v[88:91], v[48:51]
    v_perm_b32 v16, v103, v99, s76
    v_perm_b32 v17, v111, v107, s76
    v_perm_b32 v18, v119, v115, s76
    v_perm_b32 v19, v127, v123, s76
    v_mfma_f32_16x16x32_bf16 v[52:55], v[20:23], v[88:91], v[52:55]
    v_perm_b32 v20, v103, v99, s77
    v_perm_b32 v21, v111, v107, s77
    v_perm_b32 v22, v119, v115, s77
    v_perm_b32 v23, v127, v123, s77
    v_mfma_f32_16x16x32_bf16 v[56:59], v[16:19], v[88:91], v[56:59]
    s_nop 0
    v_mfma_f32_16x16x32_bf16 v[60:63], v[20:23], v[88:91], v[60:63]
    s_waitcnt vmcnt(24)
    v_mfma_f32_16x16x32_bf16 v[80:83], v[128:131], v[64:67], 0
    v_mfma_f32_16x16x32_bf16 v[84:87], v[144:147], v[64:67], 0
    v_mfma_f32_16x16x32_bf16 v[80:83], v[132:135], v[68:71], v[80:83]
    v_mfma_f32_16x16x32_bf16 v[84:87], v[148:151], v[68:71], v[84:87]
    v_mfma_f32_16x16x32_bf16 v[80:83], v[136:139], v[72:75], v[80:83]
    v_mfma_f32_16x16x32_bf16 v[84:87], v[152:155], v[72:75], v[84:87]
    v_mfma_f32_16x16x32_bf16 v[80:83], v[140:143], v[76:79], v[80:83]
    v_mfma_f32_16x16x32_bf16 v[84:87], v[156:159], v[76:79], v[84:87]
    s_nop 7
    v_max3_f32 v24, v80, v81, v82
    v_max3_f32 v24, v24, v83, v84
    v_max3_f32 v24, v24, v85, v86
    v_max3_f32 v24, v24, v87, v92
    v_mov_b32 v25, v24
    s_nop 1
    v_permlane16_swap_b32 v24, v25
    v_max_f32 v24, v24, v25
    v_mov_b32 v25, v24
    s_nop 1
    v_permlane32_swap_b32 v24, v25
    v_max_f32 v24, v24, v25
    v_mul_f32 v26, s78, v24
    v_fma_f32 v28, v92, s78, -v26
    v_exp_f32 v28, v28
    v_mov_b32 v92, v24
    v_fma_f32 v80, v80, s78, -v26
    v_fma_f32 v81, v81, s78, -v26
    v_fma_f32 v82, v82, s78, -v26
    v_fma_f32 v83, v83, s78, -v26
    v_fma_f32 v84, v84, s78, -v26
    v_fma_f32 v85, v85, s78, -v26
    v_fma_f32 v86, v86, s78, -v26
    v_fma_f32 v87, v87, s78, -v26
    v_exp_f32 v80, v80
    v_exp_f32 v81, v81
    v_exp_f32 v82, v82
    v_exp_f32 v83, v83
    v_exp_f32 v84, v84
    v_exp_f32 v85, v85
    v_exp_f32 v86, v86
    v_exp_f32 v87, v87
    v_pk_mul_f32 v[32:33], v[32:33], v[28:29] op_sel_hi:[1,0]
    v_pk_mul_f32 v[34:35], v[34:35], v[28:29] op_sel_hi:[1,0]
    v_pk_mul_f32 v[36:37], v[36:37], v[28:29] op_sel_hi:[1,0]
    v_pk_mul_f32 v[38:39], v[38:39], v[28:29] op_sel_hi:[1,0]
    v_pk_mul_f32 v[40:41], v[40:41], v[28:29] op_sel_hi:[1,0]
    v_pk_mul_f32 v[42:43], v[42:43], v[28:29] op_sel_hi:[1,0]
    v_pk_mul_f32 v[44:45], v[44:45], v[28:29] op_sel_hi:[1,0]
    v_pk_mul_f32 v[46:47], v[46:47], v[28:29] op_sel_hi:[1,0]
    v_pk_mul_f32 v[48:49], v[48:49], v[28:29] op_sel_hi:[1,0]
    v_pk_mul_f32 v[50:51], v[50:51], v[28:29] op_sel_hi:[1,0]
    v_pk_mul_f32 v[52:53], v[52:53], v[28:29] op_sel_hi:[1,0]
    v_pk_mul_f32 v[54:55], v[54:55], v[28:29] op_sel_hi:[1,0]
    v_pk_mul_f32 v[56:57], v[56:57], v[28:29] op_sel_hi:[1,0]
    v_pk_mul_f32 v[58:59], v[58:59], v[28:29] op_sel_hi:[1,0]
    v_pk_mul_f32 v[60:61], v[60:61], v[28:29] op_sel_hi:[1,0]
    v_pk_mul_f32 v[62:63], v[62:63], v[28:29] op_sel_hi:[1,0]
    v_add_f32 v24, v80, v81
    v_add_f32 v25, v82, v83
    v_add_f32 v24, v24, v84
    v_add_f32 v25, v25, v85
    v_add_f32 v24, v24, v86
    v_add_f32 v25, v25, v87
    v_cvt_pk_bf16_f32 v88, v80, v81
    v_cvt_pk_bf16_f32 v89, v82, v83
    v_cvt_pk_bf16_f32 v90, v84, v85
    v_cvt_pk_bf16_f32 v91, v86, v87
    v_add_f32 v24, v24, v25
    v_fma_f32 v93, v93, v28, v24
    s_waitcnt vmcnt(16)
    v_perm_b32 v16, v164, v160, s76
    v_perm_b32 v17, v172, v168, s76
    v_perm_b32 v18, v180, v176, s76
    v_perm_b32 v19, v188, v184, s76
    v_perm_b32 v20, v164, v160, s77
    v_perm_b32 v21, v172, v168, s77
    v_perm_b32 v22, v180, v176, s77
    v_perm_b32 v23, v188, v184, s77
    v_mfma_f32_16x16x32_bf16 v[32:35], v[16:19], v[88:91], v[32:35]
    v_perm_b32 v16, v165, v161, s76
    v_perm_b32 v17, v173, v169, s76
    v_perm_b32 v18, v181, v177, s76
    v_perm_b32 v19, v189, v185, s76
    v_mfma_f32_16x16x32_bf16 v[36:39], v[20:23], v[88:91], v[36:39]
    v_perm_b32 v20, v165, v161, s77
    v_perm_b32 v21, v173, v169, s77
    v_perm_b32 v22, v181, v177, s77
    v_perm_b32 v23, v189, v185, s77
    v_mfma_f32_16x16x32_bf16 v[40:43], v[16:19], v[88:91], v[40:43]
    v_perm_b32 v16, v166, v162, s76
    v_perm_b32 v17, v174, v170, s76
    v_perm_b32 v18, v182, v178, s76
    v_perm_b32 v19, v190, v186, s76
    v_mfma_f32_16x16x32_bf16 v[44:47], v[20:23], v[88:91], v[44:47]
    v_perm_b32 v20, v166, v162, s77
    v_perm_b32 v21, v174, v170, s77
    v_perm_b32 v22, v182, v178, s77
    v_perm_b32 v23, v190, v186, s77
    v_mfma_f32_16x16x32_bf16 v[48:51], v[16:19], v[88:91], v[48:51]
    v_perm_b32 v16, v167, v163, s76
    v_perm_b32 v17, v175, v171, s76
    v_perm_b32 v18, v183, v179, s76
    v_perm_b32 v19, v191, v187, s76
    v_mfma_f32_16x16x32_bf16 v[52:55], v[20:23], v[88:91], v[52:55]
    v_perm_b32 v20, v167, v163, s77
    v_perm_b32 v21, v175, v171, s77
    v_perm_b32 v22, v183, v179, s77
    v_perm_b32 v23, v191, v187, s77
    v_mfma_f32_16x16x32_bf16 v[56:59], v[16:19], v[88:91], v[56:59]
    s_nop 0
    v_mfma_f32_16x16x32_bf16 v[60:63], v[20:23], v[88:91], v[60:63]
    s_and_b32 s85, s3, 1
    s_lshl_b32 s85, s85, 2
    s_lshr_b32 s86, s90, 5
    s_add_u32 s85, s85, s86
    s_lshl_b32 s72, s85, 17
    s_and_b32 s86, s90, 31
    s_lshl_b32 s86, s86, 12
    s_add_u32 s72, s72, s86
    s_add_u32 s72, s72, 0x100000
    s_and_b32 s85, s3, 1
    s_lshl_b32 s85, s85, 6
    v_and_b32 v26, 7, v0
    v_lshlrev_b32 v1, 3, v26
    v_lshrrev_b32 v26, 4, v0
    v_lshl_add_u32 v1, v26, 1, v1
    v_add_u32 v1, s85, v1
    s_lshr_b32 s74, s90, 1
    s_lshl_b32 s74, s74, 14
    s_lshl_b32 s87, s3, 12
    s_add_u32 s74, s74, s87
    s_and_b32 s87, s90, 1
    s_lshl_b32 s87, s87, 6
    s_add_u32 s74, s74, s87
    s_add_u32 s74, s74, 0x600000
    v_lshrrev_b32 v26, 2, v0
    v_lshlrev_b32 v11, 7, v26
    v_and_b32 v26, 3, v0
    v_lshl_add_u32 v11, v26, 4, v11
    v_lshlrev_b32 v2, 4, v26
    v_lshrrev_b32 v27, 4, v0
    v_lshl_add_u32 v2, v27, 2, v2
    s_lshl_b32 s85, s3, 6
    s_add_u32 s85, s85, 1280
    v_add_u32 v2, s85, v2
    v_and_b32 v26, 7, v0
    v_lshlrev_b32 v4, 3, v26
    v_lshrrev_b32 v27, 1, v26
    v_lshlrev_b32 v13, 4, v27
    v_and_b32 v27, 1, v0
    v_lshl_add_u32 v13, v27, 2, v13
    s_lshr_b32 s75, s90, 3
    s_lshl_b32 s75, s75, 8
    s_and_b32 s87, s90, 3
    s_lshl_b32 s87, s87, 6
    s_add_u32 s75, s75, s87
    s_bfe_u32 s87, s90, 0x10002
    s_lshl_b32 s87, s87, 3
    s_add_u32 s75, s75, s87
    s_waitcnt vmcnt(8)
    v_mfma_f32_16x16x32_bf16 v[80:83], v[192:195], v[64:67], 0
    v_mfma_f32_16x16x32_bf16 v[84:87], v[208:211], v[64:67], 0
    v_mfma_f32_16x16x32_bf16 v[80:83], v[196:199], v[68:71], v[80:83]
    v_mfma_f32_16x16x32_bf16 v[84:87], v[212:215], v[68:71], v[84:87]
    v_mfma_f32_16x16x32_bf16 v[80:83], v[200:203], v[72:75], v[80:83]
    v_mfma_f32_16x16x32_bf16 v[84:87], v[216:219], v[72:75], v[84:87]
    v_mfma_f32_16x16x32_bf16 v[80:83], v[204:207], v[76:79], v[80:83]
    v_mfma_f32_16x16x32_bf16 v[84:87], v[220:223], v[76:79], v[84:87]
    s_nop 7
    v_max3_f32 v24, v80, v81, v82
    v_max3_f32 v24, v24, v83, v84
    v_max3_f32 v24, v24, v85, v86
    v_max3_f32 v24, v24, v87, v92
    v_mov_b32 v25, v24
    s_nop 1
    v_permlane16_swap_b32 v24, v25
    v_max_f32 v24, v24, v25
    v_mov_b32 v25, v24
    s_nop 1
    v_permlane32_swap_b32 v24, v25
    v_max_f32 v24, v24, v25
    v_mul_f32 v26, s78, v24
    v_fma_f32 v28, v92, s78, -v26
    v_exp_f32 v28, v28
    v_mov_b32 v92, v24
    v_fma_f32 v80, v80, s78, -v26
    v_fma_f32 v81, v81, s78, -v26
    v_fma_f32 v82, v82, s78, -v26
    v_fma_f32 v83, v83, s78, -v26
    v_fma_f32 v84, v84, s78, -v26
    v_fma_f32 v85, v85, s78, -v26
    v_fma_f32 v86, v86, s78, -v26
    v_fma_f32 v87, v87, s78, -v26
    v_exp_f32 v80, v80
    v_exp_f32 v81, v81
    v_exp_f32 v82, v82
    v_exp_f32 v83, v83
    v_exp_f32 v84, v84
    v_exp_f32 v85, v85
    v_exp_f32 v86, v86
    v_exp_f32 v87, v87
    v_pk_mul_f32 v[32:33], v[32:33], v[28:29] op_sel_hi:[1,0]
    v_pk_mul_f32 v[34:35], v[34:35], v[28:29] op_sel_hi:[1,0]
    v_pk_mul_f32 v[36:37], v[36:37], v[28:29] op_sel_hi:[1,0]
    v_pk_mul_f32 v[38:39], v[38:39], v[28:29] op_sel_hi:[1,0]
    v_pk_mul_f32 v[40:41], v[40:41], v[28:29] op_sel_hi:[1,0]
    v_pk_mul_f32 v[42:43], v[42:43], v[28:29] op_sel_hi:[1,0]
    v_pk_mul_f32 v[44:45], v[44:45], v[28:29] op_sel_hi:[1,0]
    v_pk_mul_f32 v[46:47], v[46:47], v[28:29] op_sel_hi:[1,0]
    v_pk_mul_f32 v[48:49], v[48:49], v[28:29] op_sel_hi:[1,0]
    v_pk_mul_f32 v[50:51], v[50:51], v[28:29] op_sel_hi:[1,0]
    v_pk_mul_f32 v[52:53], v[52:53], v[28:29] op_sel_hi:[1,0]
    v_pk_mul_f32 v[54:55], v[54:55], v[28:29] op_sel_hi:[1,0]
    v_pk_mul_f32 v[56:57], v[56:57], v[28:29] op_sel_hi:[1,0]
    v_pk_mul_f32 v[58:59], v[58:59], v[28:29] op_sel_hi:[1,0]
    v_pk_mul_f32 v[60:61], v[60:61], v[28:29] op_sel_hi:[1,0]
    v_pk_mul_f32 v[62:63], v[62:63], v[28:29] op_sel_hi:[1,0]
    v_add_f32 v24, v80, v81
    v_add_f32 v25, v82, v83
    v_add_f32 v24, v24, v84
    v_add_f32 v25, v25, v85
    v_add_f32 v24, v24, v86
    v_add_f32 v25, v25, v87
    v_cvt_pk_bf16_f32 v88, v80, v81
    v_cvt_pk_bf16_f32 v89, v82, v83
    v_cvt_pk_bf16_f32 v90, v84, v85
    v_cvt_pk_bf16_f32 v91, v86, v87
    v_add_f32 v24, v24, v25
    v_fma_f32 v93, v93, v28, v24
    v_mov_b32 v25, v93
    s_nop 1
    v_permlane16_swap_b32 v93, v25
    v_add_f32 v93, v93, v25
    v_mov_b32 v25, v93
    s_nop 1
    v_permlane32_swap_b32 v93, v25
    v_add_f32 v93, v93, v25
    s_mov_b64 exec, 0xff
    ds_write_b32 v6, v92 offset:256
    ds_write_b32 v6, v93 offset:768
    s_mov_b64 exec, -1
    v_mov_b32 v115, s79
    s_waitcnt vmcnt(0)
    v_perm_b32 v16, v228, v224, s76
    v_perm_b32 v17, v236, v232, s76
    v_perm_b32 v18, v244, v240, s76
    v_perm_b32 v19, v252, v248, s76
    v_perm_b32 v20, v228, v224, s77
    v_perm_b32 v21, v236, v232, s77
    v_perm_b32 v22, v244, v240, s77
    v_perm_b32 v23, v252, v248, s77
    v_mfma_f32_16x16x32_bf16 v[32:35], v[16:19], v[88:91], v[32:35]
    v_perm_b32 v16, v229, v225, s76
    v_perm_b32 v17, v237, v233, s76
    v_perm_b32 v18, v245, v241, s76
    v_perm_b32 v19, v253, v249, s76
    v_mfma_f32_16x16x32_bf16 v[36:39], v[20:23], v[88:91], v[36:39]
    v_perm_b32 v20, v229, v225, s77
    v_perm_b32 v21, v237, v233, s77
    v_perm_b32 v22, v245, v241, s77
    v_perm_b32 v23, v253, v249, s77
    v_mfma_f32_16x16x32_bf16 v[40:43], v[16:19], v[88:91], v[40:43]
    v_perm_b32 v16, v230, v226, s76
    v_perm_b32 v17, v238, v234, s76
    v_perm_b32 v18, v246, v242, s76
    v_perm_b32 v19, v254, v250, s76
    v_mfma_f32_16x16x32_bf16 v[44:47], v[20:23], v[88:91], v[44:47]
    v_perm_b32 v20, v230, v226, s77
    v_perm_b32 v21, v238, v234, s77
    v_perm_b32 v22, v246, v242, s77
    v_perm_b32 v23, v254, v250, s77
    v_mfma_f32_16x16x32_bf16 v[48:51], v[16:19], v[88:91], v[48:51]
    v_perm_b32 v16, v231, v227, s76
    v_perm_b32 v17, v239, v235, s76
    v_perm_b32 v18, v247, v243, s76
    v_perm_b32 v19, v255, v251, s76
    v_mfma_f32_16x16x32_bf16 v[52:55], v[20:23], v[88:91], v[52:55]
    v_perm_b32 v20, v231, v227, s77
    v_perm_b32 v21, v239, v235, s77
    v_perm_b32 v22, v247, v243, s77
    v_perm_b32 v23, v255, v251, s77
    v_mfma_f32_16x16x32_bf16 v[56:59], v[16:19], v[88:91], v[56:59]
    s_nop 0
    v_mfma_f32_16x16x32_bf16 v[60:63], v[20:23], v[88:91], v[60:63]
    s_nop 3
    s_mov_b32 exec_lo, 0x00ff00ff
    s_mov_b32 exec_hi, 0x00ff00ff
    ds_write_b128 v5, v[32:35] offset:33792
    ds_write_b128 v5, v[36:39] offset:33808
    ds_write_b128 v5, v[40:43] offset:33824
    ds_write_b128 v5, v[44:47] offset:33840
    ds_write_b128 v5, v[48:51] offset:33856
    ds_write_b128 v5, v[52:55] offset:33872
    ds_write_b128 v5, v[56:59] offset:33888
    ds_write_b128 v5, v[60:63] offset:33904
    s_mov_b64 exec, -1
    v_mov_b32 v25, 1
    s_mov_b64 exec, 1
    ds_add_u32 v10, v25 offset:20
    s_mov_b64 exec, -1
    s_mov_b32 s89, 0
L_ls3:
    ds_read_b32 v31, v10 offset:20
    s_waitcnt lgkmcnt(0)
    v_readfirstlane_b32 s88, v31
    s_add_u32 s89, s89, 1
    s_cmp_eq_u32 s88, 4
    s_cbranch_scc1 L_lsok4
    s_cmp_gt_u32 s89, 1000000
    s_cbranch_scc1 L_lsok4
    s_sleep 1
    s_branch L_ls3
L_lsok4:
    ds_read_b128 v[80:83], v9 offset:256
    ds_read_b128 v[16:19], v9 offset:768
    ds_read_b128 v[128:131], v8 offset:33792
    ds_read_b128 v[132:135], v8 offset:38016
    ds_read_b128 v[136:139], v8 offset:42240
    ds_read_b128 v[140:143], v8 offset:46464
    s_waitcnt lgkmcnt(5)
    v_max3_f32 v144, v80, v81, v82
    v_max_f32 v144, v144, v83
    v_mul_f32 v26, s78, v144
    v_fma_f32 v80, v80, s78, -v26
    v_fma_f32 v81, v81, s78, -v26
    v_fma_f32 v82, v82, s78, -v26
    v_fma_f32 v83, v83, s78, -v26
    v_exp_f32 v80, v80
    v_exp_f32 v81, v81
    v_exp_f32 v82, v82
    v_exp_f32 v83, v83
    s_waitcnt lgkmcnt(0)
    v_mul_f32 v148, v80, v128
    v_mul_f32 v149, v80, v129
    v_mul_f32 v150, v80, v130
    v_mul_f32 v151, v80, v131
    v_mul_f32 v146, v80, v16
    v_fmac_f32 v148, v81, v132
    v_fmac_f32 v149, v81, v133
    v_fmac_f32 v150, v81, v134
    v_fmac_f32 v151, v81, v135
    v_fmac_f32 v146, v81, v17
    v_fmac_f32 v148, v82, v136
    v_fmac_f32 v149, v82, v137
    v_fmac_f32 v150, v82, v138
    v_fmac_f32 v151, v82, v139
    v_fmac_f32 v146, v82, v18
    v_fmac_f32 v148, v83, v140
    v_fmac_f32 v149, v83, v141
    v_fmac_f32 v150, v83, v142
    v_fmac_f32 v151, v83, v143
    v_fmac_f32 v146, v83, v19
    s_mov_b32 exec_hi, 0
    ds_write_b128 v8, v[148:151] offset:33792
    s_mov_b64 exec, 1
    ds_write_b32 v9, v144 offset:256
    ds_write_b32 v9, v146 offset:768
    s_mov_b64 exec, -1
    ds_read_b128 v[80:83], v9 offset:384
    ds_read_b128 v[16:19], v9 offset:896
    ds_read_b128 v[128:131], v8 offset:35904
    ds_read_b128 v[132:135], v8 offset:40128
    ds_read_b128 v[136:139], v8 offset:44352
    ds_read_b128 v[140:143], v8 offset:48576
    s_waitcnt lgkmcnt(5)
    v_max3_f32 v144, v80, v81, v82
    v_max_f32 v144, v144, v83
    v_mul_f32 v26, s78, v144
    v_fma_f32 v80, v80, s78, -v26
    v_fma_f32 v81, v81, s78, -v26
    v_fma_f32 v82, v82, s78, -v26
    v_fma_f32 v83, v83, s78, -v26
    v_exp_f32 v80, v80
    v_exp_f32 v81, v81
    v_exp_f32 v82, v82
    v_exp_f32 v83, v83
    s_waitcnt lgkmcnt(0)
    v_mul_f32 v148, v80, v128
    v_mul_f32 v149, v80, v129
    v_mul_f32 v150, v80, v130
    v_mul_f32 v151, v80, v131
    v_mul_f32 v146, v80, v16
    v_fmac_f32 v148, v81, v132
    v_fmac_f32 v149, v81, v133
    v_fmac_f32 v150, v81, v134
    v_fmac_f32 v151, v81, v135
    v_fmac_f32 v146, v81, v17
    v_fmac_f32 v148, v82, v136
    v_fmac_f32 v149, v82, v137
    v_fmac_f32 v150, v82, v138
    v_fmac_f32 v151, v82, v139
    v_fmac_f32 v146, v82, v18
    v_fmac_f32 v148, v83, v140
    v_fmac_f32 v149, v83, v141
    v_fmac_f32 v150, v83, v142
    v_fmac_f32 v151, v83, v143
    v_fmac_f32 v146, v83, v19
    s_mov_b32 exec_hi, 0
    ds_write_b128 v8, v[148:151] offset:35904
    s_mov_b64 exec, 1
    ds_write_b32 v9, v144 offset:384
    ds_write_b32 v9, v146 offset:896
    s_mov_b64 exec, -1
    v_and_b32 v112, 1, v0
    v_cmp_eq_u32 vcc, 1, v112
    s_waitcnt lgkmcnt(0)
    s_barrier
    ds_read_b32 v31, v10 offset:28
    ds_read_b32 v96, v9 offset:256
    ds_read_b128 v[100:103], v9 offset:272
    ds_read_b128 v[128:131], v8 offset:33792
    ds_read_b128 v[132:135], v8 offset:50688
    ds_read_b128 v[136:139], v8 offset:54912
    ds_read_b128 v[140:143], v8 offset:59136
    ds_read_b128 v[144:147], v8 offset:63360
    ds_read_b32 v104, v9 offset:768
    ds_read_b128 v[108:111], v9 offset:784
    s_waitcnt lgkmcnt(7)
    v_max3_f32 v114, v96, v100, v101
    v_max3_f32 v114, v114, v102, v103
    v_mul_f32 v26, s78, v114
    v_fma_f32 v96, v96, s78, -v26
    v_fma_f32 v100, v100, s78, -v26
    v_fma_f32 v101, v101, s78, -v26
    v_fma_f32 v102, v102, s78, -v26
    v_fma_f32 v103, v103, s78, -v26
    v_exp_f32 v96, v96
    v_exp_f32 v100, v100
    v_exp_f32 v101, v101
    v_exp_f32 v102, v102
    v_exp_f32 v103, v103
    s_waitcnt lgkmcnt(2)
    v_pk_mul_f32 v[116:117], v[128:129], v[96:97] op_sel:[0,0] op_sel_hi:[1,0]
    v_pk_mul_f32 v[118:119], v[130:131], v[96:97] op_sel:[0,0] op_sel_hi:[1,0]
    v_pk_fma_f32 v[116:117], v[132:133], v[100:101], v[116:117] op_sel:[0,0,0] op_sel_hi:[1,0,1]
    v_pk_fma_f32 v[118:119], v[134:135], v[100:101], v[118:119] op_sel:[0,0,0] op_sel_hi:[1,0,1]
    v_pk_fma_f32 v[116:117], v[136:137], v[100:101], v[116:117] op_sel:[0,1,0] op_sel_hi:[1,1,1]
    v_pk_fma_f32 v[118:119], v[138:139], v[100:101], v[118:119] op_sel:[0,1,0] op_sel_hi:[1,1,1]
    v_pk_fma_f32 v[116:117], v[140:141], v[102:103], v[116:117] op_sel:[0,0,0] op_sel_hi:[1,0,1]
    v_pk_fma_f32 v[118:119], v[142:143], v[102:103], v[118:119] op_sel:[0,0,0] op_sel_hi:[1,0,1]
    v_pk_fma_f32 v[116:117], v[144:145], v[102:103], v[116:117] op_sel:[0,1,0] op_sel_hi:[1,1,1]
    v_pk_fma_f32 v[118:119], v[146:147], v[102:103], v[118:119] op_sel:[0,1,0] op_sel_hi:[1,1,1]
    s_waitcnt lgkmcnt(0)
    v_mul_f32 v97, v96, v104
    v_fmac_f32 v97, v100, v108
    v_fmac_f32 v97, v101, v109
    v_fmac_f32 v97, v102, v110
    v_fmac_f32 v97, v103, v111
    v_cvt_pk_bf16_f32 v112, v116, v117
    v_cvt_pk_bf16_f32 v113, v118, v119
    v_cndmask_b32 v114, v114, v97, vcc
    s_mov_b32 exec_hi, 0
    buffer_store_dwordx4 v[112:115], v12, s[28:31], s92 offen sc1
    s_mov_b32 exec_hi, -1
    v_mov_b32 v35, 0
    v_mov_b32 v39, 0
    v_mov_b32 v43, 0
    v_mov_b32 v47, 0
    v_readfirstlane_b32 s73, v31
    s_cmp_ge_u32 s3, 2
    s_cbranch_scc1 L_ga5
    s_add_u32 s72, s72, 0x100000
    s_mov_b32 s89, 0
    s_mov_b32 s12, 0
    s_cmp_ge_u32 s73, 56
    s_cselect_b32 s12, 0x1000, 0
L_pm7:
    s_waitcnt vmcnt(0)
L_pmchk9:
    v_cmp_ne_u32 s[4:5], s79, v35
    v_cmp_ne_u32 s[6:7], s79, v39
    v_cmp_ne_u32 s[8:9], s79, v43
    v_cmp_ne_u32 s[10:11], s79, v47
    s_or_b64 vcc, s[4:5], s[6:7]
    s_or_b64 vcc, vcc, s[8:9]
    s_or_b64 vcc, vcc, s[10:11]
    s_cbranch_scc0 L_pmdone8
    s_add_u32 s89, s89, 1
    s_cmp_gt_u32 s89, 20000
    s_cbranch_scc1 L_pmdone8
    s_bcnt1_i32_b64 s13, s[4:5]
    s_bcnt1_i32_b64 s88, s[6:7]
    s_add_u32 s13, s13, s88
    s_bcnt1_i32_b64 s88, s[8:9]
    s_add_u32 s13, s13, s88
    s_bcnt1_i32_b64 s88, s[10:11]
    s_add_u32 s13, s13, s88
    s_cmp_le_u32 s13, 64
    s_cbranch_scc1 L_pmfull10
    s_cmp_lt_u32 s13, s12
    s_cbranch_scc1 L_pmfull10
    s_mov_b32 s12, s13
    s_sleep 6
    s_ff1_i32_b64 s88, s[4:5]
    s_cmp_lt_i32 s88, 0
    s_cbranch_scc1 L_pmw11
    s_and_b32 s88, s88, 56
    s_lshl_b64 exec, 0xff, s88
    buffer_load_dwordx4 v[32:35], v3, s[28:31], s72 offen offset:0 sc1
    s_mov_b64 exec, -1
    s_branch L_pm7
L_pmw11:
    s_ff1_i32_b64 s88, s[6:7]
    s_cmp_lt_i32 s88, 0
    s_cbranch_scc1 L_pmw12
    s_and_b32 s88, s88, 56
    s_lshl_b64 exec, 0xff, s88
    buffer_load_dwordx4 v[36:39], v3, s[28:31], s72 offen offset:1024 sc1
    s_mov_b64 exec, -1
    s_branch L_pm7
L_pmw12:
    s_ff1_i32_b64 s88, s[8:9]
    s_cmp_lt_i32 s88, 0
    s_cbranch_scc1 L_pmw13
    s_and_b32 s88, s88, 56
    s_lshl_b64 exec, 0xff, s88
    buffer_load_dwordx4 v[40:43], v3, s[28:31], s72 offen offset:2048 sc1
    s_mov_b64 exec, -1
    s_branch L_pm7
L_pmw13:
    s_ff1_i32_b64 s88, s[10:11]
    s_cmp_lt_i32 s88, 0
    s_cbranch_scc1 L_pmw14
    s_and_b32 s88, s88, 56
    s_lshl_b64 exec, 0xff, s88
    buffer_load_dwordx4 v[44:47], v3, s[28:31], s72 offen offset:3072 sc1
    s_mov_b64 exec, -1
    s_branch L_pm7
L_pmw14:
L_pmfull10:
    s_mov_b32 s12, 0
    s_mov_b64 exec, s[4:5]
    s_cbranch_execz L_pms15
    buffer_load_dwordx4 v[32:35], v3, s[28:31], s72 offen offset:0 sc1
L_pms15:
    s_mov_b64 exec, s[6:7]
    s_cbranch_execz L_pms16
    buffer_load_dwordx4 v[36:39], v3, s[28:31], s72 offen offset:1024 sc1
L_pms16:
    s_mov_b64 exec, s[8:9]
    s_cbranch_execz L_pms17
    buffer_load_dwordx4 v[40:43], v3, s[28:31], s72 offen offset:2048 sc1
L_pms17:
    s_mov_b64 exec, s[10:11]
    s_cbranch_execz L_pms18
    buffer_load_dwordx4 v[44:47], v3, s[28:31], s72 offen offset:3072 sc1
L_pms18:
    s_mov_b64 exec, -1
    s_branch L_pm7
L_pmdone8:
    s_mov_b32 s85, 0xffff0000
    v_mov_b32_dpp v128, v34 quad_perm:[0,0,2,2] row_mask:0xf bank_mask:0xf
    v_mov_b32_dpp v132, v38 quad_perm:[0,0,2,2] row_mask:0xf bank_mask:0xf
    v_mov_b32_dpp v136, v42 quad_perm:[0,0,2,2] row_mask:0xf bank_mask:0xf
    v_mov_b32_dpp v140, v46 quad_perm:[0,0,2,2] row_mask:0xf bank_mask:0xf
    v_max3_f32 v24, v128, v132, v136
    v_max_f32 v24, v24, v140
    v_lshlrev_b32 v144, 16, v32
    v_and_b32 v145, s85, v32
    v_max_f32_dpp v24, v24, v24 row_ror:8 row_mask:0xf bank_mask:0xf
    v_mov_b32 v25, v24
    v_lshlrev_b32 v146, 16, v33
    v_and_b32 v147, s85, v33
    v_permlane16_swap_b32 v24, v25
    v_max_f32 v24, v24, v25
    v_mov_b32 v25, v24
    v_lshlrev_b32 v148, 16, v36
    v_and_b32 v149, s85, v36
    v_permlane32_swap_b32 v24, v25
    v_max_f32 v24, v24, v25
    v_mul_f32 v26, s78, v24
    v_fma_f32 v128, v128, s78, -v26
    v_fma_f32 v132, v132, s78, -v26
    v_fma_f32 v136, v136, s78, -v26
    v_fma_f32 v140, v140, s78, -v26
    v_exp_f32 v128, v128
    v_exp_f32 v132, v132
    v_exp_f32 v136, v136
    v_exp_f32 v140, v140
    v_lshlrev_b32 v150, 16, v37
    v_and_b32 v151, s85, v37
    v_lshlrev_b32 v152, 16, v40
    v_and_b32 v153, s85, v40
    v_lshlrev_b32 v154, 16, v41
    v_and_b32 v155, s85, v41
    v_lshlrev_b32 v156, 16, v44
    v_and_b32 v157, s85, v44
    v_lshlrev_b32 v158, 16, v45
    v_and_b32 v159, s85, v45
    v_mov_b32_dpp v130, v34 quad_perm:[1,1,3,3] row_mask:0xf bank_mask:0xf
    v_mov_b32_dpp v134, v38 quad_perm:[1,1,3,3] row_mask:0xf bank_mask:0xf
    v_mov_b32_dpp v138, v42 quad_perm:[1,1,3,3] row_mask:0xf bank_mask:0xf
    v_mov_b32_dpp v142, v46 quad_perm:[1,1,3,3] row_mask:0xf bank_mask:0xf
    v_pk_mul_f32 v[16:17], v[144:145], v[128:129] op_sel_hi:[1,0]
    v_pk_mul_f32 v[18:19], v[146:147], v[128:129] op_sel_hi:[1,0]
    v_mul_f32 v27, v130, v128
    v_pk_fma_f32 v[16:17], v[148:149], v[132:133], v[16:17] op_sel_hi:[1,0,1]
    v_pk_fma_f32 v[18:19], v[150:151], v[132:133], v[18:19] op_sel_hi:[1,0,1]
    v_fmac_f32 v27, v134, v132
    v_pk_fma_f32 v[16:17], v[152:153], v[136:137], v[16:17] op_sel_hi:[1,0,1]
    v_pk_fma_f32 v[18:19], v[154:155], v[136:137], v[18:19] op_sel_hi:[1,0,1]
    v_fmac_f32 v27, v138, v136
    v_pk_fma_f32 v[16:17], v[156:157], v[140:141], v[16:17] op_sel_hi:[1,0,1]
    v_pk_fma_f32 v[18:19], v[158:159], v[140:141], v[18:19] op_sel_hi:[1,0,1]
    v_fmac_f32 v27, v142, v140
    v_add_f32_dpp v16, v16, v16 row_ror:8 row_mask:0xf bank_mask:0xf
    v_add_f32_dpp v17, v17, v17 row_ror:8 row_mask:0xf bank_mask:0xf
    v_add_f32_dpp v18, v18, v18 row_ror:8 row_mask:0xf bank_mask:0xf
    v_add_f32_dpp v19, v19, v19 row_ror:8 row_mask:0xf bank_mask:0xf
    v_add_f32_dpp v27, v27, v27 row_ror:8 row_mask:0xf bank_mask:0xf
    v_mov_b32 v25, v27
    v_permlane16_swap_b32 v16, v17
    v_permlane16_swap_b32 v18, v19
    v_permlane16_swap_b32 v27, v25
    v_add_f32 v27, v27, v25
    v_add_f32 v16, v16, v17
    v_add_f32 v18, v18, v19
    v_mov_b32 v25, v27
    s_nop 0
    v_permlane32_swap_b32 v16, v18
    v_permlane32_swap_b32 v27, v25
    v_add_f32 v27, v27, v25
    v_add_f32 v16, v16, v18
    v_rcp_f32 v27, v27
    v_mul_f32 v16, v16, v15
    v_mul_f32 v16, v16, v27
    v_cvt_pk_bf16_f32 v16, v16, v16
    s_mov_b32 exec_lo, 0x00ff00ff
    s_mov_b32 exec_hi, 0x00ff00ff
    ds_write_b16 v1, v16 offset:1152
    s_mov_b64 exec, -1
    s_branch L_gj6
L_ga5:
    s_mov_b32 s89, 0
    s_mov_b32 s12, 0
    s_cmp_ge_u32 s73, 56
    s_cselect_b32 s12, 0x1000, 0
L_pm19:
    s_waitcnt vmcnt(0)
L_pmchk21:
    v_cmp_ne_u32 s[4:5], s79, v35
    v_cmp_ne_u32 s[6:7], s79, v39
    s_or_b64 vcc, s[4:5], s[6:7]
    s_cbranch_scc0 L_pmdone20
    s_add_u32 s89, s89, 1
    s_cmp_gt_u32 s89, 20000
    s_cbranch_scc1 L_pmdone20
    s_bcnt1_i32_b64 s13, s[4:5]
    s_bcnt1_i32_b64 s88, s[6:7]
    s_add_u32 s13, s13, s88
    s_cmp_le_u32 s13, 64
    s_cbranch_scc1 L_pmfull22
    s_cmp_lt_u32 s13, s12
    s_cbranch_scc1 L_pmfull22
    s_mov_b32 s12, s13
    s_sleep 6
    s_ff1_i32_b64 s88, s[4:5]
    s_cmp_lt_i32 s88, 0
    s_cbranch_scc1 L_pmw23
    s_and_b32 s88, s88, 56
    s_lshl_b64 exec, 0xff, s88
    buffer_load_dwordx4 v[32:35], v3, s[28:31], s72 offen offset:0 sc1
    s_mov_b64 exec, -1
    s_branch L_pm19
L_pmw23:
    s_ff1_i32_b64 s88, s[6:7]
    s_cmp_lt_i32 s88, 0
    s_cbranch_scc1 L_pmw24
    s_and_b32 s88, s88, 56
    s_lshl_b64 exec, 0xff, s88
    buffer_load_dwordx4 v[36:39], v3, s[28:31], s72 offen offset:1024 sc1
    s_mov_b64 exec, -1
    s_branch L_pm19
L_pmw24:
L_pmfull22:
    s_mov_b32 s12, 0
    s_mov_b64 exec, s[4:5]
    s_cbranch_execz L_pms25
    buffer_load_dwordx4 v[32:35], v3, s[28:31], s72 offen offset:0 sc1
L_pms25:
    s_mov_b64 exec, s[6:7]
    s_cbranch_execz L_pms26
    buffer_load_dwordx4 v[36:39], v3, s[28:31], s72 offen offset:1024 sc1
L_pms26:
    s_mov_b64 exec, -1
    s_branch L_pm19
L_pmdone20:
    s_mov_b32 s85, 0xffff0000
    v_mov_b32_dpp v128, v34 quad_perm:[0,0,2,2] row_mask:0xf bank_mask:0xf
    v_mov_b32_dpp v132, v38 quad_perm:[0,0,2,2] row_mask:0xf bank_mask:0xf
    v_max_f32 v24, v128, v132
    v_lshlrev_b32 v144, 16, v32
    v_and_b32 v145, s85, v32
    v_max_f32_dpp v24, v24, v24 row_ror:8 row_mask:0xf bank_mask:0xf
    v_mov_b32 v25, v24
    v_lshlrev_b32 v146, 16, v33
    v_and_b32 v147, s85, v33
    v_permlane16_swap_b32 v24, v25
    v_max_f32 v24, v24, v25
    v_mov_b32 v25, v24
    v_lshlrev_b32 v148, 16, v36
    v_and_b32 v149, s85, v36
    v_permlane32_swap_b32 v24, v25
    v_max_f32 v24, v24, v25
    v_mul_f32 v26, s78, v24
    v_fma_f32 v128, v128, s78, -v26
    v_fma_f32 v132, v132, s78, -v26
    v_exp_f32 v128, v128
    v_exp_f32 v132, v132
    v_lshlrev_b32 v150, 16, v37
    v_and_b32 v151, s85, v37
    v_mov_b32_dpp v130, v34 quad_perm:[1,1,3,3] row_mask:0xf bank_mask:0xf
    v_mov_b32_dpp v134, v38 quad_perm:[1,1,3,3] row_mask:0xf bank_mask:0xf
    v_pk_mul_f32 v[16:17], v[144:145], v[128:129] op_sel_hi:[1,0]
    v_pk_mul_f32 v[18:19], v[146:147], v[128:129] op_sel_hi:[1,0]
    v_mul_f32 v27, v130, v128
    v_pk_fma_f32 v[16:17], v[148:149], v[132:133], v[16:17] op_sel_hi:[1,0,1]
    v_pk_fma_f32 v[18:19], v[150:151], v[132:133], v[18:19] op_sel_hi:[1,0,1]
    v_fmac_f32 v27, v134, v132
    v_add_f32_dpp v16, v16, v16 row_ror:8 row_mask:0xf bank_mask:0xf
    v_add_f32_dpp v17, v17, v17 row_ror:8 row_mask:0xf bank_mask:0xf
    v_add_f32_dpp v18, v18, v18 row_ror:8 row_mask:0xf bank_mask:0xf
    v_add_f32_dpp v19, v19, v19 row_ror:8 row_mask:0xf bank_mask:0xf
    v_add_f32_dpp v27, v27, v27 row_ror:8 row_mask:0xf bank_mask:0xf
    v_mov_b32 v25, v27
    v_permlane16_swap_b32 v16, v17
    v_permlane16_swap_b32 v18, v19
    v_permlane16_swap_b32 v27, v25
    v_add_f32 v27, v27, v25
    v_add_f32 v16, v16, v17
    v_add_f32 v18, v18, v19
    v_mov_b32 v25, v27
    s_nop 0
    v_permlane32_swap_b32 v16, v18
    v_permlane32_swap_b32 v27, v25
    v_add_f32 v27, v27, v25
    v_add_f32 v16, v16, v18
    v_rcp_f32 v27, v27
    v_mul_f32 v16, v16, v14
    v_mul_f32 v16, v16, v27
    v_cvt_pk_bf16_f32 v16, v16, v16
    s_mov_b32 exec_lo, 0x00ff00ff
    s_mov_b32 exec_hi, 0x00ff00ff
    ds_write_b16 v1, v16 offset:1024
    s_mov_b64 exec, -1
    v_mov_b32 v25, 1
    s_mov_b64 exec, 1
    ds_add_u32 v10, v25 offset:16
    s_mov_b64 exec, -1
L_gj6:
    s_waitcnt lgkmcnt(0)
    s_barrier
    s_mov_b32 s76, 0x0c0c0400
    s_mov_b32 s77, 0x05040100
    v_mov_b32 v96, 0
    v_mov_b32 v100, 0
    s_mov_b32 s89, 0
    s_mov_b32 s12, 0
L_pm27:
    s_waitcnt vmcnt(0)
L_pmchk29:
    v_perm_b32 v30, v97, v96, s76
    v_perm_b32 v31, v99, v98, s76
    v_perm_b32 v30, v31, v30, s77
    v_cmp_ne_u32 s[4:5], s79, v30
    v_perm_b32 v30, v101, v100, s76
    v_perm_b32 v31, v103, v102, s76
    v_perm_b32 v30, v31, v30, s77
    v_cmp_ne_u32 s[6:7], s79, v30
    s_or_b64 vcc, s[4:5], s[6:7]
    s_cbranch_scc0 L_pmdone28
    s_add_u32 s89, s89, 1
    s_cmp_gt_u32 s89, 20000
    s_cbranch_scc1 L_pmdone28
    s_bcnt1_i32_b64 s13, s[4:5]
    s_bcnt1_i32_b64 s88, s[6:7]
    s_add_u32 s13, s13, s88
    s_cmp_le_u32 s13, 96
    s_cbranch_scc1 L_pmfull30
    s_cmp_lt_u32 s13, s12
    s_cbranch_scc1 L_pmfull30
    s_mov_b32 s12, s13
    s_sleep 6
    s_ff1_i32_b64 s88, s[4:5]
    s_cmp_lt_i32 s88, 0
    s_cbranch_scc1 L_pmw31
    s_and_b32 s88, s88, 60
    s_lshl_b64 exec, 0xf, s88
    buffer_load_dwordx4 v[96:99], v11, s[28:31], s74 offen offset:0 sc1
    s_mov_b64 exec, -1
    s_branch L_pm27
L_pmw31:
    s_ff1_i32_b64 s88, s[6:7]
    s_cmp_lt_i32 s88, 0
    s_cbranch_scc1 L_pmw32
    s_and_b32 s88, s88, 60
    s_lshl_b64 exec, 0xf, s88
    buffer_load_dwordx4 v[100:103], v11, s[28:31], s74 offen offset:2048 sc1
    s_mov_b64 exec, -1
    s_branch L_pm27
L_pmw32:
L_pmfull30:
    s_mov_b32 s12, 0
    s_mov_b64 exec, s[4:5]
    s_cbranch_execz L_pms33
    buffer_load_dwordx4 v[96:99], v11, s[28:31], s74 offen offset:0 sc1
L_pms33:
    s_mov_b64 exec, s[6:7]
    s_cbranch_execz L_pms34
    buffer_load_dwordx4 v[100:103], v11, s[28:31], s74 offen offset:2048 sc1
L_pms34:
    s_mov_b64 exec, -1
    s_branch L_pm27
L_pmdone28:
    v_and_b32 v96, 0xffffff00, v96
    v_and_b32 v97, 0xffffff00, v97
    v_and_b32 v98, 0xffffff00, v98
    v_and_b32 v99, 0xffffff00, v99
    v_and_b32 v100, 0xffffff00, v100
    v_and_b32 v101, 0xffffff00, v101
    v_and_b32 v102, 0xffffff00, v102
    v_and_b32 v103, 0xffffff00, v103
    v_pk_add_f32 v[96:97], v[96:97], v[100:101]
    v_pk_add_f32 v[98:99], v[98:99], v[102:103]
    s_nop 0
    v_add_f32_dpp v96, v96, v96 row_ror:4 row_mask:0xf bank_mask:0xf
    v_add_f32_dpp v97, v97, v97 row_ror:4 row_mask:0xf bank_mask:0xf
    v_add_f32_dpp v98, v98, v98 row_ror:4 row_mask:0xf bank_mask:0xf
    v_add_f32_dpp v99, v99, v99 row_ror:4 row_mask:0xf bank_mask:0xf
    v_add_f32_dpp v96, v96, v96 row_ror:8 row_mask:0xf bank_mask:0xf
    v_add_f32_dpp v97, v97, v97 row_ror:8 row_mask:0xf bank_mask:0xf
    v_add_f32_dpp v98, v98, v98 row_ror:8 row_mask:0xf bank_mask:0xf
    v_add_f32_dpp v99, v99, v99 row_ror:8 row_mask:0xf bank_mask:0xf
    s_nop 0
    v_permlane16_swap_b32 v96, v97
    v_permlane16_swap_b32 v98, v99
    v_add_f32 v96, v96, v97
    v_add_f32 v98, v98, v99
    s_nop 1
    v_permlane32_swap_b32 v96, v98
    v_add_f32 v96, v96, v98
    s_mov_b32 exec_lo, 0x000f000f
    s_mov_b32 exec_hi, 0x000f000f
    ds_write_b32 v2, v96
    s_mov_b64 exec, -1
    s_waitcnt lgkmcnt(0)
    s_barrier
    s_cmp_lg_u32 s3, 0
    s_cbranch_scc1 L_qdone35
    ds_read_b64 v[96:97], v4 offset:1280
    ds_read_b64 v[98:99], v4 offset:1344
    ds_read_b64 v[100:101], v4 offset:1408
    ds_read_b64 v[102:103], v4 offset:1472
    s_waitcnt lgkmcnt(0)
    v_pk_add_f32 v[96:97], v[96:97], v[98:99]
    v_pk_add_f32 v[100:101], v[100:101], v[102:103]
    v_pk_add_f32 v[96:97], v[96:97], v[100:101]
    v_cvt_pk_bf16_f32 v96, v96, v97
    s_mov_b64 exec, 0xff
    buffer_store_dword v96, v13, s[40:43], s75 offen
    s_cmp_lg_u32 s90, 0
    s_cbranch_scc1 L_qdone35
    v_mov_b32 v98, 0
    s_mov_b64 exec, 1
    buffer_store_dword v98, off, s[44:47], 0 sc1
    s_mov_b64 exec, -1
L_qdone35:
    s_mov_b64 exec, -1
    s_endpgm
L_q_y:
    s_setprio 3
    v_lshrrev_b32 v26, 5, v0
    v_lshlrev_b32 v27, 12, v26
    v_lshlrev_b32 v28, 14, v26
    v_and_b32 v26, 31, v0
    v_lshl_add_u32 v27, v26, 4, v27
    v_add_u32 v27, 6656, v27
    v_lshl_add_u32 v28, v26, 3, v28
    s_lshr_b32 s85, s90, 6
    s_lshl_b32 s85, s85, 15
    s_lshl_b32 s86, s95, 8
    s_add_u32 s87, s85, s86
    s_waitcnt vmcnt(0)
    s_mov_b32 s89, 0
L_nn36:
    v_readfirstlane_b32 s79, v95
    s_add_u32 s89, s89, 1
    s_cmp_lg_u32 s79, 0
    s_cbranch_scc1 L_nnok37
    s_cmp_gt_u32 s89, 20000
    s_cbranch_scc1 L_nnok37
    buffer_load_dword v95, off, s[44:47], 0 sc1
    s_waitcnt vmcnt(0)
    s_branch L_nn36
L_nnok37:
    s_mov_b32 s89, 0
L_ls38:
    ds_read_b32 v31, v10 offset:0
    s_waitcnt lgkmcnt(0)
    v_readfirstlane_b32 s88, v31
    s_add_u32 s89, s89, 1
    s_cmp_eq_u32 s88, 8
    s_cbranch_scc1 L_lsok39
    s_cmp_gt_u32 s89, 1000000
    s_cbranch_scc1 L_lsok39
    s_sleep 1
    s_branch L_ls38
L_lsok39:
    ds_read_b128 v[32:35], v27 offset:0
    ds_read_b128 v[36:39], v27 offset:512
    ds_read_b128 v[40:43], v27 offset:1024
    ds_read_b128 v[44:47], v27 offset:1536
    ds_read_b128 v[48:51], v27 offset:2048
    ds_read_b128 v[52:55], v27 offset:2560
    ds_read_b128 v[56:59], v27 offset:3072
    ds_read_b128 v[60:63], v27 offset:3584
    s_waitcnt lgkmcnt(0)
    v_pk_add_f32 v[32:33], v[32:33], v[48:49]
    v_pk_add_f32 v[34:35], v[34:35], v[50:51]
    v_pk_add_f32 v[36:37], v[36:37], v[52:53]
    v_pk_add_f32 v[38:39], v[38:39], v[54:55]
    v_pk_add_f32 v[40:41], v[40:41], v[56:57]
    v_pk_add_f32 v[42:43], v[42:43], v[58:59]
    v_pk_add_f32 v[44:45], v[44:45], v[60:61]
    v_pk_add_f32 v[46:47], v[46:47], v[62:63]
    v_pk_add_f32 v[32:33], v[32:33], v[40:41]
    v_pk_add_f32 v[34:35], v[34:35], v[42:43]
    v_pk_add_f32 v[36:37], v[36:37], v[44:45]
    v_pk_add_f32 v[38:39], v[38:39], v[46:47]
    v_pk_add_f32 v[32:33], v[32:33], v[36:37]
    v_pk_add_f32 v[34:35], v[34:35], v[38:39]
    v_mov_b32 v37, s79
    s_nop 0
    v_permlane32_swap_b32 v32, v33
    v_permlane32_swap_b32 v34, v35
    v_add_f32 v32, v32, v33
    v_add_f32 v34, v34, v35
    v_cvt_pk_bf16_f32 v36, v32, v34
    s_and_b32 s85, s3, 3
    s_lshl_b32 s85, s85, 4
    s_lshl_b64 exec, 0xffff, s85
    buffer_store_dwordx2 v[36:37], v28, s[28:31], s87 offen sc1
    s_mov_b64 exec, -1
    s_setprio 0
    s_lshl_b32 s100, s80, 12
    s_and_b32 s86, s3, 3
    s_lshl_b32 s87, s86, 10
    s_add_u32 s100, s100, s87
    s_add_u32 s101, s100, 32768
    s_mul_i32 s86, s86, 544
    v_add_u32 v11, s86, v11
    s_mov_b32 s99, 0
    s_add_u32 s85, s83, 0x0
    buffer_load_dwordx4 v[160:163], v1, s[4:7], s85 offen offset:0 nt
    buffer_load_dwordx4 v[164:167], v1, s[4:7], s85 offen offset:64 nt
    buffer_load_dwordx4 v[168:171], v1, s[4:7], s85 offen offset:128 nt
    buffer_load_dwordx4 v[172:175], v1, s[4:7], s85 offen offset:192 nt
    buffer_load_dwordx4 v[176:179], v2, s[4:7], s85 offen offset:0 nt
    buffer_load_dwordx4 v[180:183], v2, s[4:7], s85 offen offset:64 nt
    buffer_load_dwordx4 v[184:187], v2, s[4:7], s85 offen offset:128 nt
    buffer_load_dwordx4 v[188:191], v2, s[4:7], s85 offen offset:192 nt
    buffer_load_dwordx4 v[32:35], v3, s[28:31], s101 offen sc1
L_qps40:
    s_add_u32 s85, s83, 0x0
    buffer_load_dwordx4 v[192:195], v3, s[8:11], s85 offen offset:0 nt
    buffer_load_dwordx4 v[196:199], v3, s[8:11], s85 offen offset:1024 nt
    buffer_load_dwordx4 v[200:203], v3, s[8:11], s85 offen offset:2048 nt
    buffer_load_dwordx4 v[204:207], v3, s[8:11], s85 offen offset:3072 nt
    buffer_load_dwordx4 v[208:211], v4, s[8:11], s85 offen offset:0 nt
    buffer_load_dwordx4 v[212:215], v4, s[8:11], s85 offen offset:1024 nt
    buffer_load_dwordx4 v[216:219], v4, s[8:11], s85 offen offset:2048 nt
    buffer_load_dwordx4 v[220:223], v4, s[8:11], s85 offen offset:3072 nt
    s_cmp_eq_u32 s99, 1
    s_cbranch_scc1 L_qskip41
    s_waitcnt vmcnt(8)
    v_xor_b32 v30, s79, v33
    v_xor_b32 v31, s79, v35
    v_or_b32 v30, v30, v31
    v_cmp_ne_u32 s[72:73], 0, v30
    s_or_b64 vcc, s[72:73], s[72:73]
    s_cbranch_scc1 L_qskip41
    v_mov_b32 v33, v34
    v_mov_b32 v24, s79
    v_mov_b32 v25, 1
    ds_write_b64 v11, v[32:33] offset:2176
    s_mov_b64 exec, 1
    ds_write_b32 v10, v24 offset:8
    ds_add_u32 v10, v25 offset:4
    s_mov_b64 exec, -1
    s_mov_b32 s99, 1
L_qskip41:
    s_cmp_eq_u32 s99, 1
    s_cbranch_scc1 L_qps42
    s_mov_b64 exec, s[72:73]
    s_cbranch_execz L_qpm43
    buffer_load_dwordx4 v[32:35], v3, s[28:31], s101 offen sc1
L_qpm43:
    s_mov_b64 exec, -1
L_qps42:
    s_add_u32 s85, s83, 0x200000
    buffer_load_dwordx4 v[224:227], v1, s[4:7], s85 offen offset:0 nt
    buffer_load_dwordx4 v[228:231], v1, s[4:7], s85 offen offset:64 nt
    buffer_load_dwordx4 v[232:235], v1, s[4:7], s85 offen offset:128 nt
    buffer_load_dwordx4 v[236:239], v1, s[4:7], s85 offen offset:192 nt
    buffer_load_dwordx4 v[240:243], v2, s[4:7], s85 offen offset:0 nt
    buffer_load_dwordx4 v[244:247], v2, s[4:7], s85 offen offset:64 nt
    buffer_load_dwordx4 v[248:251], v2, s[4:7], s85 offen offset:128 nt
    buffer_load_dwordx4 v[252:255], v2, s[4:7], s85 offen offset:192 nt
    s_cmp_eq_u32 s99, 1
    s_cbranch_scc1 L_qskip44
    s_waitcnt vmcnt(8)
    v_xor_b32 v30, s79, v33
    v_xor_b32 v31, s79, v35
    v_or_b32 v30, v30, v31
    v_cmp_ne_u32 s[72:73], 0, v30
    s_or_b64 vcc, s[72:73], s[72:73]
    s_cbranch_scc1 L_qskip44
    v_mov_b32 v33, v34
    v_mov_b32 v24, s79
    v_mov_b32 v25, 1
    ds_write_b64 v11, v[32:33] offset:2176
    s_mov_b64 exec, 1
    ds_write_b32 v10, v24 offset:8
    ds_add_u32 v10, v25 offset:4
    s_mov_b64 exec, -1
    s_mov_b32 s99, 1
L_qskip44:
    s_cmp_eq_u32 s99, 1
    s_cbranch_scc1 L_qps45
    s_mov_b64 exec, s[72:73]
    s_cbranch_execz L_qpm46
    buffer_load_dwordx4 v[32:35], v3, s[28:31], s101 offen sc1
L_qpm46:
    s_mov_b64 exec, -1
L_qps45:
    s_add_u32 s85, s83, 0x200000
    buffer_load_dwordx4 v[96:99], v3, s[8:11], s85 offen offset:0 nt
    buffer_load_dwordx4 v[100:103], v3, s[8:11], s85 offen offset:1024 nt
    buffer_load_dwordx4 v[104:107], v3, s[8:11], s85 offen offset:2048 nt
    buffer_load_dwordx4 v[108:111], v3, s[8:11], s85 offen offset:3072 nt
    buffer_load_dwordx4 v[112:115], v4, s[8:11], s85 offen offset:0 nt
    buffer_load_dwordx4 v[116:119], v4, s[8:11], s85 offen offset:1024 nt
    buffer_load_dwordx4 v[120:123], v4, s[8:11], s85 offen offset:2048 nt
    buffer_load_dwordx4 v[124:127], v4, s[8:11], s85 offen offset:3072 nt
    s_cmp_eq_u32 s99, 1
    s_cbranch_scc1 L_qskip47
    s_waitcnt vmcnt(8)
    v_xor_b32 v30, s79, v33
    v_xor_b32 v31, s79, v35
    v_or_b32 v30, v30, v31
    v_cmp_ne_u32 s[72:73], 0, v30
    s_or_b64 vcc, s[72:73], s[72:73]
    s_cbranch_scc1 L_qskip47
    v_mov_b32 v33, v34
    v_mov_b32 v24, s79
    v_mov_b32 v25, 1
    ds_write_b64 v11, v[32:33] offset:2176
    s_mov_b64 exec, 1
    ds_write_b32 v10, v24 offset:8
    ds_add_u32 v10, v25 offset:4
    s_mov_b64 exec, -1
    s_mov_b32 s99, 1
L_qskip47:
    s_cmp_eq_u32 s99, 1
    s_cbranch_scc1 L_qps48
    s_mov_b64 exec, s[72:73]
    s_cbranch_execz L_qpm49
    buffer_load_dwordx4 v[32:35], v3, s[28:31], s101 offen sc1
L_qpm49:
    s_mov_b64 exec, -1
L_qps48:
    s_add_u32 s85, s83, 0x400000
    buffer_load_dwordx4 v[128:131], v1, s[4:7], s85 offen offset:0 nt
    buffer_load_dwordx4 v[132:135], v1, s[4:7], s85 offen offset:64 nt
    buffer_load_dwordx4 v[136:139], v1, s[4:7], s85 offen offset:128 nt
    buffer_load_dwordx4 v[140:143], v1, s[4:7], s85 offen offset:192 nt
    buffer_load_dwordx4 v[144:147], v2, s[4:7], s85 offen offset:0 nt
    buffer_load_dwordx4 v[148:151], v2, s[4:7], s85 offen offset:64 nt
    buffer_load_dwordx4 v[152:155], v2, s[4:7], s85 offen offset:128 nt
    buffer_load_dwordx4 v[156:159], v2, s[4:7], s85 offen offset:192 nt
    s_cmp_eq_u32 s99, 1
    s_cbranch_scc1 L_qskip50
    s_waitcnt vmcnt(8)
    v_xor_b32 v30, s79, v33
    v_xor_b32 v31, s79, v35
    v_or_b32 v30, v30, v31
    v_cmp_ne_u32 s[72:73], 0, v30
    s_or_b64 vcc, s[72:73], s[72:73]
    s_cbranch_scc1 L_qskip50
    v_mov_b32 v33, v34
    v_mov_b32 v24, s79
    v_mov_b32 v25, 1
    ds_write_b64 v11, v[32:33] offset:2176
    s_mov_b64 exec, 1
    ds_write_b32 v10, v24 offset:8
    ds_add_u32 v10, v25 offset:4
    s_mov_b64 exec, -1
    s_mov_b32 s99, 1
L_qskip50:
    s_cmp_eq_u32 s99, 1
    s_cbranch_scc1 L_qd51
    s_mov_b32 s89, 0
L_poll52:
    buffer_load_dwordx4 v[32:35], v3, s[28:31], s101 offen sc1
    s_waitcnt vmcnt(0)
    v_xor_b32 v31, s79, v33
    v_xor_b32 v30, s79, v35
    v_or_b32 v31, v31, v30
    v_cmp_ne_u32 vcc, 0, v31
    s_add_u32 s89, s89, 1
    s_cbranch_vccz L_ok53
    s_cmp_gt_u32 s89, 20000
    s_cbranch_scc1 L_ok53
    s_sleep 1
    s_branch L_poll52
L_ok53:
    v_mov_b32 v33, v34
    v_mov_b32 v24, s79
    v_mov_b32 v25, 1
    ds_write_b64 v11, v[32:33] offset:2176
    s_mov_b64 exec, 1
    ds_write_b32 v10, v24 offset:8
    ds_add_u32 v10, v25 offset:4
    s_mov_b64 exec, -1
    s_mov_b32 s99, 1
L_qd51:
    s_mov_b32 s89, 0
L_ls54:
    ds_read_b32 v31, v10 offset:4
    s_waitcnt lgkmcnt(0)
    v_readfirstlane_b32 s88, v31
    s_add_u32 s89, s89, 1
    s_cmp_eq_u32 s88, 4
    s_cbranch_scc1 L_lsok55
    s_cmp_gt_u32 s89, 1000000
    s_cbranch_scc1 L_lsok55
    s_sleep 1
    s_branch L_ls54
L_lsok55:
    ds_read_b32 v31, v10 offset:8
    s_waitcnt lgkmcnt(0)
    v_readfirstlane_b32 s79, v31
    ds_read_b128 v[64:67], v7 offset:2176
    ds_read_b128 v[68:71], v7 offset:2240
    ds_read_b128 v[72:75], v7 offset:2304
    ds_read_b128 v[76:79], v7 offset:2368
    v_lshrrev_b32 v24, 3, v0
    v_lshlrev_b32 v12, 12, v24
    v_and_b32 v24, 7, v0
    v_lshl_add_u32 v12, v24, 4, v12
    v_lshrrev_b32 v24, 4, v0
    v_lshlrev_b32 v13, 12, v24
    v_and_b32 v24, 15, v0
    v_lshl_add_u32 v13, v24, 4, v13
    s_lshl_b32 s91, s90, 16
    s_and_b32 s86, s3, 3
    s_lshl_b32 s86, s86, 8
    s_add_u32 s91, s91, s86
    s_waitcnt lgkmcnt(0)
    s_lshl_b32 s100, s80, 23
    s_lshl_b32 s85, s3, 13
    s_add_u32 s100, s100, s85
    s_add_u32 s100, s100, 0x600000
    s_lshl_b32 s101, s80, 2
    s_and_b32 s85, s3, 3
    s_add_u32 s101, s101, s85
    s_lshl_b32 s101, s101, 8
    s_add_u32 s101, s101, 0x50000
    s_waitcnt vmcnt(32)
    v_mfma_f32_16x16x32_bf16 v[80:83], v[160:163], v[64:67], 0
    v_mfma_f32_16x16x32_bf16 v[84:87], v[176:179], v[64:67], 0
    v_mfma_f32_16x16x32_bf16 v[80:83], v[164:167], v[68:71], v[80:83]
    v_mfma_f32_16x16x32_bf16 v[84:87], v[180:183], v[68:71], v[84:87]
    v_mfma_f32_16x16x32_bf16 v[80:83], v[168:171], v[72:75], v[80:83]
    v_mfma_f32_16x16x32_bf16 v[84:87], v[184:187], v[72:75], v[84:87]
    v_mfma_f32_16x16x32_bf16 v[80:83], v[172:175], v[76:79], v[80:83]
    v_mfma_f32_16x16x32_bf16 v[84:87], v[188:191], v[76:79], v[84:87]
    s_add_u32 s85, s83, 0x400000
    buffer_load_dwordx4 v[160:163], v3, s[8:11], s85 offen offset:0 nt
    buffer_load_dwordx4 v[164:167], v3, s[8:11], s85 offen offset:1024 nt
    buffer_load_dwordx4 v[168:171], v3, s[8:11], s85 offen offset:2048 nt
    buffer_load_dwordx4 v[172:175], v3, s[8:11], s85 offen offset:3072 nt
    buffer_load_dwordx4 v[176:179], v4, s[8:11], s85 offen offset:0 nt
    buffer_load_dwordx4 v[180:183], v4, s[8:11], s85 offen offset:1024 nt
    buffer_load_dwordx4 v[184:187], v4, s[8:11], s85 offen offset:2048 nt
    buffer_load_dwordx4 v[188:191], v4, s[8:11], s85 offen offset:3072 nt
    v_max3_f32 v24, v80, v81, v82
    v_max3_f32 v24, v24, v83, v84
    v_max3_f32 v24, v24, v85, v86
    v_max_f32 v24, v24, v87
    v_mov_b32 v25, v24
    s_nop 1
    v_permlane16_swap_b32 v24, v25
    v_max_f32 v24, v24, v25
    v_mov_b32 v25, v24
    s_nop 1
    v_permlane32_swap_b32 v24, v25
    v_max_f32 v24, v24, v25
    v_mul_f32 v26, s78, v24
    v_mov_b32 v92, v24
    v_fma_f32 v80, v80, s78, -v26
    v_fma_f32 v81, v81, s78, -v26
    v_fma_f32 v82, v82, s78, -v26
    v_fma_f32 v83, v83, s78, -v26
    v_fma_f32 v84, v84, s78, -v26
    v_fma_f32 v85, v85, s78, -v26
    v_fma_f32 v86, v86, s78, -v26
    v_fma_f32 v87, v87, s78, -v26
    v_exp_f32 v80, v80
    v_exp_f32 v81, v81
    v_exp_f32 v82, v82
    v_exp_f32 v83, v83
    v_exp_f32 v84, v84
    v_exp_f32 v85, v85
    v_exp_f32 v86, v86
    v_exp_f32 v87, v87
    s_nop 0
    v_add_f32 v24, v80, v81
    v_add_f32 v25, v82, v83
    v_add_f32 v24, v24, v84
    v_add_f32 v25, v25, v85
    v_add_f32 v24, v24, v86
    v_add_f32 v25, v25, v87
    v_cvt_pk_bf16_f32 v88, v80, v81
    v_cvt_pk_bf16_f32 v89, v82, v83
    v_cvt_pk_bf16_f32 v90, v84, v85
    v_cvt_pk_bf16_f32 v91, v86, v87
    v_add_f32 v24, v24, v25
    v_mov_b32 v93, v24
    s_waitcnt vmcnt(32)
    v_perm_b32 v16, v196, v192, s76
    v_perm_b32 v17, v204, v200, s76
    v_perm_b32 v18, v212, v208, s76
    v_perm_b32 v19, v220, v216, s76
    v_perm_b32 v20, v196, v192, s77
    v_perm_b32 v21, v204, v200, s77
    v_perm_b32 v22, v212, v208, s77
    v_perm_b32 v23, v220, v216, s77
    v_mfma_f32_16x16x32_bf16 v[32:35], v[16:19], v[88:91], 0
    v_perm_b32 v16, v197, v193, s76
    v_perm_b32 v17, v205, v201, s76
    v_perm_b32 v18, v213, v209, s76
    v_perm_b32 v19, v221, v217, s76
    v_mfma_f32_16x16x32_bf16 v[36:39], v[20:23], v[88:91], 0
    v_perm_b32 v20, v197, v193, s77
    v_perm_b32 v21, v205, v201, s77
    v_perm_b32 v22, v213, v209, s77
    v_perm_b32 v23, v221, v217, s77
    v_mfma_f32_16x16x32_bf16 v[40:43], v[16:19], v[88:91], 0
    v_perm_b32 v16, v198, v194, s76
    v_perm_b32 v17, v206, v202, s76
    v_perm_b32 v18, v214, v210, s76
    v_perm_b32 v19, v222, v218, s76
    v_mfma_f32_16x16x32_bf16 v[44:47], v[20:23], v[88:91], 0
    v_perm_b32 v20, v198, v194, s77
    v_perm_b32 v21, v206, v202, s77
    v_perm_b32 v22, v214, v210, s77
    v_perm_b32 v23, v222, v218, s77
    v_mfma_f32_16x16x32_bf16 v[48:51], v[16:19], v[88:91], 0
    v_perm_b32 v16, v199, v195, s76
    v_perm_b32 v17, v207, v203, s76
    v_perm_b32 v18, v215, v211, s76
    v_perm_b32 v19, v223, v219, s76
    v_mfma_f32_16x16x32_bf16 v[52:55], v[20:23], v[88:91], 0
    v_perm_b32 v20, v199, v195, s77
    v_perm_b32 v21, v207, v203, s77
    v_perm_b32 v22, v215, v211, s77
    v_perm_b32 v23, v223, v219, s77
    v_mfma_f32_16x16x32_bf16 v[56:59], v[16:19], v[88:91], 0
    s_nop 0
    v_mfma_f32_16x16x32_bf16 v[60:63], v[20:23], v[88:91], 0
    v_mov_b32 v95, 1
    s_mov_b64 exec, 1
    buffer_atomic_add v95, off, s[28:31], s101 sc0
    s_mov_b64 exec, -1
    s_waitcnt vmcnt(25)
    v_mfma_f32_16x16x32_bf16 v[80:83], v[224:227], v[64:67], 0
    v_mfma_f32_16x16x32_bf16 v[84:87], v[240:243], v[64:67], 0
    v_mfma_f32_16x16x32_bf16 v[80:83], v[228:231], v[68:71], v[80:83]
    v_mfma_f32_16x16x32_bf16 v[84:87], v[244:247], v[68:71], v[84:87]
    v_mfma_f32_16x16x32_bf16 v[80:83], v[232:235], v[72:75], v[80:83]
    v_mfma_f32_16x16x32_bf16 v[84:87], v[248:251], v[72:75], v[84:87]
    v_mfma_f32_16x16x32_bf16 v[80:83], v[236:239], v[76:79], v[80:83]
    v_mfma_f32_16x16x32_bf16 v[84:87], v[252:255], v[76:79], v[84:87]
    s_nop 7
    v_max3_f32 v24, v80, v81, v82
    v_max3_f32 v24, v24, v83, v84
    v_max3_f32 v24, v24, v85, v86
    v_max3_f32 v24, v24, v87, v92
    v_mov_b32 v25, v24
    s_nop 1
    v_permlane16_swap_b32 v24, v25
    v_max_f32 v24, v24, v25
    v_mov_b32 v25, v24
    s_nop 1
    v_permlane32_swap_b32 v24, v25
    v_max_f32 v24, v24, v25
    v_mul_f32 v26, s78, v24
    v_fma_f32 v28, v92, s78, -v26
    v_exp_f32 v28, v28
    v_mov_b32 v92, v24
    v_fma_f32 v80, v80, s78, -v26
    v_fma_f32 v81, v81, s78, -v26
    v_fma_f32 v82, v82, s78, -v26
    v_fma_f32 v83, v83, s78, -v26
    v_fma_f32 v84, v84, s78, -v26
    v_fma_f32 v85, v85, s78, -v26
    v_fma_f32 v86, v86, s78, -v26
    v_fma_f32 v87, v87, s78, -v26
    v_exp_f32 v80, v80
    v_exp_f32 v81, v81
    v_exp_f32 v82, v82
    v_exp_f32 v83, v83
    v_exp_f32 v84, v84
    v_exp_f32 v85, v85
    v_exp_f32 v86, v86
    v_exp_f32 v87, v87
    v_pk_mul_f32 v[32:33], v[32:33], v[28:29] op_sel_hi:[1,0]
    v_pk_mul_f32 v[34:35], v[34:35], v[28:29] op_sel_hi:[1,0]
    v_pk_mul_f32 v[36:37], v[36:37], v[28:29] op_sel_hi:[1,0]
    v_pk_mul_f32 v[38:39], v[38:39], v[28:29] op_sel_hi:[1,0]
    v_pk_mul_f32 v[40:41], v[40:41], v[28:29] op_sel_hi:[1,0]
    v_pk_mul_f32 v[42:43], v[42:43], v[28:29] op_sel_hi:[1,0]
    v_pk_mul_f32 v[44:45], v[44:45], v[28:29] op_sel_hi:[1,0]
    v_pk_mul_f32 v[46:47], v[46:47], v[28:29] op_sel_hi:[1,0]
    v_pk_mul_f32 v[48:49], v[48:49], v[28:29] op_sel_hi:[1,0]
    v_pk_mul_f32 v[50:51], v[50:51], v[28:29] op_sel_hi:[1,0]
    v_pk_mul_f32 v[52:53], v[52:53], v[28:29] op_sel_hi:[1,0]
    v_pk_mul_f32 v[54:55], v[54:55], v[28:29] op_sel_hi:[1,0]
    v_pk_mul_f32 v[56:57], v[56:57], v[28:29] op_sel_hi:[1,0]
    v_pk_mul_f32 v[58:59], v[58:59], v[28:29] op_sel_hi:[1,0]
    v_pk_mul_f32 v[60:61], v[60:61], v[28:29] op_sel_hi:[1,0]
    v_pk_mul_f32 v[62:63], v[62:63], v[28:29] op_sel_hi:[1,0]
    v_add_f32 v24, v80, v81
    v_add_f32 v25, v82, v83
    v_add_f32 v24, v24, v84
    v_add_f32 v25, v25, v85
    v_add_f32 v24, v24, v86
    v_add_f32 v25, v25, v87
    v_cvt_pk_bf16_f32 v88, v80, v81
    v_cvt_pk_bf16_f32 v89, v82, v83
    v_cvt_pk_bf16_f32 v90, v84, v85
    v_cvt_pk_bf16_f32 v91, v86, v87
    v_add_f32 v24, v24, v25
    v_fma_f32 v93, v93, v28, v24
    s_waitcnt vmcnt(17)
    v_perm_b32 v16, v100, v96, s76
    v_perm_b32 v17, v108, v104, s76
    v_perm_b32 v18, v116, v112, s76
    v_perm_b32 v19, v124, v120, s76
    v_perm_b32 v20, v100, v96, s77
    v_perm_b32 v21, v108, v104, s77
    v_perm_b32 v22, v116, v112, s77
    v_perm_b32 v23, v124, v120, s77
    v_mfma_f32_16x16x32_bf16 v[32:35], v[16:19], v[88:91], v[32:35]
    v_perm_b32 v16, v101, v97, s76
    v_perm_b32 v17, v109, v105, s76
    v_perm_b32 v18, v117, v113, s76
    v_perm_b32 v19, v125, v121, s76
    v_mfma_f32_16x16x32_bf16 v[36:39], v[20:23], v[88:91], v[36:39]
    v_perm_b32 v20, v101, v97, s77
    v_perm_b32 v21, v109, v105, s77
    v_perm_b32 v22, v117, v113, s77
    v_perm_b32 v23, v125, v121, s77
    v_mfma_f32_16x16x32_bf16 v[40:43], v[16:19], v[88:91], v[40:43]
    v_perm_b32 v16, v102, v98, s76
    v_perm_b32 v17, v110, v106, s76
    v_perm_b32 v18, v118, v114, s76
    v_perm_b32 v19, v126, v122, s76
    v_mfma_f32_16x16x32_bf16 v[44:47], v[20:23], v[88:91], v[44:47]
    v_perm_b32 v20, v102, v98, s77
    v_perm_b32 v21, v110, v106, s77
    v_perm_b32 v22, v118, v114, s77
    v_perm_b32 v23, v126, v122, s77
    v_mfma_f32_16x16x32_bf16 v[48:51], v[16:19], v[88:91], v[48:51]
    v_perm_b32 v16, v103, v99, s76
    v_perm_b32 v17, v111, v107, s76
    v_perm_b32 v18, v119, v115, s76
    v_perm_b32 v19, v127, v123, s76
    v_mfma_f32_16x16x32_bf16 v[52:55], v[20:23], v[88:91], v[52:55]
    v_perm_b32 v20, v103, v99, s77
    v_perm_b32 v21, v111, v107, s77
    v_perm_b32 v22, v119, v115, s77
    v_perm_b32 v23, v127, v123, s77
    v_mfma_f32_16x16x32_bf16 v[56:59], v[16:19], v[88:91], v[56:59]
    s_nop 0
    v_mfma_f32_16x16x32_bf16 v[60:63], v[20:23], v[88:91], v[60:63]
    s_waitcnt vmcnt(0)
    v_readfirstlane_b32 s99, v95
    s_nop 0
    s_cmp_ge_u32 s99, 44
    s_cbranch_scc1 L_dend56
    s_sub_u32 s85, s99, 20
    s_lshr_b32 s86, s85, 1
    s_add_u32 s86, s86, 20
    s_lshl_b32 s86, s86, 16
    s_and_b32 s85, s85, 1
    s_lshl_b32 s85, s85, 12
    s_add_u32 s86, s86, s85
    s_lshl_b32 s85, s99, 16
    s_cmp_lt_u32 s99, 20
    s_cselect_b32 s99, s85, s86
    s_cselect_b32 s70, 0, 0xff7fffff
    s_cselect_b32 s85, 0, 0x40000000
    s_add_u32 s99, s99, s100
    v_add_u32 v14, s85, v2
    v_add_u32 v15, s85, v4
    buffer_load_dwordx4 v[192:195], v1, s[4:7], s99 offen offset:0 nt
    buffer_load_dwordx4 v[196:199], v1, s[4:7], s99 offen offset:64 nt
    buffer_load_dwordx4 v[200:203], v1, s[4:7], s99 offen offset:128 nt
    buffer_load_dwordx4 v[204:207], v1, s[4:7], s99 offen offset:192 nt
    buffer_load_dwordx4 v[208:211], v14, s[4:7], s99 offen offset:0 nt
    buffer_load_dwordx4 v[212:215], v14, s[4:7], s99 offen offset:64 nt
    buffer_load_dwordx4 v[216:219], v14, s[4:7], s99 offen offset:128 nt
    buffer_load_dwordx4 v[220:223], v14, s[4:7], s99 offen offset:192 nt
    v_mov_b32 v95, 1
    s_mov_b64 exec, 1
    buffer_atomic_add v95, off, s[28:31], s101 sc0
    s_mov_b64 exec, -1
    v_mfma_f32_16x16x32_bf16 v[80:83], v[128:131], v[64:67], 0
    v_mfma_f32_16x16x32_bf16 v[84:87], v[144:147], v[64:67], 0
    v_mfma_f32_16x16x32_bf16 v[80:83], v[132:135], v[68:71], v[80:83]
    v_mfma_f32_16x16x32_bf16 v[84:87], v[148:151], v[68:71], v[84:87]
    v_mfma_f32_16x16x32_bf16 v[80:83], v[136:139], v[72:75], v[80:83]
    v_mfma_f32_16x16x32_bf16 v[84:87], v[152:155], v[72:75], v[84:87]
    v_mfma_f32_16x16x32_bf16 v[80:83], v[140:143], v[76:79], v[80:83]
    v_mfma_f32_16x16x32_bf16 v[84:87], v[156:159], v[76:79], v[84:87]
    buffer_load_dwordx4 v[224:227], v3, s[8:11], s99 offen offset:0 nt
    buffer_load_dwordx4 v[228:231], v3, s[8:11], s99 offen offset:1024 nt
    buffer_load_dwordx4 v[232:235], v3, s[8:11], s99 offen offset:2048 nt
    buffer_load_dwordx4 v[236:239], v3, s[8:11], s99 offen offset:3072 nt
    buffer_load_dwordx4 v[240:243], v15, s[8:11], s99 offen offset:0 nt
    buffer_load_dwordx4 v[244:247], v15, s[8:11], s99 offen offset:1024 nt
    buffer_load_dwordx4 v[248:251], v15, s[8:11], s99 offen offset:2048 nt
    buffer_load_dwordx4 v[252:255], v15, s[8:11], s99 offen offset:3072 nt
    v_max3_f32 v24, v80, v81, v82
    v_max3_f32 v24, v24, v83, v84
    v_max3_f32 v24, v24, v85, v86
    v_max3_f32 v24, v24, v87, v92
    v_mov_b32 v25, v24
    s_nop 1
    v_permlane16_swap_b32 v24, v25
    v_max_f32 v24, v24, v25
    v_mov_b32 v25, v24
    s_nop 1
    v_permlane32_swap_b32 v24, v25
    v_max_f32 v24, v24, v25
    v_mul_f32 v26, s78, v24
    v_fma_f32 v28, v92, s78, -v26
    v_exp_f32 v28, v28
    v_mov_b32 v92, v24
    v_fma_f32 v80, v80, s78, -v26
    v_fma_f32 v81, v81, s78, -v26
    v_fma_f32 v82, v82, s78, -v26
    v_fma_f32 v83, v83, s78, -v26
    v_fma_f32 v84, v84, s78, -v26
    v_fma_f32 v85, v85, s78, -v26
    v_fma_f32 v86, v86, s78, -v26
    v_fma_f32 v87, v87, s78, -v26
    v_exp_f32 v80, v80
    v_exp_f32 v81, v81
    v_exp_f32 v82, v82
    v_exp_f32 v83, v83
    v_exp_f32 v84, v84
    v_exp_f32 v85, v85
    v_exp_f32 v86, v86
    v_exp_f32 v87, v87
    v_pk_mul_f32 v[32:33], v[32:33], v[28:29] op_sel_hi:[1,0]
    v_pk_mul_f32 v[34:35], v[34:35], v[28:29] op_sel_hi:[1,0]
    v_pk_mul_f32 v[36:37], v[36:37], v[28:29] op_sel_hi:[1,0]
    v_pk_mul_f32 v[38:39], v[38:39], v[28:29] op_sel_hi:[1,0]
    v_pk_mul_f32 v[40:41], v[40:41], v[28:29] op_sel_hi:[1,0]
    v_pk_mul_f32 v[42:43], v[42:43], v[28:29] op_sel_hi:[1,0]
    v_pk_mul_f32 v[44:45], v[44:45], v[28:29] op_sel_hi:[1,0]
    v_pk_mul_f32 v[46:47], v[46:47], v[28:29] op_sel_hi:[1,0]
    v_pk_mul_f32 v[48:49], v[48:49], v[28:29] op_sel_hi:[1,0]
    v_pk_mul_f32 v[50:51], v[50:51], v[28:29] op_sel_hi:[1,0]
    v_pk_mul_f32 v[52:53], v[52:53], v[28:29] op_sel_hi:[1,0]
    v_pk_mul_f32 v[54:55], v[54:55], v[28:29] op_sel_hi:[1,0]
    v_pk_mul_f32 v[56:57], v[56:57], v[28:29] op_sel_hi:[1,0]
    v_pk_mul_f32 v[58:59], v[58:59], v[28:29] op_sel_hi:[1,0]
    v_pk_mul_f32 v[60:61], v[60:61], v[28:29] op_sel_hi:[1,0]
    v_pk_mul_f32 v[62:63], v[62:63], v[28:29] op_sel_hi:[1,0]
    v_add_f32 v24, v80, v81
    v_add_f32 v25, v82, v83
    v_add_f32 v24, v24, v84
    v_add_f32 v25, v25, v85
    v_add_f32 v24, v24, v86
    v_add_f32 v25, v25, v87
    v_cvt_pk_bf16_f32 v88, v80, v81
    v_cvt_pk_bf16_f32 v89, v82, v83
    v_cvt_pk_bf16_f32 v90, v84, v85
    v_cvt_pk_bf16_f32 v91, v86, v87
    v_add_f32 v24, v24, v25
    v_fma_f32 v93, v93, v28, v24
    v_perm_b32 v16, v164, v160, s76
    v_perm_b32 v17, v172, v168, s76
    v_perm_b32 v18, v180, v176, s76
    v_perm_b32 v19, v188, v184, s76
    v_perm_b32 v20, v164, v160, s77
    v_perm_b32 v21, v172, v168, s77
    v_perm_b32 v22, v180, v176, s77
    v_perm_b32 v23, v188, v184, s77
    v_mfma_f32_16x16x32_bf16 v[32:35], v[16:19], v[88:91], v[32:35]
    v_perm_b32 v16, v165, v161, s76
    v_perm_b32 v17, v173, v169, s76
    v_perm_b32 v18, v181, v177, s76
    v_perm_b32 v19, v189, v185, s76
    v_mfma_f32_16x16x32_bf16 v[36:39], v[20:23], v[88:91], v[36:39]
    v_perm_b32 v20, v165, v161, s77
    v_perm_b32 v21, v173, v169, s77
    v_perm_b32 v22, v181, v177, s77
    v_perm_b32 v23, v189, v185, s77
    v_mfma_f32_16x16x32_bf16 v[40:43], v[16:19], v[88:91], v[40:43]
    v_perm_b32 v16, v166, v162, s76
    v_perm_b32 v17, v174, v170, s76
    v_perm_b32 v18, v182, v178, s76
    v_perm_b32 v19, v190, v186, s76
    v_mfma_f32_16x16x32_bf16 v[44:47], v[20:23], v[88:91], v[44:47]
    v_perm_b32 v20, v166, v162, s77
    v_perm_b32 v21, v174, v170, s77
    v_perm_b32 v22, v182, v178, s77
    v_perm_b32 v23, v190, v186, s77
    v_mfma_f32_16x16x32_bf16 v[48:51], v[16:19], v[88:91], v[48:51]
    v_perm_b32 v16, v167, v163, s76
    v_perm_b32 v17, v175, v171, s76
    v_perm_b32 v18, v183, v179, s76
    v_perm_b32 v19, v191, v187, s76
    v_mfma_f32_16x16x32_bf16 v[52:55], v[20:23], v[88:91], v[52:55]
    v_perm_b32 v20, v167, v163, s77
    v_perm_b32 v21, v175, v171, s77
    v_perm_b32 v22, v183, v179, s77
    v_perm_b32 v23, v191, v187, s77
    v_mfma_f32_16x16x32_bf16 v[56:59], v[16:19], v[88:91], v[56:59]
    s_nop 0
    v_mfma_f32_16x16x32_bf16 v[60:63], v[20:23], v[88:91], v[60:63]
    s_waitcnt vmcnt(8)
    v_readfirstlane_b32 s99, v95
    s_nop 0
    s_cmp_ge_u32 s99, 44
    s_cbranch_scc1 L_dend57
    s_sub_u32 s85, s99, 20
    s_lshr_b32 s86, s85, 1
    s_add_u32 s86, s86, 20
    s_lshl_b32 s86, s86, 16
    s_and_b32 s85, s85, 1
    s_lshl_b32 s85, s85, 12
    s_add_u32 s86, s86, s85
    s_lshl_b32 s85, s99, 16
    s_cmp_lt_u32 s99, 20
    s_cselect_b32 s99, s85, s86
    s_cselect_b32 s71, 0, 0xff7fffff
    s_cselect_b32 s85, 0, 0x40000000
    s_add_u32 s99, s99, s100
    v_add_u32 v14, s85, v2
    v_add_u32 v15, s85, v4
    buffer_load_dwordx4 v[96:99], v1, s[4:7], s99 offen offset:0 nt
    buffer_load_dwordx4 v[100:103], v1, s[4:7], s99 offen offset:64 nt
    buffer_load_dwordx4 v[104:107], v1, s[4:7], s99 offen offset:128 nt
    buffer_load_dwordx4 v[108:111], v1, s[4:7], s99 offen offset:192 nt
    buffer_load_dwordx4 v[112:115], v14, s[4:7], s99 offen offset:0 nt
    buffer_load_dwordx4 v[116:119], v14, s[4:7], s99 offen offset:64 nt
    buffer_load_dwordx4 v[120:123], v14, s[4:7], s99 offen offset:128 nt
    buffer_load_dwordx4 v[124:127], v14, s[4:7], s99 offen offset:192 nt
    v_mov_b32 v95, 1
    s_mov_b64 exec, 1
    buffer_atomic_add v95, off, s[28:31], s101 sc0
    s_mov_b64 exec, -1
    v_mov_b32 v84, s70
    v_mov_b32 v85, s70
    v_mov_b32 v86, s70
    v_mov_b32 v87, s70
    s_nop 0
    v_mfma_f32_16x16x32_bf16 v[80:83], v[192:195], v[64:67], 0
    v_mfma_f32_16x16x32_bf16 v[84:87], v[208:211], v[64:67], v[84:87]
    v_mfma_f32_16x16x32_bf16 v[80:83], v[196:199], v[68:71], v[80:83]
    v_mfma_f32_16x16x32_bf16 v[84:87], v[212:215], v[68:71], v[84:87]
    v_mfma_f32_16x16x32_bf16 v[80:83], v[200:203], v[72:75], v[80:83]
    v_mfma_f32_16x16x32_bf16 v[84:87], v[216:219], v[72:75], v[84:87]
    v_mfma_f32_16x16x32_bf16 v[80:83], v[204:207], v[76:79], v[80:83]
    v_mfma_f32_16x16x32_bf16 v[84:87], v[220:223], v[76:79], v[84:87]
    buffer_load_dwordx4 v[128:131], v3, s[8:11], s99 offen offset:0 nt
    buffer_load_dwordx4 v[132:135], v3, s[8:11], s99 offen offset:1024 nt
    buffer_load_dwordx4 v[136:139], v3, s[8:11], s99 offen offset:2048 nt
    buffer_load_dwordx4 v[140:143], v3, s[8:11], s99 offen offset:3072 nt
    buffer_load_dwordx4 v[144:147], v15, s[8:11], s99 offen offset:0 nt
    buffer_load_dwordx4 v[148:151], v15, s[8:11], s99 offen offset:1024 nt
    buffer_load_dwordx4 v[152:155], v15, s[8:11], s99 offen offset:2048 nt
    buffer_load_dwordx4 v[156:159], v15, s[8:11], s99 offen offset:3072 nt
    v_max3_f32 v24, v80, v81, v82
    v_max3_f32 v24, v24, v83, v84
    v_max3_f32 v24, v24, v85, v86
    v_max3_f32 v24, v24, v87, v92
    v_mov_b32 v25, v24
    s_nop 1
    v_permlane16_swap_b32 v24, v25
    v_max_f32 v24, v24, v25
    v_mov_b32 v25, v24
    s_nop 1
    v_permlane32_swap_b32 v24, v25
    v_max_f32 v24, v24, v25
    v_mul_f32 v26, s78, v24
    v_fma_f32 v28, v92, s78, -v26
    v_exp_f32 v28, v28
    v_mov_b32 v92, v24
    v_fma_f32 v80, v80, s78, -v26
    v_fma_f32 v81, v81, s78, -v26
    v_fma_f32 v82, v82, s78, -v26
    v_fma_f32 v83, v83, s78, -v26
    v_fma_f32 v84, v84, s78, -v26
    v_fma_f32 v85, v85, s78, -v26
    v_fma_f32 v86, v86, s78, -v26
    v_fma_f32 v87, v87, s78, -v26
    v_exp_f32 v80, v80
    v_exp_f32 v81, v81
    v_exp_f32 v82, v82
    v_exp_f32 v83, v83
    v_exp_f32 v84, v84
    v_exp_f32 v85, v85
    v_exp_f32 v86, v86
    v_exp_f32 v87, v87
    v_pk_mul_f32 v[32:33], v[32:33], v[28:29] op_sel_hi:[1,0]
    v_pk_mul_f32 v[34:35], v[34:35], v[28:29] op_sel_hi:[1,0]
    v_pk_mul_f32 v[36:37], v[36:37], v[28:29] op_sel_hi:[1,0]
    v_pk_mul_f32 v[38:39], v[38:39], v[28:29] op_sel_hi:[1,0]
    v_pk_mul_f32 v[40:41], v[40:41], v[28:29] op_sel_hi:[1,0]
    v_pk_mul_f32 v[42:43], v[42:43], v[28:29] op_sel_hi:[1,0]
    v_pk_mul_f32 v[44:45], v[44:45], v[28:29] op_sel_hi:[1,0]
    v_pk_mul_f32 v[46:47], v[46:47], v[28:29] op_sel_hi:[1,0]
    v_pk_mul_f32 v[48:49], v[48:49], v[28:29] op_sel_hi:[1,0]
    v_pk_mul_f32 v[50:51], v[50:51], v[28:29] op_sel_hi:[1,0]
    v_pk_mul_f32 v[52:53], v[52:53], v[28:29] op_sel_hi:[1,0]
    v_pk_mul_f32 v[54:55], v[54:55], v[28:29] op_sel_hi:[1,0]
    v_pk_mul_f32 v[56:57], v[56:57], v[28:29] op_sel_hi:[1,0]
    v_pk_mul_f32 v[58:59], v[58:59], v[28:29] op_sel_hi:[1,0]
    v_pk_mul_f32 v[60:61], v[60:61], v[28:29] op_sel_hi:[1,0]
    v_pk_mul_f32 v[62:63], v[62:63], v[28:29] op_sel_hi:[1,0]
    v_add_f32 v24, v80, v81
    v_add_f32 v25, v82, v83
    v_add_f32 v24, v24, v84
    v_add_f32 v25, v25, v85
    v_add_f32 v24, v24, v86
    v_add_f32 v25, v25, v87
    v_cvt_pk_bf16_f32 v88, v80, v81
    v_cvt_pk_bf16_f32 v89, v82, v83
    v_cvt_pk_bf16_f32 v90, v84, v85
    v_cvt_pk_bf16_f32 v91, v86, v87
    v_add_f32 v24, v24, v25
    v_fma_f32 v93, v93, v28, v24
    s_waitcnt vmcnt(17)
    v_perm_b32 v16, v228, v224, s76
    v_perm_b32 v17, v236, v232, s76
    v_perm_b32 v18, v244, v240, s76
    v_perm_b32 v19, v252, v248, s76
    v_perm_b32 v20, v228, v224, s77
    v_perm_b32 v21, v236, v232, s77
    v_perm_b32 v22, v244, v240, s77
    v_perm_b32 v23, v252, v248, s77
    v_mfma_f32_16x16x32_bf16 v[32:35], v[16:19], v[88:91], v[32:35]
    v_perm_b32 v16, v229, v225, s76
    v_perm_b32 v17, v237, v233, s76
    v_perm_b32 v18, v245, v241, s76
    v_perm_b32 v19, v253, v249, s76
    v_mfma_f32_16x16x32_bf16 v[36:39], v[20:23], v[88:91], v[36:39]
    v_perm_b32 v20, v229, v225, s77
    v_perm_b32 v21, v237, v233, s77
    v_perm_b32 v22, v245, v241, s77
    v_perm_b32 v23, v253, v249, s77
    v_mfma_f32_16x16x32_bf16 v[40:43], v[16:19], v[88:91], v[40:43]
    v_perm_b32 v16, v230, v226, s76
    v_perm_b32 v17, v238, v234, s76
    v_perm_b32 v18, v246, v242, s76
    v_perm_b32 v19, v254, v250, s76
    v_mfma_f32_16x16x32_bf16 v[44:47], v[20:23], v[88:91], v[44:47]
    v_perm_b32 v20, v230, v226, s77
    v_perm_b32 v21, v238, v234, s77
    v_perm_b32 v22, v246, v242, s77
    v_perm_b32 v23, v254, v250, s77
    v_mfma_f32_16x16x32_bf16 v[48:51], v[16:19], v[88:91], v[48:51]
    v_perm_b32 v16, v231, v227, s76
    v_perm_b32 v17, v239, v235, s76
    v_perm_b32 v18, v247, v243, s76
    v_perm_b32 v19, v255, v251, s76
    v_mfma_f32_16x16x32_bf16 v[52:55], v[20:23], v[88:91], v[52:55]
    v_perm_b32 v20, v231, v227, s77
    v_perm_b32 v21, v239, v235, s77
    v_perm_b32 v22, v247, v243, s77
    v_perm_b32 v23, v255, v251, s77
    v_mfma_f32_16x16x32_bf16 v[56:59], v[16:19], v[88:91], v[56:59]
    s_nop 0
    v_mfma_f32_16x16x32_bf16 v[60:63], v[20:23], v[88:91], v[60:63]
    s_waitcnt vmcnt(8)
    v_readfirstlane_b32 s99, v95
    s_nop 0
    s_cmp_ge_u32 s99, 44
    s_cbranch_scc1 L_dend58
    s_sub_u32 s85, s99, 20
    s_lshr_b32 s86, s85, 1
    s_add_u32 s86, s86, 20
    s_lshl_b32 s86, s86, 16
    s_and_b32 s85, s85, 1
    s_lshl_b32 s85, s85, 12
    s_add_u32 s86, s86, s85
    s_lshl_b32 s85, s99, 16
    s_cmp_lt_u32 s99, 20
    s_cselect_b32 s99, s85, s86
    s_cselect_b32 s75, 0, 0xff7fffff
    s_cselect_b32 s85, 0, 0x40000000
    s_add_u32 s99, s99, s100
    v_add_u32 v14, s85, v2
    v_add_u32 v15, s85, v4
    buffer_load_dwordx4 v[160:163], v1, s[4:7], s99 offen offset:0 nt
    buffer_load_dwordx4 v[164:167], v1, s[4:7], s99 offen offset:64 nt
    buffer_load_dwordx4 v[168:171], v1, s[4:7], s99 offen offset:128 nt
    buffer_load_dwordx4 v[172:175], v1, s[4:7], s99 offen offset:192 nt
    buffer_load_dwordx4 v[176:179], v14, s[4:7], s99 offen offset:0 nt
    buffer_load_dwordx4 v[180:183], v14, s[4:7], s99 offen offset:64 nt
    buffer_load_dwordx4 v[184:187], v14, s[4:7], s99 offen offset:128 nt
    buffer_load_dwordx4 v[188:191], v14, s[4:7], s99 offen offset:192 nt
    v_mov_b32 v84, s71
    v_mov_b32 v85, s71
    v_mov_b32 v86, s71
    v_mov_b32 v87, s71
    s_nop 0
    v_mfma_f32_16x16x32_bf16 v[80:83], v[96:99], v[64:67], 0
    v_mfma_f32_16x16x32_bf16 v[84:87], v[112:115], v[64:67], v[84:87]
    v_mfma_f32_16x16x32_bf16 v[80:83], v[100:103], v[68:71], v[80:83]
    v_mfma_f32_16x16x32_bf16 v[84:87], v[116:119], v[68:71], v[84:87]
    v_mfma_f32_16x16x32_bf16 v[80:83], v[104:107], v[72:75], v[80:83]
    v_mfma_f32_16x16x32_bf16 v[84:87], v[120:123], v[72:75], v[84:87]
    v_mfma_f32_16x16x32_bf16 v[80:83], v[108:111], v[76:79], v[80:83]
    v_mfma_f32_16x16x32_bf16 v[84:87], v[124:127], v[76:79], v[84:87]
    buffer_load_dwordx4 v[192:195], v3, s[8:11], s99 offen offset:0 nt
    buffer_load_dwordx4 v[196:199], v3, s[8:11], s99 offen offset:1024 nt
    buffer_load_dwordx4 v[200:203], v3, s[8:11], s99 offen offset:2048 nt
    buffer_load_dwordx4 v[204:207], v3, s[8:11], s99 offen offset:3072 nt
    buffer_load_dwordx4 v[208:211], v15, s[8:11], s99 offen offset:0 nt
    buffer_load_dwordx4 v[212:215], v15, s[8:11], s99 offen offset:1024 nt
    buffer_load_dwordx4 v[216:219], v15, s[8:11], s99 offen offset:2048 nt
    buffer_load_dwordx4 v[220:223], v15, s[8:11], s99 offen offset:3072 nt
    v_max3_f32 v24, v80, v81, v82
    v_max3_f32 v24, v24, v83, v84
    v_max3_f32 v24, v24, v85, v86
    v_max3_f32 v24, v24, v87, v92
    v_mov_b32 v25, v24
    s_nop 1
    v_permlane16_swap_b32 v24, v25
    v_max_f32 v24, v24, v25
    v_mov_b32 v25, v24
    s_nop 1
    v_permlane32_swap_b32 v24, v25
    v_max_f32 v24, v24, v25
    v_mul_f32 v26, s78, v24
    v_fma_f32 v28, v92, s78, -v26
    v_exp_f32 v28, v28
    v_mov_b32 v92, v24
    v_fma_f32 v80, v80, s78, -v26
    v_fma_f32 v81, v81, s78, -v26
    v_fma_f32 v82, v82, s78, -v26
    v_fma_f32 v83, v83, s78, -v26
    v_fma_f32 v84, v84, s78, -v26
    v_fma_f32 v85, v85, s78, -v26
    v_fma_f32 v86, v86, s78, -v26
    v_fma_f32 v87, v87, s78, -v26
    v_exp_f32 v80, v80
    v_exp_f32 v81, v81
    v_exp_f32 v82, v82
    v_exp_f32 v83, v83
    v_exp_f32 v84, v84
    v_exp_f32 v85, v85
    v_exp_f32 v86, v86
    v_exp_f32 v87, v87
    v_pk_mul_f32 v[32:33], v[32:33], v[28:29] op_sel_hi:[1,0]
    v_pk_mul_f32 v[34:35], v[34:35], v[28:29] op_sel_hi:[1,0]
    v_pk_mul_f32 v[36:37], v[36:37], v[28:29] op_sel_hi:[1,0]
    v_pk_mul_f32 v[38:39], v[38:39], v[28:29] op_sel_hi:[1,0]
    v_pk_mul_f32 v[40:41], v[40:41], v[28:29] op_sel_hi:[1,0]
    v_pk_mul_f32 v[42:43], v[42:43], v[28:29] op_sel_hi:[1,0]
    v_pk_mul_f32 v[44:45], v[44:45], v[28:29] op_sel_hi:[1,0]
    v_pk_mul_f32 v[46:47], v[46:47], v[28:29] op_sel_hi:[1,0]
    v_pk_mul_f32 v[48:49], v[48:49], v[28:29] op_sel_hi:[1,0]
    v_pk_mul_f32 v[50:51], v[50:51], v[28:29] op_sel_hi:[1,0]
    v_pk_mul_f32 v[52:53], v[52:53], v[28:29] op_sel_hi:[1,0]
    v_pk_mul_f32 v[54:55], v[54:55], v[28:29] op_sel_hi:[1,0]
    v_pk_mul_f32 v[56:57], v[56:57], v[28:29] op_sel_hi:[1,0]
    v_pk_mul_f32 v[58:59], v[58:59], v[28:29] op_sel_hi:[1,0]
    v_pk_mul_f32 v[60:61], v[60:61], v[28:29] op_sel_hi:[1,0]
    v_pk_mul_f32 v[62:63], v[62:63], v[28:29] op_sel_hi:[1,0]
    v_add_f32 v24, v80, v81
    v_add_f32 v25, v82, v83
    v_add_f32 v24, v24, v84
    v_add_f32 v25, v25, v85
    v_add_f32 v24, v24, v86
    v_add_f32 v25, v25, v87
    v_cvt_pk_bf16_f32 v88, v80, v81
    v_cvt_pk_bf16_f32 v89, v82, v83
    v_cvt_pk_bf16_f32 v90, v84, v85
    v_cvt_pk_bf16_f32 v91, v86, v87
    v_add_f32 v24, v24, v25
    v_fma_f32 v93, v93, v28, v24
    s_waitcnt vmcnt(16)
    v_perm_b32 v16, v132, v128, s76
    v_perm_b32 v17, v140, v136, s76
    v_perm_b32 v18, v148, v144, s76
    v_perm_b32 v19, v156, v152, s76
    v_perm_b32 v20, v132, v128, s77
    v_perm_b32 v21, v140, v136, s77
    v_perm_b32 v22, v148, v144, s77
    v_perm_b32 v23, v156, v152, s77
    v_mfma_f32_16x16x32_bf16 v[32:35], v[16:19], v[88:91], v[32:35]
    v_perm_b32 v16, v133, v129, s76
    v_perm_b32 v17, v141, v137, s76
    v_perm_b32 v18, v149, v145, s76
    v_perm_b32 v19, v157, v153, s76
    v_mfma_f32_16x16x32_bf16 v[36:39], v[20:23], v[88:91], v[36:39]
    v_perm_b32 v20, v133, v129, s77
    v_perm_b32 v21, v141, v137, s77
    v_perm_b32 v22, v149, v145, s77
    v_perm_b32 v23, v157, v153, s77
    v_mfma_f32_16x16x32_bf16 v[40:43], v[16:19], v[88:91], v[40:43]
    v_perm_b32 v16, v134, v130, s76
    v_perm_b32 v17, v142, v138, s76
    v_perm_b32 v18, v150, v146, s76
    v_perm_b32 v19, v158, v154, s76
    v_mfma_f32_16x16x32_bf16 v[44:47], v[20:23], v[88:91], v[44:47]
    v_perm_b32 v20, v134, v130, s77
    v_perm_b32 v21, v142, v138, s77
    v_perm_b32 v22, v150, v146, s77
    v_perm_b32 v23, v158, v154, s77
    v_mfma_f32_16x16x32_bf16 v[48:51], v[16:19], v[88:91], v[48:51]
    v_perm_b32 v16, v135, v131, s76
    v_perm_b32 v17, v143, v139, s76
    v_perm_b32 v18, v151, v147, s76
    v_perm_b32 v19, v159, v155, s76
    v_mfma_f32_16x16x32_bf16 v[52:55], v[20:23], v[88:91], v[52:55]
    v_perm_b32 v20, v135, v131, s77
    v_perm_b32 v21, v143, v139, s77
    v_perm_b32 v22, v151, v147, s77
    v_perm_b32 v23, v159, v155, s77
    v_mfma_f32_16x16x32_bf16 v[56:59], v[16:19], v[88:91], v[56:59]
    s_nop 0
    v_mfma_f32_16x16x32_bf16 v[60:63], v[20:23], v[88:91], v[60:63]
    s_mov_b32 s101, 255
    s_add_u32 s85, s91, 0
    buffer_load_dwordx4 v[224:227], v13, s[36:39], s85 offen offset:0 nt
    s_add_u32 s85, s91, 16384
    buffer_load_dwordx4 v[228:231], v13, s[36:39], s85 offen offset:0 nt
    s_add_u32 s85, s91, 32768
    buffer_load_dwordx4 v[232:235], v13, s[36:39], s85 offen offset:0 nt
    s_add_u32 s85, s91, 49152
    buffer_load_dwordx4 v[236:239], v13, s[36:39], s85 offen offset:0 nt
    s_add_u32 s85, s91, 0
    buffer_load_dwordx4 v[240:243], v13, s[36:39], s85 offen offset:2048 nt
    s_add_u32 s85, s91, 16384
    buffer_load_dwordx4 v[244:247], v13, s[36:39], s85 offen offset:2048 nt
    s_add_u32 s85, s91, 32768
    buffer_load_dwordx4 v[248:251], v13, s[36:39], s85 offen offset:2048 nt
    s_add_u32 s85, s91, 49152
    buffer_load_dwordx4 v[252:255], v13, s[36:39], s85 offen offset:2048 nt
    s_mov_b32 s73, s101
    v_bfe_u32 v26, v0, 2, 1
    v_lshlrev_b32 v2, 6, v26
    v_lshrrev_b32 v26, 4, v0
    v_lshl_add_u32 v2, v26, 4, v2
    v_bfe_u32 v26, v0, 4, 1
    v_lshlrev_b32 v4, 19, v26
    v_bfe_u32 v26, v0, 3, 1
    v_lshl_add_u32 v4, v26, 14, v4
    v_and_b32 v26, 7, v0
    v_lshl_add_u32 v4, v26, 4, v4
    v_lshrrev_b32 v26, 5, v0
    v_lshl_add_u32 v4, v26, 15, v4
    s_and_b32 s98, s3, 3
    s_lshl_b32 s98, s98, 16
    s_lshl_b32 s86, s90, 7
    s_add_u32 s98, s98, s86
    s_add_u32 s98, s98, 0x600000
    s_mov_b32 s100, 0
    s_mov_b32 s101, -1
    s_mov_b32 s4, 0x7060500
    s_mov_b32 s5, 0x7060501
    s_mov_b32 s6, 0x7060502
    s_mov_b32 s7, 0x7060503
    s_waitcnt vmcnt(16)
    v_mov_b32 v84, s75
    v_mov_b32 v85, s75
    v_mov_b32 v86, s75
    v_mov_b32 v87, s75
    s_nop 0
    v_mfma_f32_16x16x32_bf16 v[80:83], v[160:163], v[64:67], 0
    v_mfma_f32_16x16x32_bf16 v[84:87], v[176:179], v[64:67], v[84:87]
    v_mfma_f32_16x16x32_bf16 v[80:83], v[164:167], v[68:71], v[80:83]
    v_mfma_f32_16x16x32_bf16 v[84:87], v[180:183], v[68:71], v[84:87]
    v_mfma_f32_16x16x32_bf16 v[80:83], v[168:171], v[72:75], v[80:83]
    v_mfma_f32_16x16x32_bf16 v[84:87], v[184:187], v[72:75], v[84:87]
    v_mfma_f32_16x16x32_bf16 v[80:83], v[172:175], v[76:79], v[80:83]
    v_mfma_f32_16x16x32_bf16 v[84:87], v[188:191], v[76:79], v[84:87]
    v_mov_b32 v25, s73
    s_mov_b64 exec, 1
    ds_max_u32 v10, v25 offset:28
    s_mov_b64 exec, -1
    s_nop 7
    v_max3_f32 v24, v80, v81, v82
    v_max3_f32 v24, v24, v83, v84
    v_max3_f32 v24, v24, v85, v86
    v_max3_f32 v24, v24, v87, v92
    v_mov_b32 v25, v24
    s_nop 1
    v_permlane16_swap_b32 v24, v25
    v_max_f32 v24, v24, v25
    v_mov_b32 v25, v24
    s_nop 1
    v_permlane32_swap_b32 v24, v25
    v_max_f32 v24, v24, v25
    s_setprio 2
    v_mul_f32 v26, s78, v24
    v_fma_f32 v28, v92, s78, -v26
    v_exp_f32 v28, v28
    v_mov_b32 v92, v24
    v_fma_f32 v80, v80, s78, -v26
    v_fma_f32 v81, v81, s78, -v26
    v_fma_f32 v82, v82, s78, -v26
    v_fma_f32 v83, v83, s78, -v26
    v_fma_f32 v84, v84, s78, -v26
    v_fma_f32 v85, v85, s78, -v26
    v_fma_f32 v86, v86, s78, -v26
    v_fma_f32 v87, v87, s78, -v26
    v_exp_f32 v80, v80
    v_exp_f32 v81, v81
    v_exp_f32 v82, v82
    v_exp_f32 v83, v83
    v_exp_f32 v84, v84
    v_exp_f32 v85, v85
    v_exp_f32 v86, v86
    v_exp_f32 v87, v87
    v_pk_mul_f32 v[32:33], v[32:33], v[28:29] op_sel_hi:[1,0]
    v_pk_mul_f32 v[34:35], v[34:35], v[28:29] op_sel_hi:[1,0]
    v_pk_mul_f32 v[36:37], v[36:37], v[28:29] op_sel_hi:[1,0]
    v_pk_mul_f32 v[38:39], v[38:39], v[28:29] op_sel_hi:[1,0]
    v_pk_mul_f32 v[40:41], v[40:41], v[28:29] op_sel_hi:[1,0]
    v_pk_mul_f32 v[42:43], v[42:43], v[28:29] op_sel_hi:[1,0]
    v_pk_mul_f32 v[44:45], v[44:45], v[28:29] op_sel_hi:[1,0]
    v_pk_mul_f32 v[46:47], v[46:47], v[28:29] op_sel_hi:[1,0]
    v_pk_mul_f32 v[48:49], v[48:49], v[28:29] op_sel_hi:[1,0]
    v_pk_mul_f32 v[50:51], v[50:51], v[28:29] op_sel_hi:[1,0]
    v_pk_mul_f32 v[52:53], v[52:53], v[28:29] op_sel_hi:[1,0]
    v_pk_mul_f32 v[54:55], v[54:55], v[28:29] op_sel_hi:[1,0]
    v_pk_mul_f32 v[56:57], v[56:57], v[28:29] op_sel_hi:[1,0]
    v_pk_mul_f32 v[58:59], v[58:59], v[28:29] op_sel_hi:[1,0]
    v_pk_mul_f32 v[60:61], v[60:61], v[28:29] op_sel_hi:[1,0]
    v_pk_mul_f32 v[62:63], v[62:63], v[28:29] op_sel_hi:[1,0]
    v_add_f32 v24, v80, v81
    v_add_f32 v25, v82, v83
    v_add_f32 v24, v24, v84
    v_add_f32 v25, v25, v85
    v_add_f32 v24, v24, v86
    v_add_f32 v25, v25, v87
    v_cvt_pk_bf16_f32 v88, v80, v81
    v_cvt_pk_bf16_f32 v89, v82, v83
    v_cvt_pk_bf16_f32 v90, v84, v85
    v_cvt_pk_bf16_f32 v91, v86, v87
    v_add_f32 v24, v24, v25
    v_fma_f32 v93, v93, v28, v24
    v_mov_b32 v25, v93
    s_nop 1
    v_permlane16_swap_b32 v93, v25
    v_add_f32 v93, v93, v25
    v_mov_b32 v25, v93
    s_nop 1
    v_permlane32_swap_b32 v93, v25
    v_add_f32 v93, v93, v25
    s_mov_b64 exec, 0xff
    ds_write_b32 v6, v92 offset:256
    ds_write_b32 v6, v93 offset:768
    s_mov_b64 exec, -1
    v_mov_b32 v115, s79
    s_waitcnt vmcnt(10)
    s_add_u32 s85, s91, 0
    buffer_load_dwordx4 v[160:163], v13, s[24:27], s85 offen offset:0 nt
    s_add_u32 s85, s91, 16384
    buffer_load_dwordx4 v[164:167], v13, s[24:27], s85 offen offset:0 nt
    s_add_u32 s85, s91, 32768
    buffer_load_dwordx4 v[168:171], v13, s[24:27], s85 offen offset:0 nt
    s_add_u32 s85, s91, 49152
    buffer_load_dwordx4 v[172:175], v13, s[24:27], s85 offen offset:0 nt
    v_perm_b32 v128, v196, v192, s76
    v_perm_b32 v132, v196, v192, s77
    v_perm_b32 v136, v197, v193, s76
    v_perm_b32 v140, v197, v193, s77
    v_perm_b32 v144, v198, v194, s76
    v_perm_b32 v148, v198, v194, s77
    v_perm_b32 v152, v199, v195, s76
    v_perm_b32 v156, v199, v195, s77
    v_perm_b32 v129, v204, v200, s76
    v_perm_b32 v133, v204, v200, s77
    v_perm_b32 v137, v205, v201, s76
    v_perm_b32 v141, v205, v201, s77
    v_perm_b32 v145, v206, v202, s76
    v_perm_b32 v149, v206, v202, s77
    v_perm_b32 v153, v207, v203, s76
    v_perm_b32 v157, v207, v203, s77
    v_perm_b32 v130, v212, v208, s76
    v_perm_b32 v134, v212, v208, s77
    v_perm_b32 v138, v213, v209, s76
    v_perm_b32 v142, v213, v209, s77
    v_perm_b32 v146, v214, v210, s76
    v_perm_b32 v150, v214, v210, s77
    v_perm_b32 v154, v215, v211, s76
    v_perm_b32 v158, v215, v211, s77
    s_waitcnt vmcnt(12)
    v_perm_b32 v131, v220, v216, s76
    v_perm_b32 v135, v220, v216, s77
    v_perm_b32 v139, v221, v217, s76
    v_mfma_f32_16x16x32_bf16 v[32:35], v[128:131], v[88:91], v[32:35]
    v_perm_b32 v143, v221, v217, s77
    v_mfma_f32_16x16x32_bf16 v[36:39], v[132:135], v[88:91], v[36:39]
    v_perm_b32 v147, v222, v218, s76
    v_mfma_f32_16x16x32_bf16 v[40:43], v[136:139], v[88:91], v[40:43]
    v_perm_b32 v151, v222, v218, s77
    v_mfma_f32_16x16x32_bf16 v[44:47], v[140:143], v[88:91], v[44:47]
    v_perm_b32 v155, v223, v219, s76
    v_mfma_f32_16x16x32_bf16 v[48:51], v[144:147], v[88:91], v[48:51]
    v_perm_b32 v159, v223, v219, s77
    v_mfma_f32_16x16x32_bf16 v[52:55], v[148:151], v[88:91], v[52:55]
    s_nop 0
    v_mfma_f32_16x16x32_bf16 v[56:59], v[152:155], v[88:91], v[56:59]
    v_mfma_f32_16x16x32_bf16 v[60:63], v[156:159], v[88:91], v[60:63]
    s_mov_b32 exec_lo, 0x00ff00ff
    s_mov_b32 exec_hi, 0x00ff00ff
    ds_write_b128 v5, v[32:35] offset:33792
    ds_write_b128 v5, v[36:39] offset:33808
    ds_write_b128 v5, v[40:43] offset:33824
    ds_write_b128 v5, v[44:47] offset:33840
    ds_write_b128 v5, v[48:51] offset:33856
    ds_write_b128 v5, v[52:55] offset:33872
    ds_write_b128 v5, v[56:59] offset:33888
    ds_write_b128 v5, v[60:63] offset:33904
    s_mov_b64 exec, -1
    v_and_b32 v112, 1, v0
    v_cmp_eq_u32 vcc, 1, v112
    s_setprio 0
    s_waitcnt lgkmcnt(0)
    s_barrier
    ds_read_b32 v96, v9 offset:256
    ds_read_b128 v[100:103], v9 offset:272
    ds_read_b128 v[128:131], v8 offset:33792
    ds_read_b128 v[132:135], v8 offset:50688
    ds_read_b128 v[136:139], v8 offset:54912
    ds_read_b128 v[140:143], v8 offset:59136
    ds_read_b128 v[144:147], v8 offset:63360
    ds_read_b32 v104, v9 offset:768
    ds_read_b128 v[108:111], v9 offset:784
    s_waitcnt lgkmcnt(7)
    v_max3_f32 v114, v96, v100, v101
    v_max3_f32 v114, v114, v102, v103
    v_mul_f32 v26, s78, v114
    v_fma_f32 v96, v96, s78, -v26
    v_fma_f32 v100, v100, s78, -v26
    v_fma_f32 v101, v101, s78, -v26
    v_fma_f32 v102, v102, s78, -v26
    v_fma_f32 v103, v103, s78, -v26
    v_exp_f32 v96, v96
    v_exp_f32 v100, v100
    v_exp_f32 v101, v101
    v_exp_f32 v102, v102
    v_exp_f32 v103, v103
    s_waitcnt lgkmcnt(2)
    v_pk_mul_f32 v[116:117], v[128:129], v[96:97] op_sel:[0,0] op_sel_hi:[1,0]
    v_pk_mul_f32 v[118:119], v[130:131], v[96:97] op_sel:[0,0] op_sel_hi:[1,0]
    v_pk_fma_f32 v[116:117], v[132:133], v[100:101], v[116:117] op_sel:[0,0,0] op_sel_hi:[1,0,1]
    v_pk_fma_f32 v[118:119], v[134:135], v[100:101], v[118:119] op_sel:[0,0,0] op_sel_hi:[1,0,1]
    v_pk_fma_f32 v[116:117], v[136:137], v[100:101], v[116:117] op_sel:[0,1,0] op_sel_hi:[1,1,1]
    v_pk_fma_f32 v[118:119], v[138:139], v[100:101], v[118:119] op_sel:[0,1,0] op_sel_hi:[1,1,1]
    v_pk_fma_f32 v[116:117], v[140:141], v[102:103], v[116:117] op_sel:[0,0,0] op_sel_hi:[1,0,1]
    v_pk_fma_f32 v[118:119], v[142:143], v[102:103], v[118:119] op_sel:[0,0,0] op_sel_hi:[1,0,1]
    v_pk_fma_f32 v[116:117], v[144:145], v[102:103], v[116:117] op_sel:[0,1,0] op_sel_hi:[1,1,1]
    v_pk_fma_f32 v[118:119], v[146:147], v[102:103], v[118:119] op_sel:[0,1,0] op_sel_hi:[1,1,1]
    s_waitcnt lgkmcnt(0)
    v_mul_f32 v97, v96, v104
    v_fmac_f32 v97, v100, v108
    v_fmac_f32 v97, v101, v109
    v_fmac_f32 v97, v102, v110
    v_fmac_f32 v97, v103, v111
    v_cvt_pk_bf16_f32 v112, v116, v117
    v_cvt_pk_bf16_f32 v113, v118, v119
    v_cndmask_b32 v114, v114, v97, vcc
    s_mov_b32 exec_hi, 0
    buffer_store_dwordx4 v[112:115], v12, s[28:31], s92 offen sc1
    s_mov_b32 exec_hi, -1
    s_add_u32 s85, s91, 0
    buffer_load_dwordx4 v[176:179], v13, s[24:27], s85 offen offset:2048 nt
    s_add_u32 s85, s91, 16384
    buffer_load_dwordx4 v[180:183], v13, s[24:27], s85 offen offset:2048 nt
    s_add_u32 s85, s91, 32768
    buffer_load_dwordx4 v[184:187], v13, s[24:27], s85 offen offset:2048 nt
    s_add_u32 s85, s91, 49152
    buffer_load_dwordx4 v[188:191], v13, s[24:27], s85 offen offset:2048 nt
    s_setprio 2
    v_mov_b32 v84, s79
    s_waitcnt vmcnt(9)
    v_perm_b32 v128, v228, v224, s76
    v_perm_b32 v129, v236, v232, s76
    v_perm_b32 v130, v244, v240, s76
    v_perm_b32 v131, v252, v248, s76
    v_perm_b32 v132, v228, v224, s77
    v_perm_b32 v133, v236, v232, s77
    v_perm_b32 v134, v244, v240, s77
    v_perm_b32 v135, v252, v248, s77
    v_perm_b32 v136, v229, v225, s76
    v_perm_b32 v137, v237, v233, s76
    v_perm_b32 v138, v245, v241, s76
    v_perm_b32 v139, v253, v249, s76
    v_perm_b32 v140, v229, v225, s77
    v_perm_b32 v141, v237, v233, s77
    v_perm_b32 v142, v245, v241, s77
    v_perm_b32 v143, v253, v249, s77
    v_perm_b32 v144, v230, v226, s76
    v_perm_b32 v145, v238, v234, s76
    v_perm_b32 v146, v246, v242, s76
    v_perm_b32 v147, v254, v250, s76
    v_perm_b32 v148, v230, v226, s77
    v_perm_b32 v149, v238, v234, s77
    v_perm_b32 v150, v246, v242, s77
    v_perm_b32 v151, v254, v250, s77
    v_perm_b32 v152, v231, v227, s76
    v_perm_b32 v153, v239, v235, s76
    v_perm_b32 v154, v247, v243, s76
    v_perm_b32 v155, v255, v251, s76
    v_perm_b32 v156, v231, v227, s77
    v_perm_b32 v157, v239, v235, s77
    v_perm_b32 v158, v247, v243, s77
    v_perm_b32 v159, v255, v251, s77
    s_waitcnt vmcnt(0)
    v_perm_b32 v192, v164, v160, s76
    v_perm_b32 v193, v172, v168, s76
    v_perm_b32 v194, v180, v176, s76
    v_perm_b32 v195, v188, v184, s76
    v_perm_b32 v196, v164, v160, s77
    v_perm_b32 v197, v172, v168, s77
    v_perm_b32 v198, v180, v176, s77
    v_perm_b32 v199, v188, v184, s77
    v_perm_b32 v200, v165, v161, s76
    v_perm_b32 v201, v173, v169, s76
    v_perm_b32 v202, v181, v177, s76
    v_perm_b32 v203, v189, v185, s76
    v_perm_b32 v204, v165, v161, s77
    v_perm_b32 v205, v173, v169, s77
    v_perm_b32 v206, v181, v177, s77
    v_perm_b32 v207, v189, v185, s77
    v_perm_b32 v208, v166, v162, s76
    v_perm_b32 v209, v174, v170, s76
    v_perm_b32 v210, v182, v178, s76
    v_perm_b32 v211, v190, v186, s76
    v_perm_b32 v212, v166, v162, s77
    v_perm_b32 v213, v174, v170, s77
    v_perm_b32 v214, v182, v178, s77
    v_perm_b32 v215, v190, v186, s77
    v_perm_b32 v216, v167, v163, s76
    v_perm_b32 v217, v175, v171, s76
    v_perm_b32 v218, v183, v179, s76
    v_perm_b32 v219, v191, v187, s76
    v_perm_b32 v220, v167, v163, s77
    v_perm_b32 v221, v175, v171, s77
    v_perm_b32 v222, v183, v179, s77
    v_perm_b32 v223, v191, v187, s77
    s_mov_b32 s89, 0
L_ls59:
    ds_read_b32 v31, v10 offset:16
    s_waitcnt lgkmcnt(0)
    v_readfirstlane_b32 s88, v31
    s_add_u32 s89, s89, 1
    s_cmp_eq_u32 s88, 2
    s_cbranch_scc1 L_lsok60
    s_cmp_gt_u32 s89, 1000000
    s_cbranch_scc1 L_lsok60
    s_sleep 1
    s_branch L_ls59
L_lsok60:
    ds_read_b128 v[72:75], v2 offset:1024
    s_waitcnt lgkmcnt(0)
    v_mfma_f32_16x16x32_bf16 v[32:35], v[72:75], v[128:131], 0
    v_mfma_f32_16x16x32_bf16 v[36:39], v[72:75], v[132:135], 0
    v_mfma_f32_16x16x32_bf16 v[40:43], v[72:75], v[136:139], 0
    v_mfma_f32_16x16x32_bf16 v[44:47], v[72:75], v[140:143], 0
    v_mfma_f32_16x16x32_bf16 v[48:51], v[72:75], v[144:147], 0
    v_mfma_f32_16x16x32_bf16 v[52:55], v[72:75], v[148:151], 0
    v_mfma_f32_16x16x32_bf16 v[56:59], v[72:75], v[152:155], 0
    v_mfma_f32_16x16x32_bf16 v[60:63], v[72:75], v[156:159], 0
    s_barrier
    ds_read_b128 v[76:79], v2 offset:1152
    s_waitcnt lgkmcnt(0)
    v_mfma_f32_16x16x32_bf16 v[32:35], v[76:79], v[192:195], v[32:35]
    v_mfma_f32_16x16x32_bf16 v[48:51], v[76:79], v[208:211], v[48:51]
    v_mfma_f32_16x16x32_bf16 v[36:39], v[76:79], v[196:199], v[36:39]
    v_mfma_f32_16x16x32_bf16 v[52:55], v[76:79], v[212:215], v[52:55]
    v_mfma_f32_16x16x32_bf16 v[40:43], v[76:79], v[200:203], v[40:43]
    v_mfma_f32_16x16x32_bf16 v[56:59], v[76:79], v[216:219], v[56:59]
    v_mfma_f32_16x16x32_bf16 v[44:47], v[76:79], v[204:207], v[44:47]
    v_mfma_f32_16x16x32_bf16 v[60:63], v[76:79], v[220:223], v[60:63]
    s_nop 4
    v_cndmask_b32 v80, v32, v48, s[100:101]
    v_cndmask_b32 v81, v36, v52, s[100:101]
    v_cndmask_b32 v82, v40, v56, s[100:101]
    v_cndmask_b32 v83, v44, v60, s[100:101]
    v_perm_b32 v80, v80, v84, s4
    v_perm_b32 v81, v81, v84, s5
    v_perm_b32 v82, v82, v84, s6
    v_perm_b32 v83, v83, v84, s7
    buffer_store_dwordx4 v[80:83], v4, s[28:31], s98 offen sc1
    s_endpgm
L_dend56:
    s_add_u32 s101, s99, 0
    s_add_u32 s85, s91, 0
    buffer_load_dwordx4 v[192:195], v13, s[36:39], s85 offen offset:0 nt
    s_add_u32 s85, s91, 16384
    buffer_load_dwordx4 v[196:199], v13, s[36:39], s85 offen offset:0 nt
    s_add_u32 s85, s91, 32768
    buffer_load_dwordx4 v[200:203], v13, s[36:39], s85 offen offset:0 nt
    s_add_u32 s85, s91, 49152
    buffer_load_dwordx4 v[204:207], v13, s[36:39], s85 offen offset:0 nt
    s_add_u32 s85, s91, 0
    buffer_load_dwordx4 v[208:211], v13, s[36:39], s85 offen offset:2048 nt
    s_add_u32 s85, s91, 16384
    buffer_load_dwordx4 v[212:215], v13, s[36:39], s85 offen offset:2048 nt
    s_add_u32 s85, s91, 32768
    buffer_load_dwordx4 v[216:219], v13, s[36:39], s85 offen offset:2048 nt
    s_add_u32 s85, s91, 49152
    buffer_load_dwordx4 v[220:223], v13, s[36:39], s85 offen offset:2048 nt
    s_mov_b32 s73, s101
    v_bfe_u32 v26, v0, 2, 1
    v_lshlrev_b32 v2, 6, v26
    v_lshrrev_b32 v26, 4, v0
    v_lshl_add_u32 v2, v26, 4, v2
    v_bfe_u32 v26, v0, 4, 1
    v_lshlrev_b32 v4, 19, v26
    v_bfe_u32 v26, v0, 3, 1
    v_lshl_add_u32 v4, v26, 14, v4
    v_and_b32 v26, 7, v0
    v_lshl_add_u32 v4, v26, 4, v4
    v_lshrrev_b32 v26, 5, v0
    v_lshl_add_u32 v4, v26, 15, v4
    s_and_b32 s98, s3, 3
    s_lshl_b32 s98, s98, 16
    s_lshl_b32 s86, s90, 7
    s_add_u32 s98, s98, s86
    s_add_u32 s98, s98, 0x600000
    s_mov_b32 s100, 0
    s_mov_b32 s101, -1
    s_mov_b32 s4, 0x7060500
    s_mov_b32 s5, 0x7060501
    s_mov_b32 s6, 0x7060502
    s_mov_b32 s7, 0x7060503
    v_mfma_f32_16x16x32_bf16 v[80:83], v[128:131], v[64:67], 0
    v_mfma_f32_16x16x32_bf16 v[84:87], v[144:147], v[64:67], 0
    v_mfma_f32_16x16x32_bf16 v[80:83], v[132:135], v[68:71], v[80:83]
    v_mfma_f32_16x16x32_bf16 v[84:87], v[148:151], v[68:71], v[84:87]
    v_mfma_f32_16x16x32_bf16 v[80:83], v[136:139], v[72:75], v[80:83]
    v_mfma_f32_16x16x32_bf16 v[84:87], v[152:155], v[72:75], v[84:87]
    v_mfma_f32_16x16x32_bf16 v[80:83], v[140:143], v[76:79], v[80:83]
    v_mfma_f32_16x16x32_bf16 v[84:87], v[156:159], v[76:79], v[84:87]
    v_mov_b32 v25, s73
    s_mov_b64 exec, 1
    ds_max_u32 v10, v25 offset:28
    s_mov_b64 exec, -1
    s_nop 7
    v_max3_f32 v24, v80, v81, v82
    v_max3_f32 v24, v24, v83, v84
    v_max3_f32 v24, v24, v85, v86
    v_max3_f32 v24, v24, v87, v92
    v_mov_b32 v25, v24
    s_nop 1
    v_permlane16_swap_b32 v24, v25
    v_max_f32 v24, v24, v25
    v_mov_b32 v25, v24
    s_nop 1
    v_permlane32_swap_b32 v24, v25
    v_max_f32 v24, v24, v25
    s_setprio 2
    v_mul_f32 v26, s78, v24
    v_fma_f32 v28, v92, s78, -v26
    v_exp_f32 v28, v28
    v_mov_b32 v92, v24
    v_fma_f32 v80, v80, s78, -v26
    v_fma_f32 v81, v81, s78, -v26
    v_fma_f32 v82, v82, s78, -v26
    v_fma_f32 v83, v83, s78, -v26
    v_fma_f32 v84, v84, s78, -v26
    v_fma_f32 v85, v85, s78, -v26
    v_fma_f32 v86, v86, s78, -v26
    v_fma_f32 v87, v87, s78, -v26
    v_exp_f32 v80, v80
    v_exp_f32 v81, v81
    v_exp_f32 v82, v82
    v_exp_f32 v83, v83
    v_exp_f32 v84, v84
    v_exp_f32 v85, v85
    v_exp_f32 v86, v86
    v_exp_f32 v87, v87
    v_pk_mul_f32 v[32:33], v[32:33], v[28:29] op_sel_hi:[1,0]
    v_pk_mul_f32 v[34:35], v[34:35], v[28:29] op_sel_hi:[1,0]
    v_pk_mul_f32 v[36:37], v[36:37], v[28:29] op_sel_hi:[1,0]
    v_pk_mul_f32 v[38:39], v[38:39], v[28:29] op_sel_hi:[1,0]
    v_pk_mul_f32 v[40:41], v[40:41], v[28:29] op_sel_hi:[1,0]
    v_pk_mul_f32 v[42:43], v[42:43], v[28:29] op_sel_hi:[1,0]
    v_pk_mul_f32 v[44:45], v[44:45], v[28:29] op_sel_hi:[1,0]
    v_pk_mul_f32 v[46:47], v[46:47], v[28:29] op_sel_hi:[1,0]
    v_pk_mul_f32 v[48:49], v[48:49], v[28:29] op_sel_hi:[1,0]
    v_pk_mul_f32 v[50:51], v[50:51], v[28:29] op_sel_hi:[1,0]
    v_pk_mul_f32 v[52:53], v[52:53], v[28:29] op_sel_hi:[1,0]
    v_pk_mul_f32 v[54:55], v[54:55], v[28:29] op_sel_hi:[1,0]
    v_pk_mul_f32 v[56:57], v[56:57], v[28:29] op_sel_hi:[1,0]
    v_pk_mul_f32 v[58:59], v[58:59], v[28:29] op_sel_hi:[1,0]
    v_pk_mul_f32 v[60:61], v[60:61], v[28:29] op_sel_hi:[1,0]
    v_pk_mul_f32 v[62:63], v[62:63], v[28:29] op_sel_hi:[1,0]
    v_add_f32 v24, v80, v81
    v_add_f32 v25, v82, v83
    v_add_f32 v24, v24, v84
    v_add_f32 v25, v25, v85
    v_add_f32 v24, v24, v86
    v_add_f32 v25, v25, v87
    v_cvt_pk_bf16_f32 v88, v80, v81
    v_cvt_pk_bf16_f32 v89, v82, v83
    v_cvt_pk_bf16_f32 v90, v84, v85
    v_cvt_pk_bf16_f32 v91, v86, v87
    v_add_f32 v24, v24, v25
    v_fma_f32 v93, v93, v28, v24
    v_mov_b32 v25, v93
    s_nop 1
    v_permlane16_swap_b32 v93, v25
    v_add_f32 v93, v93, v25
    v_mov_b32 v25, v93
    s_nop 1
    v_permlane32_swap_b32 v93, v25
    v_add_f32 v93, v93, v25
    s_mov_b64 exec, 0xff
    ds_write_b32 v6, v92 offset:256
    ds_write_b32 v6, v93 offset:768
    s_mov_b64 exec, -1
    v_mov_b32 v243, s79
    s_add_u32 s85, s91, 0
    buffer_load_dwordx4 v[128:131], v13, s[24:27], s85 offen offset:0 nt
    s_add_u32 s85, s91, 16384
    buffer_load_dwordx4 v[132:135], v13, s[24:27], s85 offen offset:0 nt
    s_add_u32 s85, s91, 32768
    buffer_load_dwordx4 v[136:139], v13, s[24:27], s85 offen offset:0 nt
    s_add_u32 s85, s91, 49152
    buffer_load_dwordx4 v[140:143], v13, s[24:27], s85 offen offset:0 nt
    v_perm_b32 v96, v164, v160, s76
    v_perm_b32 v100, v164, v160, s77
    v_perm_b32 v104, v165, v161, s76
    v_perm_b32 v108, v165, v161, s77
    v_perm_b32 v112, v166, v162, s76
    v_perm_b32 v116, v166, v162, s77
    v_perm_b32 v120, v167, v163, s76
    v_perm_b32 v124, v167, v163, s77
    v_perm_b32 v97, v172, v168, s76
    v_perm_b32 v101, v172, v168, s77
    v_perm_b32 v105, v173, v169, s76
    v_perm_b32 v109, v173, v169, s77
    v_perm_b32 v113, v174, v170, s76
    v_perm_b32 v117, v174, v170, s77
    v_perm_b32 v121, v175, v171, s76
    v_perm_b32 v125, v175, v171, s77
    v_perm_b32 v98, v180, v176, s76
    v_perm_b32 v102, v180, v176, s77
    v_perm_b32 v106, v181, v177, s76
    v_perm_b32 v110, v181, v177, s77
    v_perm_b32 v114, v182, v178, s76
    v_perm_b32 v118, v182, v178, s77
    v_perm_b32 v122, v183, v179, s76
    v_perm_b32 v126, v183, v179, s77
    v_perm_b32 v99, v188, v184, s76
    v_perm_b32 v103, v188, v184, s77
    v_perm_b32 v107, v189, v185, s76
    v_mfma_f32_16x16x32_bf16 v[32:35], v[96:99], v[88:91], v[32:35]
    v_perm_b32 v111, v189, v185, s77
    v_mfma_f32_16x16x32_bf16 v[36:39], v[100:103], v[88:91], v[36:39]
    v_perm_b32 v115, v190, v186, s76
    v_mfma_f32_16x16x32_bf16 v[40:43], v[104:107], v[88:91], v[40:43]
    v_perm_b32 v119, v190, v186, s77
    v_mfma_f32_16x16x32_bf16 v[44:47], v[108:111], v[88:91], v[44:47]
    v_perm_b32 v123, v191, v187, s76
    v_mfma_f32_16x16x32_bf16 v[48:51], v[112:115], v[88:91], v[48:51]
    v_perm_b32 v127, v191, v187, s77
    v_mfma_f32_16x16x32_bf16 v[52:55], v[116:119], v[88:91], v[52:55]
    s_nop 0
    v_mfma_f32_16x16x32_bf16 v[56:59], v[120:123], v[88:91], v[56:59]
    v_mfma_f32_16x16x32_bf16 v[60:63], v[124:127], v[88:91], v[60:63]
    s_mov_b32 exec_lo, 0x00ff00ff
    s_mov_b32 exec_hi, 0x00ff00ff
    ds_write_b128 v5, v[32:35] offset:33792
    ds_write_b128 v5, v[36:39] offset:33808
    ds_write_b128 v5, v[40:43] offset:33824
    ds_write_b128 v5, v[44:47] offset:33840
    ds_write_b128 v5, v[48:51] offset:33856
    ds_write_b128 v5, v[52:55] offset:33872
    ds_write_b128 v5, v[56:59] offset:33888
    ds_write_b128 v5, v[60:63] offset:33904
    s_mov_b64 exec, -1
    v_and_b32 v240, 1, v0
    v_cmp_eq_u32 vcc, 1, v240
    s_setprio 0
    s_waitcnt lgkmcnt(0)
    s_barrier
    ds_read_b32 v224, v9 offset:256
    ds_read_b128 v[228:231], v9 offset:272
    ds_read_b128 v[96:99], v8 offset:33792
    ds_read_b128 v[100:103], v8 offset:50688
    ds_read_b128 v[104:107], v8 offset:54912
    ds_read_b128 v[108:111], v8 offset:59136
    ds_read_b128 v[112:115], v8 offset:63360
    ds_read_b32 v232, v9 offset:768
    ds_read_b128 v[236:239], v9 offset:784
    s_waitcnt lgkmcnt(7)
    v_max3_f32 v242, v224, v228, v229
    v_max3_f32 v242, v242, v230, v231
    v_mul_f32 v26, s78, v242
    v_fma_f32 v224, v224, s78, -v26
    v_fma_f32 v228, v228, s78, -v26
    v_fma_f32 v229, v229, s78, -v26
    v_fma_f32 v230, v230, s78, -v26
    v_fma_f32 v231, v231, s78, -v26
    v_exp_f32 v224, v224
    v_exp_f32 v228, v228
    v_exp_f32 v229, v229
    v_exp_f32 v230, v230
    v_exp_f32 v231, v231
    s_waitcnt lgkmcnt(2)
    v_pk_mul_f32 v[244:245], v[96:97], v[224:225] op_sel:[0,0] op_sel_hi:[1,0]
    v_pk_mul_f32 v[246:247], v[98:99], v[224:225] op_sel:[0,0] op_sel_hi:[1,0]
    v_pk_fma_f32 v[244:245], v[100:101], v[228:229], v[244:245] op_sel:[0,0,0] op_sel_hi:[1,0,1]
    v_pk_fma_f32 v[246:247], v[102:103], v[228:229], v[246:247] op_sel:[0,0,0] op_sel_hi:[1,0,1]
    v_pk_fma_f32 v[244:245], v[104:105], v[228:229], v[244:245] op_sel:[0,1,0] op_sel_hi:[1,1,1]
    v_pk_fma_f32 v[246:247], v[106:107], v[228:229], v[246:247] op_sel:[0,1,0] op_sel_hi:[1,1,1]
    v_pk_fma_f32 v[244:245], v[108:109], v[230:231], v[244:245] op_sel:[0,0,0] op_sel_hi:[1,0,1]
    v_pk_fma_f32 v[246:247], v[110:111], v[230:231], v[246:247] op_sel:[0,0,0] op_sel_hi:[1,0,1]
    v_pk_fma_f32 v[244:245], v[112:113], v[230:231], v[244:245] op_sel:[0,1,0] op_sel_hi:[1,1,1]
    v_pk_fma_f32 v[246:247], v[114:115], v[230:231], v[246:247] op_sel:[0,1,0] op_sel_hi:[1,1,1]
    s_waitcnt lgkmcnt(0)
    v_mul_f32 v225, v224, v232
    v_fmac_f32 v225, v228, v236
    v_fmac_f32 v225, v229, v237
    v_fmac_f32 v225, v230, v238
    v_fmac_f32 v225, v231, v239
    v_cvt_pk_bf16_f32 v240, v244, v245
    v_cvt_pk_bf16_f32 v241, v246, v247
    v_cndmask_b32 v242, v242, v225, vcc
    s_mov_b32 exec_hi, 0
    buffer_store_dwordx4 v[240:243], v12, s[28:31], s92 offen sc1
    s_mov_b32 exec_hi, -1
    s_add_u32 s85, s91, 0
    buffer_load_dwordx4 v[144:147], v13, s[24:27], s85 offen offset:2048 nt
    s_add_u32 s85, s91, 16384
    buffer_load_dwordx4 v[148:151], v13, s[24:27], s85 offen offset:2048 nt
    s_add_u32 s85, s91, 32768
    buffer_load_dwordx4 v[152:155], v13, s[24:27], s85 offen offset:2048 nt
    s_add_u32 s85, s91, 49152
    buffer_load_dwordx4 v[156:159], v13, s[24:27], s85 offen offset:2048 nt
    s_setprio 2
    v_mov_b32 v84, s79
    s_waitcnt vmcnt(9)
    v_perm_b32 v96, v196, v192, s76
    v_perm_b32 v97, v204, v200, s76
    v_perm_b32 v98, v212, v208, s76
    v_perm_b32 v99, v220, v216, s76
    v_perm_b32 v100, v196, v192, s77
    v_perm_b32 v101, v204, v200, s77
    v_perm_b32 v102, v212, v208, s77
    v_perm_b32 v103, v220, v216, s77
    v_perm_b32 v104, v197, v193, s76
    v_perm_b32 v105, v205, v201, s76
    v_perm_b32 v106, v213, v209, s76
    v_perm_b32 v107, v221, v217, s76
    v_perm_b32 v108, v197, v193, s77
    v_perm_b32 v109, v205, v201, s77
    v_perm_b32 v110, v213, v209, s77
    v_perm_b32 v111, v221, v217, s77
    v_perm_b32 v112, v198, v194, s76
    v_perm_b32 v113, v206, v202, s76
    v_perm_b32 v114, v214, v210, s76
    v_perm_b32 v115, v222, v218, s76
    v_perm_b32 v116, v198, v194, s77
    v_perm_b32 v117, v206, v202, s77
    v_perm_b32 v118, v214, v210, s77
    v_perm_b32 v119, v222, v218, s77
    v_perm_b32 v120, v199, v195, s76
    v_perm_b32 v121, v207, v203, s76
    v_perm_b32 v122, v215, v211, s76
    v_perm_b32 v123, v223, v219, s76
    v_perm_b32 v124, v199, v195, s77
    v_perm_b32 v125, v207, v203, s77
    v_perm_b32 v126, v215, v211, s77
    v_perm_b32 v127, v223, v219, s77
    s_waitcnt vmcnt(0)
    v_perm_b32 v160, v132, v128, s76
    v_perm_b32 v161, v140, v136, s76
    v_perm_b32 v162, v148, v144, s76
    v_perm_b32 v163, v156, v152, s76
    v_perm_b32 v164, v132, v128, s77
    v_perm_b32 v165, v140, v136, s77
    v_perm_b32 v166, v148, v144, s77
    v_perm_b32 v167, v156, v152, s77
    v_perm_b32 v168, v133, v129, s76
    v_perm_b32 v169, v141, v137, s76
    v_perm_b32 v170, v149, v145, s76
    v_perm_b32 v171, v157, v153, s76
    v_perm_b32 v172, v133, v129, s77
    v_perm_b32 v173, v141, v137, s77
    v_perm_b32 v174, v149, v145, s77
    v_perm_b32 v175, v157, v153, s77
    v_perm_b32 v176, v134, v130, s76
    v_perm_b32 v177, v142, v138, s76
    v_perm_b32 v178, v150, v146, s76
    v_perm_b32 v179, v158, v154, s76
    v_perm_b32 v180, v134, v130, s77
    v_perm_b32 v181, v142, v138, s77
    v_perm_b32 v182, v150, v146, s77
    v_perm_b32 v183, v158, v154, s77
    v_perm_b32 v184, v135, v131, s76
    v_perm_b32 v185, v143, v139, s76
    v_perm_b32 v186, v151, v147, s76
    v_perm_b32 v187, v159, v155, s76
    v_perm_b32 v188, v135, v131, s77
    v_perm_b32 v189, v143, v139, s77
    v_perm_b32 v190, v151, v147, s77
    v_perm_b32 v191, v159, v155, s77
    s_mov_b32 s89, 0
L_ls61:
    ds_read_b32 v31, v10 offset:16
    s_waitcnt lgkmcnt(0)
    v_readfirstlane_b32 s88, v31
    s_add_u32 s89, s89, 1
    s_cmp_eq_u32 s88, 2
    s_cbranch_scc1 L_lsok62
    s_cmp_gt_u32 s89, 1000000
    s_cbranch_scc1 L_lsok62
    s_sleep 1
    s_branch L_ls61
L_lsok62:
    ds_read_b128 v[72:75], v2 offset:1024
    s_waitcnt lgkmcnt(0)
    v_mfma_f32_16x16x32_bf16 v[32:35], v[72:75], v[96:99], 0
    v_mfma_f32_16x16x32_bf16 v[36:39], v[72:75], v[100:103], 0
    v_mfma_f32_16x16x32_bf16 v[40:43], v[72:75], v[104:107], 0
    v_mfma_f32_16x16x32_bf16 v[44:47], v[72:75], v[108:111], 0
    v_mfma_f32_16x16x32_bf16 v[48:51], v[72:75], v[112:115], 0
    v_mfma_f32_16x16x32_bf16 v[52:55], v[72:75], v[116:119], 0
    v_mfma_f32_16x16x32_bf16 v[56:59], v[72:75], v[120:123], 0
    v_mfma_f32_16x16x32_bf16 v[60:63], v[72:75], v[124:127], 0
    s_barrier
    ds_read_b128 v[76:79], v2 offset:1152
    s_waitcnt lgkmcnt(0)
    v_mfma_f32_16x16x32_bf16 v[32:35], v[76:79], v[160:163], v[32:35]
    v_mfma_f32_16x16x32_bf16 v[48:51], v[76:79], v[176:179], v[48:51]
    v_mfma_f32_16x16x32_bf16 v[36:39], v[76:79], v[164:167], v[36:39]
    v_mfma_f32_16x16x32_bf16 v[52:55], v[76:79], v[180:183], v[52:55]
    v_mfma_f32_16x16x32_bf16 v[40:43], v[76:79], v[168:171], v[40:43]
    v_mfma_f32_16x16x32_bf16 v[56:59], v[76:79], v[184:187], v[56:59]
    v_mfma_f32_16x16x32_bf16 v[44:47], v[76:79], v[172:175], v[44:47]
    v_mfma_f32_16x16x32_bf16 v[60:63], v[76:79], v[188:191], v[60:63]
    s_nop 4
    v_cndmask_b32 v80, v32, v48, s[100:101]
    v_cndmask_b32 v81, v36, v52, s[100:101]
    v_cndmask_b32 v82, v40, v56, s[100:101]
    v_cndmask_b32 v83, v44, v60, s[100:101]
    v_perm_b32 v80, v80, v84, s4
    v_perm_b32 v81, v81, v84, s5
    v_perm_b32 v82, v82, v84, s6
    v_perm_b32 v83, v83, v84, s7
    buffer_store_dwordx4 v[80:83], v4, s[28:31], s98 offen sc1
    s_endpgm
L_dend57:
    s_add_u32 s101, s99, 0
    s_add_u32 s85, s91, 0
    buffer_load_dwordx4 v[96:99], v13, s[36:39], s85 offen offset:0 nt
    s_add_u32 s85, s91, 16384
    buffer_load_dwordx4 v[100:103], v13, s[36:39], s85 offen offset:0 nt
    s_add_u32 s85, s91, 32768
    buffer_load_dwordx4 v[104:107], v13, s[36:39], s85 offen offset:0 nt
    s_add_u32 s85, s91, 49152
    buffer_load_dwordx4 v[108:111], v13, s[36:39], s85 offen offset:0 nt
    s_add_u32 s85, s91, 0
    buffer_load_dwordx4 v[112:115], v13, s[36:39], s85 offen offset:2048 nt
    s_add_u32 s85, s91, 16384
    buffer_load_dwordx4 v[116:119], v13, s[36:39], s85 offen offset:2048 nt
    s_add_u32 s85, s91, 32768
    buffer_load_dwordx4 v[120:123], v13, s[36:39], s85 offen offset:2048 nt
    s_add_u32 s85, s91, 49152
    buffer_load_dwordx4 v[124:127], v13, s[36:39], s85 offen offset:2048 nt
    s_mov_b32 s73, s101
    v_bfe_u32 v26, v0, 2, 1
    v_lshlrev_b32 v2, 6, v26
    v_lshrrev_b32 v26, 4, v0
    v_lshl_add_u32 v2, v26, 4, v2
    v_bfe_u32 v26, v0, 4, 1
    v_lshlrev_b32 v4, 19, v26
    v_bfe_u32 v26, v0, 3, 1
    v_lshl_add_u32 v4, v26, 14, v4
    v_and_b32 v26, 7, v0
    v_lshl_add_u32 v4, v26, 4, v4
    v_lshrrev_b32 v26, 5, v0
    v_lshl_add_u32 v4, v26, 15, v4
    s_and_b32 s98, s3, 3
    s_lshl_b32 s98, s98, 16
    s_lshl_b32 s86, s90, 7
    s_add_u32 s98, s98, s86
    s_add_u32 s98, s98, 0x600000
    s_mov_b32 s100, 0
    s_mov_b32 s101, -1
    s_mov_b32 s4, 0x7060500
    s_mov_b32 s5, 0x7060501
    s_mov_b32 s6, 0x7060502
    s_mov_b32 s7, 0x7060503
    v_mov_b32 v84, s70
    v_mov_b32 v85, s70
    v_mov_b32 v86, s70
    v_mov_b32 v87, s70
    s_nop 0
    v_mfma_f32_16x16x32_bf16 v[80:83], v[192:195], v[64:67], 0
    v_mfma_f32_16x16x32_bf16 v[84:87], v[208:211], v[64:67], v[84:87]
    v_mfma_f32_16x16x32_bf16 v[80:83], v[196:199], v[68:71], v[80:83]
    v_mfma_f32_16x16x32_bf16 v[84:87], v[212:215], v[68:71], v[84:87]
    v_mfma_f32_16x16x32_bf16 v[80:83], v[200:203], v[72:75], v[80:83]
    v_mfma_f32_16x16x32_bf16 v[84:87], v[216:219], v[72:75], v[84:87]
    v_mfma_f32_16x16x32_bf16 v[80:83], v[204:207], v[76:79], v[80:83]
    v_mfma_f32_16x16x32_bf16 v[84:87], v[220:223], v[76:79], v[84:87]
    v_mov_b32 v25, s73
    s_mov_b64 exec, 1
    ds_max_u32 v10, v25 offset:28
    s_mov_b64 exec, -1
    s_nop 7
    v_max3_f32 v24, v80, v81, v82
    v_max3_f32 v24, v24, v83, v84
    v_max3_f32 v24, v24, v85, v86
    v_max3_f32 v24, v24, v87, v92
    v_mov_b32 v25, v24
    s_nop 1
    v_permlane16_swap_b32 v24, v25
    v_max_f32 v24, v24, v25
    v_mov_b32 v25, v24
    s_nop 1
    v_permlane32_swap_b32 v24, v25
    v_max_f32 v24, v24, v25
    s_setprio 2
    v_mul_f32 v26, s78, v24
    v_fma_f32 v28, v92, s78, -v26
    v_exp_f32 v28, v28
    v_mov_b32 v92, v24
    v_fma_f32 v80, v80, s78, -v26
    v_fma_f32 v81, v81, s78, -v26
    v_fma_f32 v82, v82, s78, -v26
    v_fma_f32 v83, v83, s78, -v26
    v_fma_f32 v84, v84, s78, -v26
    v_fma_f32 v85, v85, s78, -v26
    v_fma_f32 v86, v86, s78, -v26
    v_fma_f32 v87, v87, s78, -v26
    v_exp_f32 v80, v80
    v_exp_f32 v81, v81
    v_exp_f32 v82, v82
    v_exp_f32 v83, v83
    v_exp_f32 v84, v84
    v_exp_f32 v85, v85
    v_exp_f32 v86, v86
    v_exp_f32 v87, v87
    v_pk_mul_f32 v[32:33], v[32:33], v[28:29] op_sel_hi:[1,0]
    v_pk_mul_f32 v[34:35], v[34:35], v[28:29] op_sel_hi:[1,0]
    v_pk_mul_f32 v[36:37], v[36:37], v[28:29] op_sel_hi:[1,0]
    v_pk_mul_f32 v[38:39], v[38:39], v[28:29] op_sel_hi:[1,0]
    v_pk_mul_f32 v[40:41], v[40:41], v[28:29] op_sel_hi:[1,0]
    v_pk_mul_f32 v[42:43], v[42:43], v[28:29] op_sel_hi:[1,0]
    v_pk_mul_f32 v[44:45], v[44:45], v[28:29] op_sel_hi:[1,0]
    v_pk_mul_f32 v[46:47], v[46:47], v[28:29] op_sel_hi:[1,0]
    v_pk_mul_f32 v[48:49], v[48:49], v[28:29] op_sel_hi:[1,0]
    v_pk_mul_f32 v[50:51], v[50:51], v[28:29] op_sel_hi:[1,0]
    v_pk_mul_f32 v[52:53], v[52:53], v[28:29] op_sel_hi:[1,0]
    v_pk_mul_f32 v[54:55], v[54:55], v[28:29] op_sel_hi:[1,0]
    v_pk_mul_f32 v[56:57], v[56:57], v[28:29] op_sel_hi:[1,0]
    v_pk_mul_f32 v[58:59], v[58:59], v[28:29] op_sel_hi:[1,0]
    v_pk_mul_f32 v[60:61], v[60:61], v[28:29] op_sel_hi:[1,0]
    v_pk_mul_f32 v[62:63], v[62:63], v[28:29] op_sel_hi:[1,0]
    v_add_f32 v24, v80, v81
    v_add_f32 v25, v82, v83
    v_add_f32 v24, v24, v84
    v_add_f32 v25, v25, v85
    v_add_f32 v24, v24, v86
    v_add_f32 v25, v25, v87
    v_cvt_pk_bf16_f32 v88, v80, v81
    v_cvt_pk_bf16_f32 v89, v82, v83
    v_cvt_pk_bf16_f32 v90, v84, v85
    v_cvt_pk_bf16_f32 v91, v86, v87
    v_add_f32 v24, v24, v25
    v_fma_f32 v93, v93, v28, v24
    v_mov_b32 v25, v93
    s_nop 1
    v_permlane16_swap_b32 v93, v25
    v_add_f32 v93, v93, v25
    v_mov_b32 v25, v93
    s_nop 1
    v_permlane32_swap_b32 v93, v25
    v_add_f32 v93, v93, v25
    s_mov_b64 exec, 0xff
    ds_write_b32 v6, v92 offset:256
    ds_write_b32 v6, v93 offset:768
    s_mov_b64 exec, -1
    v_mov_b32 v147, s79
    s_waitcnt vmcnt(10)
    s_add_u32 s85, s91, 0
    buffer_load_dwordx4 v[192:195], v13, s[24:27], s85 offen offset:0 nt
    s_add_u32 s85, s91, 16384
    buffer_load_dwordx4 v[196:199], v13, s[24:27], s85 offen offset:0 nt
    s_add_u32 s85, s91, 32768
    buffer_load_dwordx4 v[200:203], v13, s[24:27], s85 offen offset:0 nt
    s_add_u32 s85, s91, 49152
    buffer_load_dwordx4 v[204:207], v13, s[24:27], s85 offen offset:0 nt
    v_perm_b32 v160, v228, v224, s76
    v_perm_b32 v164, v228, v224, s77
    v_perm_b32 v168, v229, v225, s76
    v_perm_b32 v172, v229, v225, s77
    v_perm_b32 v176, v230, v226, s76
    v_perm_b32 v180, v230, v226, s77
    v_perm_b32 v184, v231, v227, s76
    v_perm_b32 v188, v231, v227, s77
    v_perm_b32 v161, v236, v232, s76
    v_perm_b32 v165, v236, v232, s77
    v_perm_b32 v169, v237, v233, s76
    v_perm_b32 v173, v237, v233, s77
    v_perm_b32 v177, v238, v234, s76
    v_perm_b32 v181, v238, v234, s77
    v_perm_b32 v185, v239, v235, s76
    v_perm_b32 v189, v239, v235, s77
    v_perm_b32 v162, v244, v240, s76
    v_perm_b32 v166, v244, v240, s77
    v_perm_b32 v170, v245, v241, s76
    v_perm_b32 v174, v245, v241, s77
    v_perm_b32 v178, v246, v242, s76
    v_perm_b32 v182, v246, v242, s77
    v_perm_b32 v186, v247, v243, s76
    v_perm_b32 v190, v247, v243, s77
    s_waitcnt vmcnt(12)
    v_perm_b32 v163, v252, v248, s76
    v_perm_b32 v167, v252, v248, s77
    v_perm_b32 v171, v253, v249, s76
    v_mfma_f32_16x16x32_bf16 v[32:35], v[160:163], v[88:91], v[32:35]
    v_perm_b32 v175, v253, v249, s77
    v_mfma_f32_16x16x32_bf16 v[36:39], v[164:167], v[88:91], v[36:39]
    v_perm_b32 v179, v254, v250, s76
    v_mfma_f32_16x16x32_bf16 v[40:43], v[168:171], v[88:91], v[40:43]
    v_perm_b32 v183, v254, v250, s77
    v_mfma_f32_16x16x32_bf16 v[44:47], v[172:175], v[88:91], v[44:47]
    v_perm_b32 v187, v255, v251, s76
    v_mfma_f32_16x16x32_bf16 v[48:51], v[176:179], v[88:91], v[48:51]
    v_perm_b32 v191, v255, v251, s77
    v_mfma_f32_16x16x32_bf16 v[52:55], v[180:183], v[88:91], v[52:55]
    s_nop 0
    v_mfma_f32_16x16x32_bf16 v[56:59], v[184:187], v[88:91], v[56:59]
    v_mfma_f32_16x16x32_bf16 v[60:63], v[188:191], v[88:91], v[60:63]
    s_mov_b32 exec_lo, 0x00ff00ff
    s_mov_b32 exec_hi, 0x00ff00ff
    ds_write_b128 v5, v[32:35] offset:33792
    ds_write_b128 v5, v[36:39] offset:33808
    ds_write_b128 v5, v[40:43] offset:33824
    ds_write_b128 v5, v[44:47] offset:33840
    ds_write_b128 v5, v[48:51] offset:33856
    ds_write_b128 v5, v[52:55] offset:33872
    ds_write_b128 v5, v[56:59] offset:33888
    ds_write_b128 v5, v[60:63] offset:33904
    s_mov_b64 exec, -1
    v_and_b32 v144, 1, v0
    v_cmp_eq_u32 vcc, 1, v144
    s_setprio 0
    s_waitcnt lgkmcnt(0)
    s_barrier
    ds_read_b32 v128, v9 offset:256
    ds_read_b128 v[132:135], v9 offset:272
    ds_read_b128 v[160:163], v8 offset:33792
    ds_read_b128 v[164:167], v8 offset:50688
    ds_read_b128 v[168:171], v8 offset:54912
    ds_read_b128 v[172:175], v8 offset:59136
    ds_read_b128 v[176:179], v8 offset:63360
    ds_read_b32 v136, v9 offset:768
    ds_read_b128 v[140:143], v9 offset:784
    s_waitcnt lgkmcnt(7)
    v_max3_f32 v146, v128, v132, v133
    v_max3_f32 v146, v146, v134, v135
    v_mul_f32 v26, s78, v146
    v_fma_f32 v128, v128, s78, -v26
    v_fma_f32 v132, v132, s78, -v26
    v_fma_f32 v133, v133, s78, -v26
    v_fma_f32 v134, v134, s78, -v26
    v_fma_f32 v135, v135, s78, -v26
    v_exp_f32 v128, v128
    v_exp_f32 v132, v132
    v_exp_f32 v133, v133
    v_exp_f32 v134, v134
    v_exp_f32 v135, v135
    s_waitcnt lgkmcnt(2)
    v_pk_mul_f32 v[148:149], v[160:161], v[128:129] op_sel:[0,0] op_sel_hi:[1,0]
    v_pk_mul_f32 v[150:151], v[162:163], v[128:129] op_sel:[0,0] op_sel_hi:[1,0]
    v_pk_fma_f32 v[148:149], v[164:165], v[132:133], v[148:149] op_sel:[0,0,0] op_sel_hi:[1,0,1]
    v_pk_fma_f32 v[150:151], v[166:167], v[132:133], v[150:151] op_sel:[0,0,0] op_sel_hi:[1,0,1]
    v_pk_fma_f32 v[148:149], v[168:169], v[132:133], v[148:149] op_sel:[0,1,0] op_sel_hi:[1,1,1]
    v_pk_fma_f32 v[150:151], v[170:171], v[132:133], v[150:151] op_sel:[0,1,0] op_sel_hi:[1,1,1]
    v_pk_fma_f32 v[148:149], v[172:173], v[134:135], v[148:149] op_sel:[0,0,0] op_sel_hi:[1,0,1]
    v_pk_fma_f32 v[150:151], v[174:175], v[134:135], v[150:151] op_sel:[0,0,0] op_sel_hi:[1,0,1]
    v_pk_fma_f32 v[148:149], v[176:177], v[134:135], v[148:149] op_sel:[0,1,0] op_sel_hi:[1,1,1]
    v_pk_fma_f32 v[150:151], v[178:179], v[134:135], v[150:151] op_sel:[0,1,0] op_sel_hi:[1,1,1]
    s_waitcnt lgkmcnt(0)
    v_mul_f32 v129, v128, v136
    v_fmac_f32 v129, v132, v140
    v_fmac_f32 v129, v133, v141
    v_fmac_f32 v129, v134, v142
    v_fmac_f32 v129, v135, v143
    v_cvt_pk_bf16_f32 v144, v148, v149
    v_cvt_pk_bf16_f32 v145, v150, v151
    v_cndmask_b32 v146, v146, v129, vcc
    s_mov_b32 exec_hi, 0
    buffer_store_dwordx4 v[144:147], v12, s[28:31], s92 offen sc1
    s_mov_b32 exec_hi, -1
    s_add_u32 s85, s91, 0
    buffer_load_dwordx4 v[208:211], v13, s[24:27], s85 offen offset:2048 nt
    s_add_u32 s85, s91, 16384
    buffer_load_dwordx4 v[212:215], v13, s[24:27], s85 offen offset:2048 nt
    s_add_u32 s85, s91, 32768
    buffer_load_dwordx4 v[216:219], v13, s[24:27], s85 offen offset:2048 nt
    s_add_u32 s85, s91, 49152
    buffer_load_dwordx4 v[220:223], v13, s[24:27], s85 offen offset:2048 nt
    s_setprio 2
    v_mov_b32 v84, s79
    s_waitcnt vmcnt(9)
    v_perm_b32 v160, v100, v96, s76
    v_perm_b32 v161, v108, v104, s76
    v_perm_b32 v162, v116, v112, s76
    v_perm_b32 v163, v124, v120, s76
    v_perm_b32 v164, v100, v96, s77
    v_perm_b32 v165, v108, v104, s77
    v_perm_b32 v166, v116, v112, s77
    v_perm_b32 v167, v124, v120, s77
    v_perm_b32 v168, v101, v97, s76
    v_perm_b32 v169, v109, v105, s76
    v_perm_b32 v170, v117, v113, s76
    v_perm_b32 v171, v125, v121, s76
    v_perm_b32 v172, v101, v97, s77
    v_perm_b32 v173, v109, v105, s77
    v_perm_b32 v174, v117, v113, s77
    v_perm_b32 v175, v125, v121, s77
    v_perm_b32 v176, v102, v98, s76
    v_perm_b32 v177, v110, v106, s76
    v_perm_b32 v178, v118, v114, s76
    v_perm_b32 v179, v126, v122, s76
    v_perm_b32 v180, v102, v98, s77
    v_perm_b32 v181, v110, v106, s77
    v_perm_b32 v182, v118, v114, s77
    v_perm_b32 v183, v126, v122, s77
    v_perm_b32 v184, v103, v99, s76
    v_perm_b32 v185, v111, v107, s76
    v_perm_b32 v186, v119, v115, s76
    v_perm_b32 v187, v127, v123, s76
    v_perm_b32 v188, v103, v99, s77
    v_perm_b32 v189, v111, v107, s77
    v_perm_b32 v190, v119, v115, s77
    v_perm_b32 v191, v127, v123, s77
    s_waitcnt vmcnt(0)
    v_perm_b32 v224, v196, v192, s76
    v_perm_b32 v225, v204, v200, s76
    v_perm_b32 v226, v212, v208, s76
    v_perm_b32 v227, v220, v216, s76
    v_perm_b32 v228, v196, v192, s77
    v_perm_b32 v229, v204, v200, s77
    v_perm_b32 v230, v212, v208, s77
    v_perm_b32 v231, v220, v216, s77
    v_perm_b32 v232, v197, v193, s76
    v_perm_b32 v233, v205, v201, s76
    v_perm_b32 v234, v213, v209, s76
    v_perm_b32 v235, v221, v217, s76
    v_perm_b32 v236, v197, v193, s77
    v_perm_b32 v237, v205, v201, s77
    v_perm_b32 v238, v213, v209, s77
    v_perm_b32 v239, v221, v217, s77
    v_perm_b32 v240, v198, v194, s76
    v_perm_b32 v241, v206, v202, s76
    v_perm_b32 v242, v214, v210, s76
    v_perm_b32 v243, v222, v218, s76
    v_perm_b32 v244, v198, v194, s77
    v_perm_b32 v245, v206, v202, s77
    v_perm_b32 v246, v214, v210, s77
    v_perm_b32 v247, v222, v218, s77
    v_perm_b32 v248, v199, v195, s76
    v_perm_b32 v249, v207, v203, s76
    v_perm_b32 v250, v215, v211, s76
    v_perm_b32 v251, v223, v219, s76
    v_perm_b32 v252, v199, v195, s77
    v_perm_b32 v253, v207, v203, s77
    v_perm_b32 v254, v215, v211, s77
    v_perm_b32 v255, v223, v219, s77
    s_mov_b32 s89, 0
L_ls63:
    ds_read_b32 v31, v10 offset:16
    s_waitcnt lgkmcnt(0)
    v_readfirstlane_b32 s88, v31
    s_add_u32 s89, s89, 1
    s_cmp_eq_u32 s88, 2
    s_cbranch_scc1 L_lsok64
    s_cmp_gt_u32 s89, 1000000
    s_cbranch_scc1 L_lsok64
    s_sleep 1
    s_branch L_ls63
L_lsok64:
    ds_read_b128 v[72:75], v2 offset:1024
    s_waitcnt lgkmcnt(0)
    v_mfma_f32_16x16x32_bf16 v[32:35], v[72:75], v[160:163], 0
    v_mfma_f32_16x16x32_bf16 v[36:39], v[72:75], v[164:167], 0
    v_mfma_f32_16x16x32_bf16 v[40:43], v[72:75], v[168:171], 0
    v_mfma_f32_16x16x32_bf16 v[44:47], v[72:75], v[172:175], 0
    v_mfma_f32_16x16x32_bf16 v[48:51], v[72:75], v[176:179], 0
    v_mfma_f32_16x16x32_bf16 v[52:55], v[72:75], v[180:183], 0
    v_mfma_f32_16x16x32_bf16 v[56:59], v[72:75], v[184:187], 0
    v_mfma_f32_16x16x32_bf16 v[60:63], v[72:75], v[188:191], 0
    s_barrier
    ds_read_b128 v[76:79], v2 offset:1152
    s_waitcnt lgkmcnt(0)
    v_mfma_f32_16x16x32_bf16 v[32:35], v[76:79], v[224:227], v[32:35]
    v_mfma_f32_16x16x32_bf16 v[48:51], v[76:79], v[240:243], v[48:51]
    v_mfma_f32_16x16x32_bf16 v[36:39], v[76:79], v[228:231], v[36:39]
    v_mfma_f32_16x16x32_bf16 v[52:55], v[76:79], v[244:247], v[52:55]
    v_mfma_f32_16x16x32_bf16 v[40:43], v[76:79], v[232:235], v[40:43]
    v_mfma_f32_16x16x32_bf16 v[56:59], v[76:79], v[248:251], v[56:59]
    v_mfma_f32_16x16x32_bf16 v[44:47], v[76:79], v[236:239], v[44:47]
    v_mfma_f32_16x16x32_bf16 v[60:63], v[76:79], v[252:255], v[60:63]
    s_nop 4
    v_cndmask_b32 v80, v32, v48, s[100:101]
    v_cndmask_b32 v81, v36, v52, s[100:101]
    v_cndmask_b32 v82, v40, v56, s[100:101]
    v_cndmask_b32 v83, v44, v60, s[100:101]
    v_perm_b32 v80, v80, v84, s4
    v_perm_b32 v81, v81, v84, s5
    v_perm_b32 v82, v82, v84, s6
    v_perm_b32 v83, v83, v84, s7
    buffer_store_dwordx4 v[80:83], v4, s[28:31], s98 offen sc1
    s_endpgm
L_dend58:
    s_add_u32 s101, s99, 0
    s_add_u32 s85, s91, 0
    buffer_load_dwordx4 v[160:163], v13, s[36:39], s85 offen offset:0 nt
    s_add_u32 s85, s91, 16384
    buffer_load_dwordx4 v[164:167], v13, s[36:39], s85 offen offset:0 nt
    s_add_u32 s85, s91, 32768
    buffer_load_dwordx4 v[168:171], v13, s[36:39], s85 offen offset:0 nt
    s_add_u32 s85, s91, 49152
    buffer_load_dwordx4 v[172:175], v13, s[36:39], s85 offen offset:0 nt
    s_add_u32 s85, s91, 0
    buffer_load_dwordx4 v[176:179], v13, s[36:39], s85 offen offset:2048 nt
    s_add_u32 s85, s91, 16384
    buffer_load_dwordx4 v[180:183], v13, s[36:39], s85 offen offset:2048 nt
    s_add_u32 s85, s91, 32768
    buffer_load_dwordx4 v[184:187], v13, s[36:39], s85 offen offset:2048 nt
    s_add_u32 s85, s91, 49152
    buffer_load_dwordx4 v[188:191], v13, s[36:39], s85 offen offset:2048 nt
    s_mov_b32 s73, s101
    v_bfe_u32 v26, v0, 2, 1
    v_lshlrev_b32 v2, 6, v26
    v_lshrrev_b32 v26, 4, v0
    v_lshl_add_u32 v2, v26, 4, v2
    v_bfe_u32 v26, v0, 4, 1
    v_lshlrev_b32 v4, 19, v26
    v_bfe_u32 v26, v0, 3, 1
    v_lshl_add_u32 v4, v26, 14, v4
    v_and_b32 v26, 7, v0
    v_lshl_add_u32 v4, v26, 4, v4
    v_lshrrev_b32 v26, 5, v0
    v_lshl_add_u32 v4, v26, 15, v4
    s_and_b32 s98, s3, 3
    s_lshl_b32 s98, s98, 16
    s_lshl_b32 s86, s90, 7
    s_add_u32 s98, s98, s86
    s_add_u32 s98, s98, 0x600000
    s_mov_b32 s100, 0
    s_mov_b32 s101, -1
    s_mov_b32 s4, 0x7060500
    s_mov_b32 s5, 0x7060501
    s_mov_b32 s6, 0x7060502
    s_mov_b32 s7, 0x7060503
    v_mov_b32 v84, s71
    v_mov_b32 v85, s71
    v_mov_b32 v86, s71
    v_mov_b32 v87, s71
    s_nop 0
    v_mfma_f32_16x16x32_bf16 v[80:83], v[96:99], v[64:67], 0
    v_mfma_f32_16x16x32_bf16 v[84:87], v[112:115], v[64:67], v[84:87]
    v_mfma_f32_16x16x32_bf16 v[80:83], v[100:103], v[68:71], v[80:83]
    v_mfma_f32_16x16x32_bf16 v[84:87], v[116:119], v[68:71], v[84:87]
    v_mfma_f32_16x16x32_bf16 v[80:83], v[104:107], v[72:75], v[80:83]
    v_mfma_f32_16x16x32_bf16 v[84:87], v[120:123], v[72:75], v[84:87]
    v_mfma_f32_16x16x32_bf16 v[80:83], v[108:111], v[76:79], v[80:83]
    v_mfma_f32_16x16x32_bf16 v[84:87], v[124:127], v[76:79], v[84:87]
    v_mov_b32 v25, s73
    s_mov_b64 exec, 1
    ds_max_u32 v10, v25 offset:28
    s_mov_b64 exec, -1
    s_nop 7
    v_max3_f32 v24, v80, v81, v82
    v_max3_f32 v24, v24, v83, v84
    v_max3_f32 v24, v24, v85, v86
    v_max3_f32 v24, v24, v87, v92
    v_mov_b32 v25, v24
    s_nop 1
    v_permlane16_swap_b32 v24, v25
    v_max_f32 v24, v24, v25
    v_mov_b32 v25, v24
    s_nop 1
    v_permlane32_swap_b32 v24, v25
    v_max_f32 v24, v24, v25
    s_setprio 2
    v_mul_f32 v26, s78, v24
    v_fma_f32 v28, v92, s78, -v26
    v_exp_f32 v28, v28
    v_mov_b32 v92, v24
    v_fma_f32 v80, v80, s78, -v26
    v_fma_f32 v81, v81, s78, -v26
    v_fma_f32 v82, v82, s78, -v26
    v_fma_f32 v83, v83, s78, -v26
    v_fma_f32 v84, v84, s78, -v26
    v_fma_f32 v85, v85, s78, -v26
    v_fma_f32 v86, v86, s78, -v26
    v_fma_f32 v87, v87, s78, -v26
    v_exp_f32 v80, v80
    v_exp_f32 v81, v81
    v_exp_f32 v82, v82
    v_exp_f32 v83, v83
    v_exp_f32 v84, v84
    v_exp_f32 v85, v85
    v_exp_f32 v86, v86
    v_exp_f32 v87, v87
    v_pk_mul_f32 v[32:33], v[32:33], v[28:29] op_sel_hi:[1,0]
    v_pk_mul_f32 v[34:35], v[34:35], v[28:29] op_sel_hi:[1,0]
    v_pk_mul_f32 v[36:37], v[36:37], v[28:29] op_sel_hi:[1,0]
    v_pk_mul_f32 v[38:39], v[38:39], v[28:29] op_sel_hi:[1,0]
    v_pk_mul_f32 v[40:41], v[40:41], v[28:29] op_sel_hi:[1,0]
    v_pk_mul_f32 v[42:43], v[42:43], v[28:29] op_sel_hi:[1,0]
    v_pk_mul_f32 v[44:45], v[44:45], v[28:29] op_sel_hi:[1,0]
    v_pk_mul_f32 v[46:47], v[46:47], v[28:29] op_sel_hi:[1,0]
    v_pk_mul_f32 v[48:49], v[48:49], v[28:29] op_sel_hi:[1,0]
    v_pk_mul_f32 v[50:51], v[50:51], v[28:29] op_sel_hi:[1,0]
    v_pk_mul_f32 v[52:53], v[52:53], v[28:29] op_sel_hi:[1,0]
    v_pk_mul_f32 v[54:55], v[54:55], v[28:29] op_sel_hi:[1,0]
    v_pk_mul_f32 v[56:57], v[56:57], v[28:29] op_sel_hi:[1,0]
    v_pk_mul_f32 v[58:59], v[58:59], v[28:29] op_sel_hi:[1,0]
    v_pk_mul_f32 v[60:61], v[60:61], v[28:29] op_sel_hi:[1,0]
    v_pk_mul_f32 v[62:63], v[62:63], v[28:29] op_sel_hi:[1,0]
    v_add_f32 v24, v80, v81
    v_add_f32 v25, v82, v83
    v_add_f32 v24, v24, v84
    v_add_f32 v25, v25, v85
    v_add_f32 v24, v24, v86
    v_add_f32 v25, v25, v87
    v_cvt_pk_bf16_f32 v88, v80, v81
    v_cvt_pk_bf16_f32 v89, v82, v83
    v_cvt_pk_bf16_f32 v90, v84, v85
    v_cvt_pk_bf16_f32 v91, v86, v87
    v_add_f32 v24, v24, v25
    v_fma_f32 v93, v93, v28, v24
    v_mov_b32 v25, v93
    s_nop 1
    v_permlane16_swap_b32 v93, v25
    v_add_f32 v93, v93, v25
    v_mov_b32 v25, v93
    s_nop 1
    v_permlane32_swap_b32 v93, v25
    v_add_f32 v93, v93, v25
    s_mov_b64 exec, 0xff
    ds_write_b32 v6, v92 offset:256
    ds_write_b32 v6, v93 offset:768
    s_mov_b64 exec, -1
    v_mov_b32 v211, s79
    s_waitcnt vmcnt(10)
    s_add_u32 s85, s91, 0
    buffer_load_dwordx4 v[96:99], v13, s[24:27], s85 offen offset:0 nt
    s_add_u32 s85, s91, 16384
    buffer_load_dwordx4 v[100:103], v13, s[24:27], s85 offen offset:0 nt
    s_add_u32 s85, s91, 32768
    buffer_load_dwordx4 v[104:107], v13, s[24:27], s85 offen offset:0 nt
    s_add_u32 s85, s91, 49152
    buffer_load_dwordx4 v[108:111], v13, s[24:27], s85 offen offset:0 nt
    v_perm_b32 v224, v132, v128, s76
    v_perm_b32 v228, v132, v128, s77
    v_perm_b32 v232, v133, v129, s76
    v_perm_b32 v236, v133, v129, s77
    v_perm_b32 v240, v134, v130, s76
    v_perm_b32 v244, v134, v130, s77
    v_perm_b32 v248, v135, v131, s76
    v_perm_b32 v252, v135, v131, s77
    v_perm_b32 v225, v140, v136, s76
    v_perm_b32 v229, v140, v136, s77
    v_perm_b32 v233, v141, v137, s76
    v_perm_b32 v237, v141, v137, s77
    v_perm_b32 v241, v142, v138, s76
    v_perm_b32 v245, v142, v138, s77
    v_perm_b32 v249, v143, v139, s76
    v_perm_b32 v253, v143, v139, s77
    v_perm_b32 v226, v148, v144, s76
    v_perm_b32 v230, v148, v144, s77
    v_perm_b32 v234, v149, v145, s76
    v_perm_b32 v238, v149, v145, s77
    v_perm_b32 v242, v150, v146, s76
    v_perm_b32 v246, v150, v146, s77
    v_perm_b32 v250, v151, v147, s76
    v_perm_b32 v254, v151, v147, s77
    s_waitcnt vmcnt(12)
    v_perm_b32 v227, v156, v152, s76
    v_perm_b32 v231, v156, v152, s77
    v_perm_b32 v235, v157, v153, s76
    v_mfma_f32_16x16x32_bf16 v[32:35], v[224:227], v[88:91], v[32:35]
    v_perm_b32 v239, v157, v153, s77
    v_mfma_f32_16x16x32_bf16 v[36:39], v[228:231], v[88:91], v[36:39]
    v_perm_b32 v243, v158, v154, s76
    v_mfma_f32_16x16x32_bf16 v[40:43], v[232:235], v[88:91], v[40:43]
    v_perm_b32 v247, v158, v154, s77
    v_mfma_f32_16x16x32_bf16 v[44:47], v[236:239], v[88:91], v[44:47]
    v_perm_b32 v251, v159, v155, s76
    v_mfma_f32_16x16x32_bf16 v[48:51], v[240:243], v[88:91], v[48:51]
    v_perm_b32 v255, v159, v155, s77
    v_mfma_f32_16x16x32_bf16 v[52:55], v[244:247], v[88:91], v[52:55]
    s_nop 0
    v_mfma_f32_16x16x32_bf16 v[56:59], v[248:251], v[88:91], v[56:59]
    v_mfma_f32_16x16x32_bf16 v[60:63], v[252:255], v[88:91], v[60:63]
    s_mov_b32 exec_lo, 0x00ff00ff
    s_mov_b32 exec_hi, 0x00ff00ff
    ds_write_b128 v5, v[32:35] offset:33792
    ds_write_b128 v5, v[36:39] offset:33808
    ds_write_b128 v5, v[40:43] offset:33824
    ds_write_b128 v5, v[44:47] offset:33840
    ds_write_b128 v5, v[48:51] offset:33856
    ds_write_b128 v5, v[52:55] offset:33872
    ds_write_b128 v5, v[56:59] offset:33888
    ds_write_b128 v5, v[60:63] offset:33904
    s_mov_b64 exec, -1
    v_and_b32 v208, 1, v0
    v_cmp_eq_u32 vcc, 1, v208
    s_setprio 0
    s_waitcnt lgkmcnt(0)
    s_barrier
    ds_read_b32 v192, v9 offset:256
    ds_read_b128 v[196:199], v9 offset:272
    ds_read_b128 v[224:227], v8 offset:33792
    ds_read_b128 v[228:231], v8 offset:50688
    ds_read_b128 v[232:235], v8 offset:54912
    ds_read_b128 v[236:239], v8 offset:59136
    ds_read_b128 v[240:243], v8 offset:63360
    ds_read_b32 v200, v9 offset:768
    ds_read_b128 v[204:207], v9 offset:784
    s_waitcnt lgkmcnt(7)
    v_max3_f32 v210, v192, v196, v197
    v_max3_f32 v210, v210, v198, v199
    v_mul_f32 v26, s78, v210
    v_fma_f32 v192, v192, s78, -v26
    v_fma_f32 v196, v196, s78, -v26
    v_fma_f32 v197, v197, s78, -v26
    v_fma_f32 v198, v198, s78, -v26
    v_fma_f32 v199, v199, s78, -v26
    v_exp_f32 v192, v192
    v_exp_f32 v196, v196
    v_exp_f32 v197, v197
    v_exp_f32 v198, v198
    v_exp_f32 v199, v199
    s_waitcnt lgkmcnt(2)
    v_pk_mul_f32 v[212:213], v[224:225], v[192:193] op_sel:[0,0] op_sel_hi:[1,0]
    v_pk_mul_f32 v[214:215], v[226:227], v[192:193] op_sel:[0,0] op_sel_hi:[1,0]
    v_pk_fma_f32 v[212:213], v[228:229], v[196:197], v[212:213] op_sel:[0,0,0] op_sel_hi:[1,0,1]
    v_pk_fma_f32 v[214:215], v[230:231], v[196:197], v[214:215] op_sel:[0,0,0] op_sel_hi:[1,0,1]
    v_pk_fma_f32 v[212:213], v[232:233], v[196:197], v[212:213] op_sel:[0,1,0] op_sel_hi:[1,1,1]
    v_pk_fma_f32 v[214:215], v[234:235], v[196:197], v[214:215] op_sel:[0,1,0] op_sel_hi:[1,1,1]
    v_pk_fma_f32 v[212:213], v[236:237], v[198:199], v[212:213] op_sel:[0,0,0] op_sel_hi:[1,0,1]
    v_pk_fma_f32 v[214:215], v[238:239], v[198:199], v[214:215] op_sel:[0,0,0] op_sel_hi:[1,0,1]
    v_pk_fma_f32 v[212:213], v[240:241], v[198:199], v[212:213] op_sel:[0,1,0] op_sel_hi:[1,1,1]
    v_pk_fma_f32 v[214:215], v[242:243], v[198:199], v[214:215] op_sel:[0,1,0] op_sel_hi:[1,1,1]
    s_waitcnt lgkmcnt(0)
    v_mul_f32 v193, v192, v200
    v_fmac_f32 v193, v196, v204
    v_fmac_f32 v193, v197, v205
    v_fmac_f32 v193, v198, v206
    v_fmac_f32 v193, v199, v207
    v_cvt_pk_bf16_f32 v208, v212, v213
    v_cvt_pk_bf16_f32 v209, v214, v215
    v_cndmask_b32 v210, v210, v193, vcc
    s_mov_b32 exec_hi, 0
    buffer_store_dwordx4 v[208:211], v12, s[28:31], s92 offen sc1
    s_mov_b32 exec_hi, -1
    s_add_u32 s85, s91, 0
    buffer_load_dwordx4 v[112:115], v13, s[24:27], s85 offen offset:2048 nt
    s_add_u32 s85, s91, 16384
    buffer_load_dwordx4 v[116:119], v13, s[24:27], s85 offen offset:2048 nt
    s_add_u32 s85, s91, 32768
    buffer_load_dwordx4 v[120:123], v13, s[24:27], s85 offen offset:2048 nt
    s_add_u32 s85, s91, 49152
    buffer_load_dwordx4 v[124:127], v13, s[24:27], s85 offen offset:2048 nt
    s_setprio 2
    v_mov_b32 v84, s79
    s_waitcnt vmcnt(9)
    v_perm_b32 v224, v164, v160, s76
    v_perm_b32 v225, v172, v168, s76
    v_perm_b32 v226, v180, v176, s76
    v_perm_b32 v227, v188, v184, s76
    v_perm_b32 v228, v164, v160, s77
    v_perm_b32 v229, v172, v168, s77
    v_perm_b32 v230, v180, v176, s77
    v_perm_b32 v231, v188, v184, s77
    v_perm_b32 v232, v165, v161, s76
    v_perm_b32 v233, v173, v169, s76
    v_perm_b32 v234, v181, v177, s76
    v_perm_b32 v235, v189, v185, s76
    v_perm_b32 v236, v165, v161, s77
    v_perm_b32 v237, v173, v169, s77
    v_perm_b32 v238, v181, v177, s77
    v_perm_b32 v239, v189, v185, s77
    v_perm_b32 v240, v166, v162, s76
    v_perm_b32 v241, v174, v170, s76
    v_perm_b32 v242, v182, v178, s76
    v_perm_b32 v243, v190, v186, s76
    v_perm_b32 v244, v166, v162, s77
    v_perm_b32 v245, v174, v170, s77
    v_perm_b32 v246, v182, v178, s77
    v_perm_b32 v247, v190, v186, s77
    v_perm_b32 v248, v167, v163, s76
    v_perm_b32 v249, v175, v171, s76
    v_perm_b32 v250, v183, v179, s76
    v_perm_b32 v251, v191, v187, s76
    v_perm_b32 v252, v167, v163, s77
    v_perm_b32 v253, v175, v171, s77
    v_perm_b32 v254, v183, v179, s77
    v_perm_b32 v255, v191, v187, s77
    s_waitcnt vmcnt(0)
    v_perm_b32 v128, v100, v96, s76
    v_perm_b32 v129, v108, v104, s76
    v_perm_b32 v130, v116, v112, s76
    v_perm_b32 v131, v124, v120, s76
    v_perm_b32 v132, v100, v96, s77
    v_perm_b32 v133, v108, v104, s77
    v_perm_b32 v134, v116, v112, s77
    v_perm_b32 v135, v124, v120, s77
    v_perm_b32 v136, v101, v97, s76
    v_perm_b32 v137, v109, v105, s76
    v_perm_b32 v138, v117, v113, s76
    v_perm_b32 v139, v125, v121, s76
    v_perm_b32 v140, v101, v97, s77
    v_perm_b32 v141, v109, v105, s77
    v_perm_b32 v142, v117, v113, s77
    v_perm_b32 v143, v125, v121, s77
    v_perm_b32 v144, v102, v98, s76
    v_perm_b32 v145, v110, v106, s76
    v_perm_b32 v146, v118, v114, s76
    v_perm_b32 v147, v126, v122, s76
    v_perm_b32 v148, v102, v98, s77
    v_perm_b32 v149, v110, v106, s77
    v_perm_b32 v150, v118, v114, s77
    v_perm_b32 v151, v126, v122, s77
    v_perm_b32 v152, v103, v99, s76
    v_perm_b32 v153, v111, v107, s76
    v_perm_b32 v154, v119, v115, s76
    v_perm_b32 v155, v127, v123, s76
    v_perm_b32 v156, v103, v99, s77
    v_perm_b32 v157, v111, v107, s77
    v_perm_b32 v158, v119, v115, s77
    v_perm_b32 v159, v127, v123, s77
    s_mov_b32 s89, 0
L_ls65:
    ds_read_b32 v31, v10 offset:16
    s_waitcnt lgkmcnt(0)
    v_readfirstlane_b32 s88, v31
    s_add_u32 s89, s89, 1
    s_cmp_eq_u32 s88, 2
    s_cbranch_scc1 L_lsok66
    s_cmp_gt_u32 s89, 1000000
    s_cbranch_scc1 L_lsok66
    s_sleep 1
    s_branch L_ls65
L_lsok66:
    ds_read_b128 v[72:75], v2 offset:1024
    s_waitcnt lgkmcnt(0)
    v_mfma_f32_16x16x32_bf16 v[32:35], v[72:75], v[224:227], 0
    v_mfma_f32_16x16x32_bf16 v[36:39], v[72:75], v[228:231], 0
    v_mfma_f32_16x16x32_bf16 v[40:43], v[72:75], v[232:235], 0
    v_mfma_f32_16x16x32_bf16 v[44:47], v[72:75], v[236:239], 0
    v_mfma_f32_16x16x32_bf16 v[48:51], v[72:75], v[240:243], 0
    v_mfma_f32_16x16x32_bf16 v[52:55], v[72:75], v[244:247], 0
    v_mfma_f32_16x16x32_bf16 v[56:59], v[72:75], v[248:251], 0
    v_mfma_f32_16x16x32_bf16 v[60:63], v[72:75], v[252:255], 0
    s_barrier
    ds_read_b128 v[76:79], v2 offset:1152
    s_waitcnt lgkmcnt(0)
    v_mfma_f32_16x16x32_bf16 v[32:35], v[76:79], v[128:131], v[32:35]
    v_mfma_f32_16x16x32_bf16 v[48:51], v[76:79], v[144:147], v[48:51]
    v_mfma_f32_16x16x32_bf16 v[36:39], v[76:79], v[132:135], v[36:39]
    v_mfma_f32_16x16x32_bf16 v[52:55], v[76:79], v[148:151], v[52:55]
    v_mfma_f32_16x16x32_bf16 v[40:43], v[76:79], v[136:139], v[40:43]
    v_mfma_f32_16x16x32_bf16 v[56:59], v[76:79], v[152:155], v[56:59]
    v_mfma_f32_16x16x32_bf16 v[44:47], v[76:79], v[140:143], v[44:47]
    v_mfma_f32_16x16x32_bf16 v[60:63], v[76:79], v[156:159], v[60:63]
    s_nop 4
    v_cndmask_b32 v80, v32, v48, s[100:101]
    v_cndmask_b32 v81, v36, v52, s[100:101]
    v_cndmask_b32 v82, v40, v56, s[100:101]
    v_cndmask_b32 v83, v44, v60, s[100:101]
    v_perm_b32 v80, v80, v84, s4
    v_perm_b32 v81, v81, v84, s5
    v_perm_b32 v82, v82, v84, s6
    v_perm_b32 v83, v83, v84, s7
    buffer_store_dwordx4 v[80:83], v4, s[28:31], s98 offen sc1
    s_endpgm
L_roleO:
    s_lshl_b32 s84, s81, 3
    s_add_u32 s84, s84, s3
    s_lshl_b32 s84, s84, 13
    s_add_u32 s84, s84, s85
    s_add_u32 s84, s84, 0x700000
    s_mov_b32 s76, 0x05040100
    s_mov_b32 s77, 0x07060302
    s_mov_b32 s78, 0x3e0293ee
    s_mul_i32 s85, s3, 4224
    s_add_u32 s85, s85, 6656
    v_mul_u32_u24 v5, 528, v24
    v_lshl_add_u32 v5, v25, 7, v5
    v_add_u32 v5, s85, v5
    s_lshl_b32 s85, s3, 2
    v_lshlrev_b32 v6, 5, v24
    v_add_u32 v6, s85, v6
    v_and_b32 v26, 7, v24
    v_lshlrev_b32 v94, 5, v26
    v_mul_u32_u24 v7, 272, v26
    v_lshl_add_u32 v7, v25, 4, v7
    v_add_u32 v7, 2048, v7
    s_mul_i32 s85, s3, 528
    s_add_u32 s85, s85, 6656
    v_and_b32 v26, 31, v0
    v_lshlrev_b32 v8, 4, v26
    v_add_u32 v8, s85, v8
    s_lshl_b32 s85, s3, 5
    v_mov_b32 v9, s85
    v_lshrrev_b32 v26, 5, v0
    v_mul_u32_u24 v11, 272, v26
    v_and_b32 v26, 31, v0
    v_lshl_add_u32 v11, v26, 3, v11
    v_add_u32 v11, 2048, v11
    s_lshl_b32 s92, s80, 3
    s_add_u32 s92, s92, s3
    s_lshl_b32 s92, s92, 14
    s_add_u32 s92, s92, 0x100000
    s_lshl_b32 s86, s81, 7
    s_add_u32 s93, s92, s86
    s_add_u32 s94, s93, 65536
    s_lshl_b32 s86, s82, 7
    s_add_u32 s92, s92, s86
    s_add_u32 s92, s92, 0x100000
    s_waitcnt lgkmcnt(0)
    s_mov_b32 s32, s48
    s_mov_b32 s33, s49
    s_mov_b32 s34, 0x1000
    s_mov_b32 s35, 0x20000
    s_mov_b32 s36, s68
    s_mov_b32 s37, s69
    s_mov_b32 s38, 0x800
    s_mov_b32 s39, 0x20000
    s_mov_b32 s4, s60
    s_mov_b32 s5, s61
    s_mov_b32 s6, 0x4000000
    s_mov_b32 s7, 0x20000
    s_mov_b32 s8, s62
    s_mov_b32 s9, s63
    s_mov_b32 s10, 0x4000000
    s_mov_b32 s11, 0x20000
    s_mov_b32 s12, s50
    s_mov_b32 s13, s51
    s_mov_b32 s14, 0x4000000
    s_mov_b32 s15, 0x20000
    s_mov_b32 s16, s52
    s_mov_b32 s17, s53
    s_mov_b32 s18, 0x4000000
    s_mov_b32 s19, 0x20000
    s_mov_b32 s28, s74
    s_mov_b32 s29, s75
    s_mov_b32 s30, 0x1000000
    s_mov_b32 s31, 0x20000
    s_mov_b32 s44, s72
    s_mov_b32 s45, s73
    s_mov_b32 s46, 0x100
    s_mov_b32 s47, 0x20000
    s_mov_b32 s20, s56
    s_mov_b32 s21, s57
    s_mov_b32 s22, 0x800000
    s_mov_b32 s23, 0x20000
    s_mov_b32 s24, s66
    s_mov_b32 s25, s67
    s_mov_b32 s26, 0x800000
    s_mov_b32 s27, 0x20000
    s_barrier
    s_cmp_ge_u32 s3, 4
    s_cbranch_scc1 L_o_y
    s_and_b32 s86, s3, 1
    s_lshl_b32 s86, s86, 11
    v_lshlrev_b32 v12, 5, v0
    buffer_load_dwordx4 v[64:67], v12, s[32:35], s86 offen
    buffer_load_dwordx4 v[68:71], v12, s[32:35], s86 offen offset:16
    buffer_load_dwordx4 v[72:75], v12, s[36:39], 0 offen
    buffer_load_dwordx4 v[76:79], v12, s[36:39], 0 offen offset:16
    s_xor_b32 s98, s2, 16
    s_xor_b32 s87, s3, 0
    s_or_b32 s98, s98, s87
    s_cmp_lg_u32 s98, 0
    s_cbranch_scc1 L_non67
    s_setprio 3
    v_lshlrev_b32 v26, 8, v0
    v_mov_b32 v27, 0
    s_mov_b32 s98, 0x50000
    s_mov_b32 exec_hi, 0
    buffer_store_dword v27, v26, s[28:31], s98 offen sc1
    s_waitcnt vmcnt(0)
    s_or_b32 s98, s96, 1
    v_mov_b32 v26, s98
    s_mov_b64 exec, 1
    buffer_store_dword v26, off, s[44:47], 0 sc1
    s_mov_b64 exec, -1
    s_setprio 0
L_non67:
    s_waitcnt vmcnt(0)
    v_mov_b32 v24, 0
    s_mov_b32 s85, 0xffff0000
    v_lshlrev_b32 v25, 16, v64
    v_lshlrev_b32 v26, 16, v72
    v_and_b32 v27, s85, v64
    v_and_b32 v28, s85, v72
    v_mul_f32 v25, v25, v26
    v_mul_f32 v27, v27, v28
    v_cvt_pk_bf16_f32 v25, v25, v27
    v_lshlrev_b32 v26, 16, v25
    v_and_b32 v27, s85, v25
    v_add_f32 v24, v24, v26
    v_add_f32 v24, v24, v27
    v_lshlrev_b32 v25, 16, v65
    v_lshlrev_b32 v26, 16, v73
    v_and_b32 v27, s85, v65
    v_and_b32 v28, s85, v73
    v_mul_f32 v25, v25, v26
    v_mul_f32 v27, v27, v28
    v_cvt_pk_bf16_f32 v25, v25, v27
    v_lshlrev_b32 v26, 16, v25
    v_and_b32 v27, s85, v25
    v_add_f32 v24, v24, v26
    v_add_f32 v24, v24, v27
    v_lshlrev_b32 v25, 16, v66
    v_lshlrev_b32 v26, 16, v74
    v_and_b32 v27, s85, v66
    v_and_b32 v28, s85, v74
    v_mul_f32 v25, v25, v26
    v_mul_f32 v27, v27, v28
    v_cvt_pk_bf16_f32 v25, v25, v27
    v_lshlrev_b32 v26, 16, v25
    v_and_b32 v27, s85, v25
    v_add_f32 v24, v24, v26
    v_add_f32 v24, v24, v27
    v_lshlrev_b32 v25, 16, v67
    v_lshlrev_b32 v26, 16, v75
    v_and_b32 v27, s85, v67
    v_and_b32 v28, s85, v75
    v_mul_f32 v25, v25, v26
    v_mul_f32 v27, v27, v28
    v_cvt_pk_bf16_f32 v25, v25, v27
    v_lshlrev_b32 v26, 16, v25
    v_and_b32 v27, s85, v25
    v_add_f32 v24, v24, v26
    v_add_f32 v24, v24, v27
    v_lshlrev_b32 v25, 16, v68
    v_lshlrev_b32 v26, 16, v76
    v_and_b32 v27, s85, v68
    v_and_b32 v28, s85, v76
    v_mul_f32 v25, v25, v26
    v_mul_f32 v27, v27, v28
    v_cvt_pk_bf16_f32 v25, v25, v27
    v_lshlrev_b32 v26, 16, v25
    v_and_b32 v27, s85, v25
    v_add_f32 v24, v24, v26
    v_add_f32 v24, v24, v27
    v_lshlrev_b32 v25, 16, v69
    v_lshlrev_b32 v26, 16, v77
    v_and_b32 v27, s85, v69
    v_and_b32 v28, s85, v77
    v_mul_f32 v25, v25, v26
    v_mul_f32 v27, v27, v28
    v_cvt_pk_bf16_f32 v25, v25, v27
    v_lshlrev_b32 v26, 16, v25
    v_and_b32 v27, s85, v25
    v_add_f32 v24, v24, v26
    v_add_f32 v24, v24, v27
    v_lshlrev_b32 v25, 16, v70
    v_lshlrev_b32 v26, 16, v78
    v_and_b32 v27, s85, v70
    v_and_b32 v28, s85, v78
    v_mul_f32 v25, v25, v26
    v_mul_f32 v27, v27, v28
    v_cvt_pk_bf16_f32 v25, v25, v27
    v_lshlrev_b32 v26, 16, v25
    v_and_b32 v27, s85, v25
    v_add_f32 v24, v24, v26
    v_add_f32 v24, v24, v27
    v_lshlrev_b32 v25, 16, v71
    v_lshlrev_b32 v26, 16, v79
    v_and_b32 v27, s85, v71
    v_and_b32 v28, s85, v79
    v_mul_f32 v25, v25, v26
    v_mul_f32 v27, v27, v28
    v_cvt_pk_bf16_f32 v25, v25, v27
    v_lshlrev_b32 v26, 16, v25
    v_and_b32 v27, s85, v25
    v_add_f32 v24, v24, v26
    v_add_f32 v24, v24, v27
    s_nop 1
    v_add_f32_dpp v24, v24, v24 row_ror:1 row_mask:0xf bank_mask:0xf
    s_nop 1
    v_add_f32_dpp v24, v24, v24 row_ror:2 row_mask:0xf bank_mask:0xf
    s_nop 1
    v_add_f32_dpp v24, v24, v24 row_ror:4 row_mask:0xf bank_mask:0xf
    s_nop 1
    v_add_f32_dpp v24, v24, v24 row_ror:8 row_mask:0xf bank_mask:0xf
    v_mov_b32 v25, v24
    s_nop 1
    v_permlane16_swap_b32 v24, v25
    v_add_f32 v24, v24, v25
    v_mov_b32 v25, v24
    s_nop 1
    v_permlane32_swap_b32 v24, v25
    v_add_f32 v24, v24, v25
    v_cvt_pk_bf16_f32 v24, v24, v24
    v_lshlrev_b32 v24, 16, v24
    v_mul_f32 v24, 0xbfb8aa3b, v24
    v_exp_f32 v24, v24
    s_nop 0
    v_add_f32 v24, 1.0, v24
    v_rcp_f32 v24, v24
    s_nop 0
    v_cvt_pk_bf16_f32 v24, v24, v24
    v_lshlrev_b32 v14, 16, v24
    v_sub_f32 v24, 1.0, v14
    v_cvt_pk_bf16_f32 v24, v24, v24
    v_lshlrev_b32 v15, 16, v24
    s_add_u32 s85, s83, 0x0
    buffer_load_dwordx4 v[96:99], v1, s[4:7], s85 offen offset:0 nt
    buffer_load_dwordx4 v[100:103], v1, s[4:7], s85 offen offset:64 nt
    buffer_load_dwordx4 v[104:107], v1, s[4:7], s85 offen offset:128 nt
    buffer_load_dwordx4 v[108:111], v1, s[4:7], s85 offen offset:192 nt
    buffer_load_dwordx4 v[112:115], v2, s[4:7], s85 offen offset:0 nt
    buffer_load_dwordx4 v[116:119], v2, s[4:7], s85 offen offset:64 nt
    buffer_load_dwordx4 v[120:123], v2, s[4:7], s85 offen offset:128 nt
    buffer_load_dwordx4 v[124:127], v2, s[4:7], s85 offen offset:192 nt
    s_add_u32 s85, s83, 0x0
    buffer_load_dwordx4 v[128:131], v3, s[8:11], s85 offen offset:0 nt
    buffer_load_dwordx4 v[132:135], v3, s[8:11], s85 offen offset:1024 nt
    buffer_load_dwordx4 v[136:139], v3, s[8:11], s85 offen offset:2048 nt
    buffer_load_dwordx4 v[140:143], v3, s[8:11], s85 offen offset:3072 nt
    buffer_load_dwordx4 v[144:147], v4, s[8:11], s85 offen offset:0 nt
    buffer_load_dwordx4 v[148:151], v4, s[8:11], s85 offen offset:1024 nt
    buffer_load_dwordx4 v[152:155], v4, s[8:11], s85 offen offset:2048 nt
    buffer_load_dwordx4 v[156:159], v4, s[8:11], s85 offen offset:3072 nt
    s_add_u32 s85, s83, 0x200000
    buffer_load_dwordx4 v[160:163], v1, s[4:7], s85 offen offset:0 nt
    buffer_load_dwordx4 v[164:167], v1, s[4:7], s85 offen offset:64 nt
    buffer_load_dwordx4 v[168:171], v1, s[4:7], s85 offen offset:128 nt
    buffer_load_dwordx4 v[172:175], v1, s[4:7], s85 offen offset:192 nt
    buffer_load_dwordx4 v[176:179], v2, s[4:7], s85 offen offset:0 nt
    buffer_load_dwordx4 v[180:183], v2, s[4:7], s85 offen offset:64 nt
    buffer_load_dwordx4 v[184:187], v2, s[4:7], s85 offen offset:128 nt
    buffer_load_dwordx4 v[188:191], v2, s[4:7], s85 offen offset:192 nt
    s_add_u32 s85, s83, 0x200000
    buffer_load_dwordx4 v[192:195], v3, s[8:11], s85 offen offset:0 nt
    buffer_load_dwordx4 v[196:199], v3, s[8:11], s85 offen offset:1024 nt
    buffer_load_dwordx4 v[200:203], v3, s[8:11], s85 offen offset:2048 nt
    buffer_load_dwordx4 v[204:207], v3, s[8:11], s85 offen offset:3072 nt
    buffer_load_dwordx4 v[208:211], v4, s[8:11], s85 offen offset:0 nt
    buffer_load_dwordx4 v[212:215], v4, s[8:11], s85 offen offset:1024 nt
    buffer_load_dwordx4 v[216:219], v4, s[8:11], s85 offen offset:2048 nt
    buffer_load_dwordx4 v[220:223], v4, s[8:11], s85 offen offset:3072 nt
    s_add_u32 s85, s83, 0x400000
    buffer_load_dwordx4 v[224:227], v1, s[4:7], s85 offen offset:0 nt
    buffer_load_dwordx4 v[228:231], v1, s[4:7], s85 offen offset:64 nt
    buffer_load_dwordx4 v[232:235], v1, s[4:7], s85 offen offset:128 nt
    buffer_load_dwordx4 v[236:239], v1, s[4:7], s85 offen offset:192 nt
    buffer_load_dwordx4 v[240:243], v2, s[4:7], s85 offen offset:0 nt
    buffer_load_dwordx4 v[244:247], v2, s[4:7], s85 offen offset:64 nt
    buffer_load_dwordx4 v[248:251], v2, s[4:7], s85 offen offset:128 nt
    buffer_load_dwordx4 v[252:255], v2, s[4:7], s85 offen offset:192 nt
    s_mov_b32 s89, 0
L_ls68:
    ds_read_b32 v31, v10 offset:4
    s_waitcnt lgkmcnt(0)
    v_readfirstlane_b32 s88, v31
    s_add_u32 s89, s89, 1
    s_cmp_eq_u32 s88, 4
    s_cbranch_scc1 L_lsok69
    s_cmp_gt_u32 s89, 1000000
    s_cbranch_scc1 L_lsok69
    s_sleep 1
    s_branch L_ls68
L_lsok69:
    ds_read_b32 v31, v10 offset:8
    s_waitcnt lgkmcnt(0)
    v_readfirstlane_b32 s79, v31
    ds_read_b128 v[64:67], v7 offset:2176
    ds_read_b128 v[68:71], v7 offset:2240
    ds_read_b128 v[72:75], v7 offset:2304
    ds_read_b128 v[76:79], v7 offset:2368
    v_lshrrev_b32 v24, 3, v0
    v_lshlrev_b32 v12, 12, v24
    v_and_b32 v24, 7, v0
    v_lshl_add_u32 v12, v24, 4, v12
    s_waitcnt lgkmcnt(0)
    s_waitcnt vmcnt(32)
    v_mfma_f32_16x16x32_bf16 v[80:83], v[96:99], v[64:67], 0
    v_mfma_f32_16x16x32_bf16 v[84:87], v[112:115], v[64:67], 0
    v_mfma_f32_16x16x32_bf16 v[80:83], v[100:103], v[68:71], v[80:83]
    v_mfma_f32_16x16x32_bf16 v[84:87], v[116:119], v[68:71], v[84:87]
    v_mfma_f32_16x16x32_bf16 v[80:83], v[104:107], v[72:75], v[80:83]
    v_mfma_f32_16x16x32_bf16 v[84:87], v[120:123], v[72:75], v[84:87]
    v_mfma_f32_16x16x32_bf16 v[80:83], v[108:111], v[76:79], v[80:83]
    v_mfma_f32_16x16x32_bf16 v[84:87], v[124:127], v[76:79], v[84:87]
    s_add_u32 s85, s83, 0x400000
    buffer_load_dwordx4 v[96:99], v3, s[8:11], s85 offen offset:0 nt
    buffer_load_dwordx4 v[100:103], v3, s[8:11], s85 offen offset:1024 nt
    buffer_load_dwordx4 v[104:107], v3, s[8:11], s85 offen offset:2048 nt
    buffer_load_dwordx4 v[108:111], v3, s[8:11], s85 offen offset:3072 nt
    buffer_load_dwordx4 v[112:115], v4, s[8:11], s85 offen offset:0 nt
    buffer_load_dwordx4 v[116:119], v4, s[8:11], s85 offen offset:1024 nt
    buffer_load_dwordx4 v[120:123], v4, s[8:11], s85 offen offset:2048 nt
    buffer_load_dwordx4 v[124:127], v4, s[8:11], s85 offen offset:3072 nt
    v_max3_f32 v24, v80, v81, v82
    v_max3_f32 v24, v24, v83, v84
    v_max3_f32 v24, v24, v85, v86
    v_max_f32 v24, v24, v87
    v_mov_b32 v25, v24
    s_nop 1
    v_permlane16_swap_b32 v24, v25
    v_max_f32 v24, v24, v25
    v_mov_b32 v25, v24
    s_nop 1
    v_permlane32_swap_b32 v24, v25
    v_max_f32 v24, v24, v25
    v_mul_f32 v26, s78, v24
    v_mov_b32 v92, v24
    v_fma_f32 v80, v80, s78, -v26
    v_fma_f32 v81, v81, s78, -v26
    v_fma_f32 v82, v82, s78, -v26
    v_fma_f32 v83, v83, s78, -v26
    v_fma_f32 v84, v84, s78, -v26
    v_fma_f32 v85, v85, s78, -v26
    v_fma_f32 v86, v86, s78, -v26
    v_fma_f32 v87, v87, s78, -v26
    v_exp_f32 v80, v80
    v_exp_f32 v81, v81
    v_exp_f32 v82, v82
    v_exp_f32 v83, v83
    v_exp_f32 v84, v84
    v_exp_f32 v85, v85
    v_exp_f32 v86, v86
    v_exp_f32 v87, v87
    s_nop 0
    v_add_f32 v24, v80, v81
    v_add_f32 v25, v82, v83
    v_add_f32 v24, v24, v84
    v_add_f32 v25, v25, v85
    v_add_f32 v24, v24, v86
    v_add_f32 v25, v25, v87
    v_cvt_pk_bf16_f32 v88, v80, v81
    v_cvt_pk_bf16_f32 v89, v82, v83
    v_cvt_pk_bf16_f32 v90, v84, v85
    v_cvt_pk_bf16_f32 v91, v86, v87
    v_add_f32 v24, v24, v25
    v_mov_b32 v93, v24
    s_waitcnt vmcnt(32)
    v_perm_b32 v16, v132, v128, s76
    v_perm_b32 v17, v140, v136, s76
    v_perm_b32 v18, v148, v144, s76
    v_perm_b32 v19, v156, v152, s76
    v_perm_b32 v20, v132, v128, s77
    v_perm_b32 v21, v140, v136, s77
    v_perm_b32 v22, v148, v144, s77
    v_perm_b32 v23, v156, v152, s77
    v_mfma_f32_16x16x32_bf16 v[32:35], v[16:19], v[88:91], 0
    v_perm_b32 v16, v133, v129, s76
    v_perm_b32 v17, v141, v137, s76
    v_perm_b32 v18, v149, v145, s76
    v_perm_b32 v19, v157, v153, s76
    v_mfma_f32_16x16x32_bf16 v[36:39], v[20:23], v[88:91], 0
    v_perm_b32 v20, v133, v129, s77
    v_perm_b32 v21, v141, v137, s77
    v_perm_b32 v22, v149, v145, s77
    v_perm_b32 v23, v157, v153, s77
    v_mfma_f32_16x16x32_bf16 v[40:43], v[16:19], v[88:91], 0
    v_perm_b32 v16, v134, v130, s76
    v_perm_b32 v17, v142, v138, s76
    v_perm_b32 v18, v150, v146, s76
    v_perm_b32 v19, v158, v154, s76
    v_mfma_f32_16x16x32_bf16 v[44:47], v[20:23], v[88:91], 0
    v_perm_b32 v20, v134, v130, s77
    v_perm_b32 v21, v142, v138, s77
    v_perm_b32 v22, v150, v146, s77
    v_perm_b32 v23, v158, v154, s77
    v_mfma_f32_16x16x32_bf16 v[48:51], v[16:19], v[88:91], 0
    v_perm_b32 v16, v135, v131, s76
    v_perm_b32 v17, v143, v139, s76
    v_perm_b32 v18, v151, v147, s76
    v_perm_b32 v19, v159, v155, s76
    v_mfma_f32_16x16x32_bf16 v[52:55], v[20:23], v[88:91], 0
    v_perm_b32 v20, v135, v131, s77
    v_perm_b32 v21, v143, v139, s77
    v_perm_b32 v22, v151, v147, s77
    v_perm_b32 v23, v159, v155, s77
    v_mfma_f32_16x16x32_bf16 v[56:59], v[16:19], v[88:91], 0
    s_nop 0
    v_mfma_f32_16x16x32_bf16 v[60:63], v[20:23], v[88:91], 0
    buffer_load_dwordx4 v[128:131], v1, s[12:15], s84 offen offset:0 nt
    buffer_load_dwordx4 v[132:135], v1, s[12:15], s84 offen offset:64 nt
    buffer_load_dwordx4 v[136:139], v1, s[12:15], s84 offen offset:128 nt
    buffer_load_dwordx4 v[140:143], v1, s[12:15], s84 offen offset:192 nt
    buffer_load_dwordx4 v[144:147], v2, s[12:15], s84 offen offset:0 nt
    buffer_load_dwordx4 v[148:151], v2, s[12:15], s84 offen offset:64 nt
    buffer_load_dwordx4 v[152:155], v2, s[12:15], s84 offen offset:128 nt
    buffer_load_dwordx4 v[156:159], v2, s[12:15], s84 offen offset:192 nt
    s_waitcnt vmcnt(32)
    v_mfma_f32_16x16x32_bf16 v[80:83], v[160:163], v[64:67], 0
    v_mfma_f32_16x16x32_bf16 v[84:87], v[176:179], v[64:67], 0
    v_mfma_f32_16x16x32_bf16 v[80:83], v[164:167], v[68:71], v[80:83]
    v_mfma_f32_16x16x32_bf16 v[84:87], v[180:183], v[68:71], v[84:87]
    v_mfma_f32_16x16x32_bf16 v[80:83], v[168:171], v[72:75], v[80:83]
    v_mfma_f32_16x16x32_bf16 v[84:87], v[184:187], v[72:75], v[84:87]
    v_mfma_f32_16x16x32_bf16 v[80:83], v[172:175], v[76:79], v[80:83]
    v_mfma_f32_16x16x32_bf16 v[84:87], v[188:191], v[76:79], v[84:87]
    buffer_load_dwordx4 v[160:163], v3, s[16:19], s84 offen offset:0 nt
    buffer_load_dwordx4 v[164:167], v3, s[16:19], s84 offen offset:1024 nt
    buffer_load_dwordx4 v[168:171], v3, s[16:19], s84 offen offset:2048 nt
    buffer_load_dwordx4 v[172:175], v3, s[16:19], s84 offen offset:3072 nt
    buffer_load_dwordx4 v[176:179], v4, s[16:19], s84 offen offset:0 nt
    buffer_load_dwordx4 v[180:183], v4, s[16:19], s84 offen offset:1024 nt
    buffer_load_dwordx4 v[184:187], v4, s[16:19], s84 offen offset:2048 nt
    buffer_load_dwordx4 v[188:191], v4, s[16:19], s84 offen offset:3072 nt
    v_max3_f32 v24, v80, v81, v82
    v_max3_f32 v24, v24, v83, v84
    v_max3_f32 v24, v24, v85, v86
    v_max3_f32 v24, v24, v87, v92
    v_mov_b32 v25, v24
    s_nop 1
    v_permlane16_swap_b32 v24, v25
    v_max_f32 v24, v24, v25
    v_mov_b32 v25, v24
    s_nop 1
    v_permlane32_swap_b32 v24, v25
    v_max_f32 v24, v24, v25
    v_mul_f32 v26, s78, v24
    v_fma_f32 v28, v92, s78, -v26
    v_exp_f32 v28, v28
    v_mov_b32 v92, v24
    v_fma_f32 v80, v80, s78, -v26
    v_fma_f32 v81, v81, s78, -v26
    v_fma_f32 v82, v82, s78, -v26
    v_fma_f32 v83, v83, s78, -v26
    v_fma_f32 v84, v84, s78, -v26
    v_fma_f32 v85, v85, s78, -v26
    v_fma_f32 v86, v86, s78, -v26
    v_fma_f32 v87, v87, s78, -v26
    v_exp_f32 v80, v80
    v_exp_f32 v81, v81
    v_exp_f32 v82, v82
    v_exp_f32 v83, v83
    v_exp_f32 v84, v84
    v_exp_f32 v85, v85
    v_exp_f32 v86, v86
    v_exp_f32 v87, v87
    v_pk_mul_f32 v[32:33], v[32:33], v[28:29] op_sel_hi:[1,0]
    v_pk_mul_f32 v[34:35], v[34:35], v[28:29] op_sel_hi:[1,0]
    v_pk_mul_f32 v[36:37], v[36:37], v[28:29] op_sel_hi:[1,0]
    v_pk_mul_f32 v[38:39], v[38:39], v[28:29] op_sel_hi:[1,0]
    v_pk_mul_f32 v[40:41], v[40:41], v[28:29] op_sel_hi:[1,0]
    v_pk_mul_f32 v[42:43], v[42:43], v[28:29] op_sel_hi:[1,0]
    v_pk_mul_f32 v[44:45], v[44:45], v[28:29] op_sel_hi:[1,0]
    v_pk_mul_f32 v[46:47], v[46:47], v[28:29] op_sel_hi:[1,0]
    v_pk_mul_f32 v[48:49], v[48:49], v[28:29] op_sel_hi:[1,0]
    v_pk_mul_f32 v[50:51], v[50:51], v[28:29] op_sel_hi:[1,0]
    v_pk_mul_f32 v[52:53], v[52:53], v[28:29] op_sel_hi:[1,0]
    v_pk_mul_f32 v[54:55], v[54:55], v[28:29] op_sel_hi:[1,0]
    v_pk_mul_f32 v[56:57], v[56:57], v[28:29] op_sel_hi:[1,0]
    v_pk_mul_f32 v[58:59], v[58:59], v[28:29] op_sel_hi:[1,0]
    v_pk_mul_f32 v[60:61], v[60:61], v[28:29] op_sel_hi:[1,0]
    v_pk_mul_f32 v[62:63], v[62:63], v[28:29] op_sel_hi:[1,0]
    v_add_f32 v24, v80, v81
    v_add_f32 v25, v82, v83
    v_add_f32 v24, v24, v84
    v_add_f32 v25, v25, v85
    v_add_f32 v24, v24, v86
    v_add_f32 v25, v25, v87
    v_cvt_pk_bf16_f32 v88, v80, v81
    v_cvt_pk_bf16_f32 v89, v82, v83
    v_cvt_pk_bf16_f32 v90, v84, v85
    v_cvt_pk_bf16_f32 v91, v86, v87
    v_add_f32 v24, v24, v25
    v_fma_f32 v93, v93, v28, v24
    s_waitcnt vmcnt(32)
    v_perm_b32 v16, v196, v192, s76
    v_perm_b32 v17, v204, v200, s76
    v_perm_b32 v18, v212, v208, s76
    v_perm_b32 v19, v220, v216, s76
    v_perm_b32 v20, v196, v192, s77
    v_perm_b32 v21, v204, v200, s77
    v_perm_b32 v22, v212, v208, s77
    v_perm_b32 v23, v220, v216, s77
    v_mfma_f32_16x16x32_bf16 v[32:35], v[16:19], v[88:91], v[32:35]
    v_perm_b32 v16, v197, v193, s76
    v_perm_b32 v17, v205, v201, s76
    v_perm_b32 v18, v213, v209, s76
    v_perm_b32 v19, v221, v217, s76
    v_mfma_f32_16x16x32_bf16 v[36:39], v[20:23], v[88:91], v[36:39]
    v_perm_b32 v20, v197, v193, s77
    v_perm_b32 v21, v205, v201, s77
    v_perm_b32 v22, v213, v209, s77
    v_perm_b32 v23, v221, v217, s77
    v_mfma_f32_16x16x32_bf16 v[40:43], v[16:19], v[88:91], v[40:43]
    v_perm_b32 v16, v198, v194, s76
    v_perm_b32 v17, v206, v202, s76
    v_perm_b32 v18, v214, v210, s76
    v_perm_b32 v19, v222, v218, s76
    v_mfma_f32_16x16x32_bf16 v[44:47], v[20:23], v[88:91], v[44:47]
    v_perm_b32 v20, v198, v194, s77
    v_perm_b32 v21, v206, v202, s77
    v_perm_b32 v22, v214, v210, s77
    v_perm_b32 v23, v222, v218, s77
    v_mfma_f32_16x16x32_bf16 v[48:51], v[16:19], v[88:91], v[48:51]
    v_perm_b32 v16, v199, v195, s76
    v_perm_b32 v17, v207, v203, s76
    v_perm_b32 v18, v215, v211, s76
    v_perm_b32 v19, v223, v219, s76
    v_mfma_f32_16x16x32_bf16 v[52:55], v[20:23], v[88:91], v[52:55]
    v_perm_b32 v20, v199, v195, s77
    v_perm_b32 v21, v207, v203, s77
    v_perm_b32 v22, v215, v211, s77
    v_perm_b32 v23, v223, v219, s77
    v_mfma_f32_16x16x32_bf16 v[56:59], v[16:19], v[88:91], v[56:59]
    s_nop 0
    v_mfma_f32_16x16x32_bf16 v[60:63], v[20:23], v[88:91], v[60:63]
    s_add_u32 s85, s83, 0x600000
    buffer_load_dwordx4 v[192:195], v1, s[4:7], s85 offen offset:0 nt
    buffer_load_dwordx4 v[196:199], v1, s[4:7], s85 offen offset:64 nt
    buffer_load_dwordx4 v[200:203], v1, s[4:7], s85 offen offset:128 nt
    buffer_load_dwordx4 v[204:207], v1, s[4:7], s85 offen offset:192 nt
    buffer_load_dwordx4 v[208:211], v2, s[4:7], s85 offen offset:0 nt
    buffer_load_dwordx4 v[212:215], v2, s[4:7], s85 offen offset:64 nt
    buffer_load_dwordx4 v[216:219], v2, s[4:7], s85 offen offset:128 nt
    buffer_load_dwordx4 v[220:223], v2, s[4:7], s85 offen offset:192 nt
    s_waitcnt vmcnt(32)
    v_mfma_f32_16x16x32_bf16 v[80:83], v[224:227], v[64:67], 0
    v_mfma_f32_16x16x32_bf16 v[84:87], v[240:243], v[64:67], 0
    v_mfma_f32_16x16x32_bf16 v[80:83], v[228:231], v[68:71], v[80:83]
    v_mfma_f32_16x16x32_bf16 v[84:87], v[244:247], v[68:71], v[84:87]
    v_mfma_f32_16x16x32_bf16 v[80:83], v[232:235], v[72:75], v[80:83]
    v_mfma_f32_16x16x32_bf16 v[84:87], v[248:251], v[72:75], v[84:87]
    v_mfma_f32_16x16x32_bf16 v[80:83], v[236:239], v[76:79], v[80:83]
    v_mfma_f32_16x16x32_bf16 v[84:87], v[252:255], v[76:79], v[84:87]
    s_add_u32 s85, s83, 0x600000
    buffer_load_dwordx4 v[224:227], v3, s[8:11], s85 offen offset:0 nt
    buffer_load_dwordx4 v[228:231], v3, s[8:11], s85 offen offset:1024 nt
    buffer_load_dwordx4 v[232:235], v3, s[8:11], s85 offen offset:2048 nt
    buffer_load_dwordx4 v[236:239], v3, s[8:11], s85 offen offset:3072 nt
    buffer_load_dwordx4 v[240:243], v4, s[8:11], s85 offen offset:0 nt
    buffer_load_dwordx4 v[244:247], v4, s[8:11], s85 offen offset:1024 nt
    buffer_load_dwordx4 v[248:251], v4, s[8:11], s85 offen offset:2048 nt
    buffer_load_dwordx4 v[252:255], v4, s[8:11], s85 offen offset:3072 nt
    v_max3_f32 v24, v80, v81, v82
    v_max3_f32 v24, v24, v83, v84
    v_max3_f32 v24, v24, v85, v86
    v_max3_f32 v24, v24, v87, v92
    v_mov_b32 v25, v24
    s_nop 1
    v_permlane16_swap_b32 v24, v25
    v_max_f32 v24, v24, v25
    v_mov_b32 v25, v24
    s_nop 1
    v_permlane32_swap_b32 v24, v25
    v_max_f32 v24, v24, v25
    v_mul_f32 v26, s78, v24
    v_fma_f32 v28, v92, s78, -v26
    v_exp_f32 v28, v28
    v_mov_b32 v92, v24
    v_fma_f32 v80, v80, s78, -v26
    v_fma_f32 v81, v81, s78, -v26
    v_fma_f32 v82, v82, s78, -v26
    v_fma_f32 v83, v83, s78, -v26
    v_fma_f32 v84, v84, s78, -v26
    v_fma_f32 v85, v85, s78, -v26
    v_fma_f32 v86, v86, s78, -v26
    v_fma_f32 v87, v87, s78, -v26
    v_exp_f32 v80, v80
    v_exp_f32 v81, v81
    v_exp_f32 v82, v82
    v_exp_f32 v83, v83
    v_exp_f32 v84, v84
    v_exp_f32 v85, v85
    v_exp_f32 v86, v86
    v_exp_f32 v87, v87
    v_pk_mul_f32 v[32:33], v[32:33], v[28:29] op_sel_hi:[1,0]
    v_pk_mul_f32 v[34:35], v[34:35], v[28:29] op_sel_hi:[1,0]
    v_pk_mul_f32 v[36:37], v[36:37], v[28:29] op_sel_hi:[1,0]
    v_pk_mul_f32 v[38:39], v[38:39], v[28:29] op_sel_hi:[1,0]
    v_pk_mul_f32 v[40:41], v[40:41], v[28:29] op_sel_hi:[1,0]
    v_pk_mul_f32 v[42:43], v[42:43], v[28:29] op_sel_hi:[1,0]
    v_pk_mul_f32 v[44:45], v[44:45], v[28:29] op_sel_hi:[1,0]
    v_pk_mul_f32 v[46:47], v[46:47], v[28:29] op_sel_hi:[1,0]
    v_pk_mul_f32 v[48:49], v[48:49], v[28:29] op_sel_hi:[1,0]
    v_pk_mul_f32 v[50:51], v[50:51], v[28:29] op_sel_hi:[1,0]
    v_pk_mul_f32 v[52:53], v[52:53], v[28:29] op_sel_hi:[1,0]
    v_pk_mul_f32 v[54:55], v[54:55], v[28:29] op_sel_hi:[1,0]
    v_pk_mul_f32 v[56:57], v[56:57], v[28:29] op_sel_hi:[1,0]
    v_pk_mul_f32 v[58:59], v[58:59], v[28:29] op_sel_hi:[1,0]
    v_pk_mul_f32 v[60:61], v[60:61], v[28:29] op_sel_hi:[1,0]
    v_pk_mul_f32 v[62:63], v[62:63], v[28:29] op_sel_hi:[1,0]
    v_add_f32 v24, v80, v81
    v_add_f32 v25, v82, v83
    v_add_f32 v24, v24, v84
    v_add_f32 v25, v25, v85
    v_add_f32 v24, v24, v86
    v_add_f32 v25, v25, v87
    v_cvt_pk_bf16_f32 v88, v80, v81
    v_cvt_pk_bf16_f32 v89, v82, v83
    v_cvt_pk_bf16_f32 v90, v84, v85
    v_cvt_pk_bf16_f32 v91, v86, v87
    v_add_f32 v24, v24, v25
    v_fma_f32 v93, v93, v28, v24
    s_waitcnt vmcnt(32)
    v_perm_b32 v16, v100, v96, s76
    v_perm_b32 v17, v108, v104, s76
    v_perm_b32 v18, v116, v112, s76
    v_perm_b32 v19, v124, v120, s76
    v_perm_b32 v20, v100, v96, s77
    v_perm_b32 v21, v108, v104, s77
    v_perm_b32 v22, v116, v112, s77
    v_perm_b32 v23, v124, v120, s77
    v_mfma_f32_16x16x32_bf16 v[32:35], v[16:19], v[88:91], v[32:35]
    v_perm_b32 v16, v101, v97, s76
    v_perm_b32 v17, v109, v105, s76
    v_perm_b32 v18, v117, v113, s76
    v_perm_b32 v19, v125, v121, s76
    v_mfma_f32_16x16x32_bf16 v[36:39], v[20:23], v[88:91], v[36:39]
    v_perm_b32 v20, v101, v97, s77
    v_perm_b32 v21, v109, v105, s77
    v_perm_b32 v22, v117, v113, s77
    v_perm_b32 v23, v125, v121, s77
    v_mfma_f32_16x16x32_bf16 v[40:43], v[16:19], v[88:91], v[40:43]
    v_perm_b32 v16, v102, v98, s76
    v_perm_b32 v17, v110, v106, s76
    v_perm_b32 v18, v118, v114, s76
    v_perm_b32 v19, v126, v122, s76
    v_mfma_f32_16x16x32_bf16 v[44:47], v[20:23], v[88:91], v[44:47]
    v_perm_b32 v20, v102, v98, s77
    v_perm_b32 v21, v110, v106, s77
    v_perm_b32 v22, v118, v114, s77
    v_perm_b32 v23, v126, v122, s77
    v_mfma_f32_16x16x32_bf16 v[48:51], v[16:19], v[88:91], v[48:51]
    v_perm_b32 v16, v103, v99, s76
    v_perm_b32 v17, v111, v107, s76
    v_perm_b32 v18, v119, v115, s76
    v_perm_b32 v19, v127, v123, s76
    v_mfma_f32_16x16x32_bf16 v[52:55], v[20:23], v[88:91], v[52:55]
    v_perm_b32 v20, v103, v99, s77
    v_perm_b32 v21, v111, v107, s77
    v_perm_b32 v22, v119, v115, s77
    v_perm_b32 v23, v127, v123, s77
    v_mfma_f32_16x16x32_bf16 v[56:59], v[16:19], v[88:91], v[56:59]
    s_nop 0
    v_mfma_f32_16x16x32_bf16 v[60:63], v[20:23], v[88:91], v[60:63]
    ds_read_b128 v[64:67], v7 offset:0
    ds_read_b128 v[68:71], v7 offset:64
    ds_read_b128 v[72:75], v7 offset:128
    ds_read_b128 v[76:79], v7 offset:192
    s_waitcnt vmcnt(24)
    s_waitcnt lgkmcnt(0)
    v_mfma_f32_16x16x32_bf16 v[80:83], v[128:131], v[64:67], 0
    v_mfma_f32_16x16x32_bf16 v[84:87], v[144:147], v[64:67], 0
    v_mfma_f32_16x16x32_bf16 v[80:83], v[132:135], v[68:71], v[80:83]
    v_mfma_f32_16x16x32_bf16 v[84:87], v[148:151], v[68:71], v[84:87]
    v_mfma_f32_16x16x32_bf16 v[80:83], v[136:139], v[72:75], v[80:83]
    v_mfma_f32_16x16x32_bf16 v[84:87], v[152:155], v[72:75], v[84:87]
    v_mfma_f32_16x16x32_bf16 v[80:83], v[140:143], v[76:79], v[80:83]
    v_mfma_f32_16x16x32_bf16 v[84:87], v[156:159], v[76:79], v[84:87]
    ds_read_b128 v[64:67], v7 offset:2176
    ds_read_b128 v[68:71], v7 offset:2240
    ds_read_b128 v[72:75], v7 offset:2304
    ds_read_b128 v[76:79], v7 offset:2368
    s_nop 3
    v_max3_f32 v24, v80, v81, v82
    v_max3_f32 v24, v24, v83, v84
    v_max3_f32 v24, v24, v85, v86
    v_max_f32 v24, v24, v87
    v_mov_b32 v25, v24
    s_nop 1
    v_permlane16_swap_b32 v24, v25
    v_max_f32 v24, v24, v25
    v_mov_b32 v25, v24
    s_nop 1
    v_permlane32_swap_b32 v24, v25
    v_max_f32 v24, v24, v25
    v_mul_f32 v26, s78, v24
    v_mov_b32 v29, v24
    v_fma_f32 v80, v80, s78, -v26
    v_fma_f32 v81, v81, s78, -v26
    v_fma_f32 v82, v82, s78, -v26
    v_fma_f32 v83, v83, s78, -v26
    v_fma_f32 v84, v84, s78, -v26
    v_fma_f32 v85, v85, s78, -v26
    v_fma_f32 v86, v86, s78, -v26
    v_fma_f32 v87, v87, s78, -v26
    v_exp_f32 v80, v80
    v_exp_f32 v81, v81
    v_exp_f32 v82, v82
    v_exp_f32 v83, v83
    v_exp_f32 v84, v84
    v_exp_f32 v85, v85
    v_exp_f32 v86, v86
    v_exp_f32 v87, v87
    s_nop 0
    v_add_f32 v24, v80, v81
    v_add_f32 v25, v82, v83
    v_add_f32 v24, v24, v84
    v_add_f32 v25, v25, v85
    v_add_f32 v24, v24, v86
    v_add_f32 v25, v25, v87
    v_cvt_pk_bf16_f32 v88, v80, v81
    v_cvt_pk_bf16_f32 v89, v82, v83
    v_cvt_pk_bf16_f32 v90, v84, v85
    v_cvt_pk_bf16_f32 v91, v86, v87
    v_add_f32 v24, v24, v25
    v_mov_b32 v30, v24
    v_mov_b32 v25, v30
    s_nop 1
    v_permlane16_swap_b32 v30, v25
    v_add_f32 v30, v30, v25
    v_mov_b32 v25, v30
    s_nop 1
    v_permlane32_swap_b32 v30, v25
    v_add_f32 v30, v30, v25
    s_mov_b64 exec, 0xff
    ds_write_b32 v6, v29 offset:0
    ds_write_b32 v6, v30 offset:512
    s_mov_b64 exec, -1
    s_waitcnt vmcnt(16)
    v_perm_b32 v16, v164, v160, s76
    v_perm_b32 v17, v172, v168, s76
    v_perm_b32 v18, v180, v176, s76
    v_perm_b32 v19, v188, v184, s76
    v_perm_b32 v20, v164, v160, s77
    v_perm_b32 v21, v172, v168, s77
    v_perm_b32 v22, v180, v176, s77
    v_perm_b32 v23, v188, v184, s77
    v_mfma_f32_16x16x32_bf16 v[128:131], v[16:19], v[88:91], 0
    v_perm_b32 v16, v165, v161, s76
    v_perm_b32 v17, v173, v169, s76
    v_perm_b32 v18, v181, v177, s76
    v_perm_b32 v19, v189, v185, s76
    v_mfma_f32_16x16x32_bf16 v[132:135], v[20:23], v[88:91], 0
    v_perm_b32 v20, v165, v161, s77
    v_perm_b32 v21, v173, v169, s77
    v_perm_b32 v22, v181, v177, s77
    v_perm_b32 v23, v189, v185, s77
    v_mfma_f32_16x16x32_bf16 v[136:139], v[16:19], v[88:91], 0
    v_perm_b32 v16, v166, v162, s76
    v_perm_b32 v17, v174, v170, s76
    v_perm_b32 v18, v182, v178, s76
    v_perm_b32 v19, v190, v186, s76
    v_mfma_f32_16x16x32_bf16 v[140:143], v[20:23], v[88:91], 0
    v_perm_b32 v20, v166, v162, s77
    v_perm_b32 v21, v174, v170, s77
    v_perm_b32 v22, v182, v178, s77
    v_perm_b32 v23, v190, v186, s77
    v_mfma_f32_16x16x32_bf16 v[144:147], v[16:19], v[88:91], 0
    v_perm_b32 v16, v167, v163, s76
    v_perm_b32 v17, v175, v171, s76
    v_perm_b32 v18, v183, v179, s76
    v_perm_b32 v19, v191, v187, s76
    v_mfma_f32_16x16x32_bf16 v[148:151], v[20:23], v[88:91], 0
    v_perm_b32 v20, v167, v163, s77
    v_perm_b32 v21, v175, v171, s77
    v_perm_b32 v22, v183, v179, s77
    v_perm_b32 v23, v191, v187, s77
    v_mfma_f32_16x16x32_bf16 v[152:155], v[16:19], v[88:91], 0
    s_nop 0
    v_mfma_f32_16x16x32_bf16 v[156:159], v[20:23], v[88:91], 0
    s_nop 3
    s_mov_b32 exec_lo, 0x00ff00ff
    s_mov_b32 exec_hi, 0x00ff00ff
    ds_write_b128 v5, v[128:131] offset:0
    ds_write_b128 v5, v[132:135] offset:16
    ds_write_b128 v5, v[136:139] offset:32
    ds_write_b128 v5, v[140:143] offset:48
    ds_write_b128 v5, v[144:147] offset:64
    ds_write_b128 v5, v[148:151] offset:80
    ds_write_b128 v5, v[152:155] offset:96
    ds_write_b128 v5, v[156:159] offset:112
    s_mov_b64 exec, -1
    v_mov_b32 v25, 1
    s_mov_b64 exec, 1
    ds_add_u32 v10, v25 offset:12
    s_mov_b64 exec, -1
    s_waitcnt lgkmcnt(0)
    s_and_b32 s85, s3, 1
    s_lshl_b32 s85, s85, 2
    s_lshr_b32 s86, s90, 5
    s_add_u32 s85, s85, s86
    s_lshl_b32 s72, s85, 17
    s_and_b32 s86, s90, 31
    s_lshl_b32 s86, s86, 12
    s_add_u32 s72, s72, s86
    s_add_u32 s72, s72, 0x100000
    s_and_b32 s85, s3, 1
    s_lshl_b32 s85, s85, 6
    v_and_b32 v26, 7, v0
    v_lshlrev_b32 v1, 3, v26
    v_lshrrev_b32 v26, 4, v0
    v_lshl_add_u32 v1, v26, 1, v1
    v_add_u32 v1, s85, v1
    s_mov_b32 s89, 0
L_ls70:
    ds_read_b32 v31, v10 offset:12
    s_waitcnt lgkmcnt(0)
    v_readfirstlane_b32 s88, v31
    s_add_u32 s89, s89, 1
    s_cmp_eq_u32 s88, 8
    s_cbranch_scc1 L_lsok71
    s_cmp_gt_u32 s89, 1000000
    s_cbranch_scc1 L_lsok71
    s_sleep 1
    s_branch L_ls70
L_lsok71:
    ds_read_b128 v[80:83], v9 offset:0
    ds_read_b128 v[84:87], v9 offset:16
    ds_read_b128 v[16:19], v9 offset:512
    ds_read_b128 v[20:23], v9 offset:528
    ds_read_b128 v[96:99], v8 offset:0
    ds_read_b128 v[100:103], v8 offset:4224
    ds_read_b128 v[104:107], v8 offset:8448
    ds_read_b128 v[108:111], v8 offset:12672
    v_mov_b32 v123, s79
    v_and_b32 v113, 1, v0
    v_cmp_eq_u32 vcc, 1, v113
    s_waitcnt lgkmcnt(6)
    v_max3_f32 v112, v80, v81, v82
    v_max_f32 v112, v112, v83
    v_max3_f32 v112, v112, v84, v85
    v_max3_f32 v112, v112, v86, v87
    v_mul_f32 v26, s78, v112
    v_fma_f32 v80, v80, s78, -v26
    v_fma_f32 v81, v81, s78, -v26
    v_fma_f32 v82, v82, s78, -v26
    v_fma_f32 v83, v83, s78, -v26
    v_fma_f32 v84, v84, s78, -v26
    v_fma_f32 v85, v85, s78, -v26
    v_fma_f32 v86, v86, s78, -v26
    v_fma_f32 v87, v87, s78, -v26
    v_exp_f32 v80, v80
    v_exp_f32 v81, v81
    v_exp_f32 v82, v82
    v_exp_f32 v83, v83
    v_exp_f32 v84, v84
    v_exp_f32 v85, v85
    v_exp_f32 v86, v86
    v_exp_f32 v87, v87
    s_waitcnt lgkmcnt(0)
    v_mul_f32 v116, v80, v96
    v_mul_f32 v117, v80, v97
    v_mul_f32 v118, v80, v98
    v_mul_f32 v119, v80, v99
    v_mul_f32 v114, v80, v16
    v_fmac_f32 v116, v81, v100
    v_fmac_f32 v117, v81, v101
    v_fmac_f32 v118, v81, v102
    v_fmac_f32 v119, v81, v103
    v_fmac_f32 v114, v81, v17
    v_fmac_f32 v116, v82, v104
    v_fmac_f32 v117, v82, v105
    v_fmac_f32 v118, v82, v106
    v_fmac_f32 v119, v82, v107
    v_fmac_f32 v114, v82, v18
    v_fmac_f32 v116, v83, v108
    v_fmac_f32 v117, v83, v109
    v_fmac_f32 v118, v83, v110
    v_fmac_f32 v119, v83, v111
    v_fmac_f32 v114, v83, v19
    ds_read_b128 v[96:99], v8 offset:16896
    ds_read_b128 v[100:103], v8 offset:21120
    ds_read_b128 v[104:107], v8 offset:25344
    ds_read_b128 v[108:111], v8 offset:29568
    s_waitcnt lgkmcnt(0)
    v_fmac_f32 v116, v84, v96
    v_fmac_f32 v117, v84, v97
    v_fmac_f32 v118, v84, v98
    v_fmac_f32 v119, v84, v99
    v_fmac_f32 v114, v84, v20
    v_fmac_f32 v116, v85, v100
    v_fmac_f32 v117, v85, v101
    v_fmac_f32 v118, v85, v102
    v_fmac_f32 v119, v85, v103
    v_fmac_f32 v114, v85, v21
    v_fmac_f32 v116, v86, v104
    v_fmac_f32 v117, v86, v105
    v_fmac_f32 v118, v86, v106
    v_fmac_f32 v119, v86, v107
    v_fmac_f32 v114, v86, v22
    v_fmac_f32 v116, v87, v108
    v_fmac_f32 v117, v87, v109
    v_fmac_f32 v118, v87, v110
    v_fmac_f32 v119, v87, v111
    v_fmac_f32 v114, v87, v23
    v_cvt_pk_bf16_f32 v120, v116, v117
    v_cvt_pk_bf16_f32 v121, v118, v119
    v_cndmask_b32 v122, v112, v114, vcc
    ds_read_b128 v[80:83], v9 offset:128
    ds_read_b128 v[84:87], v9 offset:144
    ds_read_b128 v[16:19], v9 offset:640
    ds_read_b128 v[20:23], v9 offset:656
    ds_read_b128 v[96:99], v8 offset:2112
    ds_read_b128 v[100:103], v8 offset:6336
    ds_read_b128 v[104:107], v8 offset:10560
    ds_read_b128 v[108:111], v8 offset:14784
    v_mov_b32 v127, s79
    v_and_b32 v113, 1, v0
    v_cmp_eq_u32 vcc, 1, v113
    s_waitcnt lgkmcnt(6)
    v_max3_f32 v112, v80, v81, v82
    v_max_f32 v112, v112, v83
    v_max3_f32 v112, v112, v84, v85
    v_max3_f32 v112, v112, v86, v87
    v_mul_f32 v26, s78, v112
    v_fma_f32 v80, v80, s78, -v26
    v_fma_f32 v81, v81, s78, -v26
    v_fma_f32 v82, v82, s78, -v26
    v_fma_f32 v83, v83, s78, -v26
    v_fma_f32 v84, v84, s78, -v26
    v_fma_f32 v85, v85, s78, -v26
    v_fma_f32 v86, v86, s78, -v26
    v_fma_f32 v87, v87, s78, -v26
    v_exp_f32 v80, v80
    v_exp_f32 v81, v81
    v_exp_f32 v82, v82
    v_exp_f32 v83, v83
    v_exp_f32 v84, v84
    v_exp_f32 v85, v85
    v_exp_f32 v86, v86
    v_exp_f32 v87, v87
    s_waitcnt lgkmcnt(0)
    v_mul_f32 v116, v80, v96
    v_mul_f32 v117, v80, v97
    v_mul_f32 v118, v80, v98
    v_mul_f32 v119, v80, v99
    v_mul_f32 v114, v80, v16
    v_fmac_f32 v116, v81, v100
    v_fmac_f32 v117, v81, v101
    v_fmac_f32 v118, v81, v102
    v_fmac_f32 v119, v81, v103
    v_fmac_f32 v114, v81, v17
    v_fmac_f32 v116, v82, v104
    v_fmac_f32 v117, v82, v105
    v_fmac_f32 v118, v82, v106
    v_fmac_f32 v119, v82, v107
    v_fmac_f32 v114, v82, v18
    v_fmac_f32 v116, v83, v108
    v_fmac_f32 v117, v83, v109
    v_fmac_f32 v118, v83, v110
    v_fmac_f32 v119, v83, v111
    v_fmac_f32 v114, v83, v19
    ds_read_b128 v[96:99], v8 offset:19008
    ds_read_b128 v[100:103], v8 offset:23232
    ds_read_b128 v[104:107], v8 offset:27456
    ds_read_b128 v[108:111], v8 offset:31680
    s_waitcnt lgkmcnt(0)
    v_fmac_f32 v116, v84, v96
    v_fmac_f32 v117, v84, v97
    v_fmac_f32 v118, v84, v98
    v_fmac_f32 v119, v84, v99
    v_fmac_f32 v114, v84, v20
    v_fmac_f32 v116, v85, v100
    v_fmac_f32 v117, v85, v101
    v_fmac_f32 v118, v85, v102
    v_fmac_f32 v119, v85, v103
    v_fmac_f32 v114, v85, v21
    v_fmac_f32 v116, v86, v104
    v_fmac_f32 v117, v86, v105
    v_fmac_f32 v118, v86, v106
    v_fmac_f32 v119, v86, v107
    v_fmac_f32 v114, v86, v22
    v_fmac_f32 v116, v87, v108
    v_fmac_f32 v117, v87, v109
    v_fmac_f32 v118, v87, v110
    v_fmac_f32 v119, v87, v111
    v_fmac_f32 v114, v87, v23
    v_cvt_pk_bf16_f32 v124, v116, v117
    v_cvt_pk_bf16_f32 v125, v118, v119
    v_cndmask_b32 v126, v112, v114, vcc
    s_waitcnt vmcnt(8)
    v_mfma_f32_16x16x32_bf16 v[80:83], v[192:195], v[64:67], 0
    v_mfma_f32_16x16x32_bf16 v[84:87], v[208:211], v[64:67], 0
    v_mfma_f32_16x16x32_bf16 v[80:83], v[196:199], v[68:71], v[80:83]
    v_mfma_f32_16x16x32_bf16 v[84:87], v[212:215], v[68:71], v[84:87]
    v_mfma_f32_16x16x32_bf16 v[80:83], v[200:203], v[72:75], v[80:83]
    v_mfma_f32_16x16x32_bf16 v[84:87], v[216:219], v[72:75], v[84:87]
    v_mfma_f32_16x16x32_bf16 v[80:83], v[204:207], v[76:79], v[80:83]
    v_mfma_f32_16x16x32_bf16 v[84:87], v[220:223], v[76:79], v[84:87]
    s_nop 7
    v_max3_f32 v24, v80, v81, v82
    v_max3_f32 v24, v24, v83, v84
    v_max3_f32 v24, v24, v85, v86
    v_max3_f32 v24, v24, v87, v92
    v_mov_b32 v25, v24
    s_nop 1
    v_permlane16_swap_b32 v24, v25
    v_max_f32 v24, v24, v25
    v_mov_b32 v25, v24
    s_nop 1
    v_permlane32_swap_b32 v24, v25
    v_max_f32 v24, v24, v25
    v_mul_f32 v26, s78, v24
    v_fma_f32 v28, v92, s78, -v26
    v_exp_f32 v28, v28
    v_mov_b32 v92, v24
    v_fma_f32 v80, v80, s78, -v26
    v_fma_f32 v81, v81, s78, -v26
    v_fma_f32 v82, v82, s78, -v26
    v_fma_f32 v83, v83, s78, -v26
    v_fma_f32 v84, v84, s78, -v26
    v_fma_f32 v85, v85, s78, -v26
    v_fma_f32 v86, v86, s78, -v26
    v_fma_f32 v87, v87, s78, -v26
    v_exp_f32 v80, v80
    v_exp_f32 v81, v81
    v_exp_f32 v82, v82
    v_exp_f32 v83, v83
    v_exp_f32 v84, v84
    v_exp_f32 v85, v85
    v_exp_f32 v86, v86
    v_exp_f32 v87, v87
    v_pk_mul_f32 v[32:33], v[32:33], v[28:29] op_sel_hi:[1,0]
    v_pk_mul_f32 v[34:35], v[34:35], v[28:29] op_sel_hi:[1,0]
    v_pk_mul_f32 v[36:37], v[36:37], v[28:29] op_sel_hi:[1,0]
    v_pk_mul_f32 v[38:39], v[38:39], v[28:29] op_sel_hi:[1,0]
    v_pk_mul_f32 v[40:41], v[40:41], v[28:29] op_sel_hi:[1,0]
    v_pk_mul_f32 v[42:43], v[42:43], v[28:29] op_sel_hi:[1,0]
    v_pk_mul_f32 v[44:45], v[44:45], v[28:29] op_sel_hi:[1,0]
    v_pk_mul_f32 v[46:47], v[46:47], v[28:29] op_sel_hi:[1,0]
    v_pk_mul_f32 v[48:49], v[48:49], v[28:29] op_sel_hi:[1,0]
    v_pk_mul_f32 v[50:51], v[50:51], v[28:29] op_sel_hi:[1,0]
    v_pk_mul_f32 v[52:53], v[52:53], v[28:29] op_sel_hi:[1,0]
    v_pk_mul_f32 v[54:55], v[54:55], v[28:29] op_sel_hi:[1,0]
    v_pk_mul_f32 v[56:57], v[56:57], v[28:29] op_sel_hi:[1,0]
    v_pk_mul_f32 v[58:59], v[58:59], v[28:29] op_sel_hi:[1,0]
    v_pk_mul_f32 v[60:61], v[60:61], v[28:29] op_sel_hi:[1,0]
    v_pk_mul_f32 v[62:63], v[62:63], v[28:29] op_sel_hi:[1,0]
    v_add_f32 v24, v80, v81
    v_add_f32 v25, v82, v83
    v_add_f32 v24, v24, v84
    v_add_f32 v25, v25, v85
    v_add_f32 v24, v24, v86
    v_add_f32 v25, v25, v87
    v_cvt_pk_bf16_f32 v88, v80, v81
    v_cvt_pk_bf16_f32 v89, v82, v83
    v_cvt_pk_bf16_f32 v90, v84, v85
    v_cvt_pk_bf16_f32 v91, v86, v87
    v_add_f32 v24, v24, v25
    v_fma_f32 v93, v93, v28, v24
    v_mov_b32 v25, v93
    s_nop 1
    v_permlane16_swap_b32 v93, v25
    v_add_f32 v93, v93, v25
    v_mov_b32 v25, v93
    s_nop 1
    v_permlane32_swap_b32 v93, v25
    v_add_f32 v93, v93, v25
    s_mov_b64 exec, 0xff
    ds_write_b32 v6, v92 offset:256
    ds_write_b32 v6, v93 offset:768
    s_mov_b64 exec, -1
    v_mov_b32 v115, s79
    s_waitcnt vmcnt(0)
    v_perm_b32 v16, v228, v224, s76
    v_perm_b32 v17, v236, v232, s76
    v_perm_b32 v18, v244, v240, s76
    v_perm_b32 v19, v252, v248, s76
    v_perm_b32 v20, v228, v224, s77
    v_perm_b32 v21, v236, v232, s77
    v_perm_b32 v22, v244, v240, s77
    v_perm_b32 v23, v252, v248, s77
    v_mfma_f32_16x16x32_bf16 v[32:35], v[16:19], v[88:91], v[32:35]
    v_perm_b32 v16, v229, v225, s76
    v_perm_b32 v17, v237, v233, s76
    v_perm_b32 v18, v245, v241, s76
    v_perm_b32 v19, v253, v249, s76
    v_mfma_f32_16x16x32_bf16 v[36:39], v[20:23], v[88:91], v[36:39]
    v_perm_b32 v20, v229, v225, s77
    v_perm_b32 v21, v237, v233, s77
    v_perm_b32 v22, v245, v241, s77
    v_perm_b32 v23, v253, v249, s77
    v_mfma_f32_16x16x32_bf16 v[40:43], v[16:19], v[88:91], v[40:43]
    v_perm_b32 v16, v230, v226, s76
    v_perm_b32 v17, v238, v234, s76
    v_perm_b32 v18, v246, v242, s76
    v_perm_b32 v19, v254, v250, s76
    v_mfma_f32_16x16x32_bf16 v[44:47], v[20:23], v[88:91], v[44:47]
    v_perm_b32 v20, v230, v226, s77
    v_perm_b32 v21, v238, v234, s77
    v_perm_b32 v22, v246, v242, s77
    v_perm_b32 v23, v254, v250, s77
    v_mfma_f32_16x16x32_bf16 v[48:51], v[16:19], v[88:91], v[48:51]
    v_perm_b32 v16, v231, v227, s76
    v_perm_b32 v17, v239, v235, s76
    v_perm_b32 v18, v247, v243, s76
    v_perm_b32 v19, v255, v251, s76
    v_mfma_f32_16x16x32_bf16 v[52:55], v[20:23], v[88:91], v[52:55]
    v_perm_b32 v20, v231, v227, s77
    v_perm_b32 v21, v239, v235, s77
    v_perm_b32 v22, v247, v243, s77
    v_perm_b32 v23, v255, v251, s77
    v_mfma_f32_16x16x32_bf16 v[56:59], v[16:19], v[88:91], v[56:59]
    s_nop 0
    v_mfma_f32_16x16x32_bf16 v[60:63], v[20:23], v[88:91], v[60:63]
    s_nop 3
    s_mov_b32 exec_lo, 0x00ff00ff
    s_mov_b32 exec_hi, 0x00ff00ff
    ds_write_b128 v5, v[32:35] offset:33792
    ds_write_b128 v5, v[36:39] offset:33808
    ds_write_b128 v5, v[40:43] offset:33824
    ds_write_b128 v5, v[44:47] offset:33840
    ds_write_b128 v5, v[48:51] offset:33856
    ds_write_b128 v5, v[52:55] offset:33872
    ds_write_b128 v5, v[56:59] offset:33888
    ds_write_b128 v5, v[60:63] offset:33904
    s_mov_b64 exec, -1
    v_mov_b32 v25, 1
    s_mov_b64 exec, 1
    ds_add_u32 v10, v25 offset:20
    s_mov_b64 exec, -1
    s_mov_b32 s89, 0
L_ls72:
    ds_read_b32 v31, v10 offset:20
    s_waitcnt lgkmcnt(0)
    v_readfirstlane_b32 s88, v31
    s_add_u32 s89, s89, 1
    s_cmp_eq_u32 s88, 4
    s_cbranch_scc1 L_lsok73
    s_cmp_gt_u32 s89, 1000000
    s_cbranch_scc1 L_lsok73
    s_sleep 1
    s_branch L_ls72
L_lsok73:
    ds_read_b128 v[80:83], v9 offset:256
    ds_read_b128 v[16:19], v9 offset:768
    ds_read_b128 v[160:163], v8 offset:33792
    ds_read_b128 v[164:167], v8 offset:38016
    ds_read_b128 v[168:171], v8 offset:42240
    ds_read_b128 v[172:175], v8 offset:46464
    s_waitcnt lgkmcnt(5)
    v_max3_f32 v176, v80, v81, v82
    v_max_f32 v176, v176, v83
    v_mul_f32 v26, s78, v176
    v_fma_f32 v80, v80, s78, -v26
    v_fma_f32 v81, v81, s78, -v26
    v_fma_f32 v82, v82, s78, -v26
    v_fma_f32 v83, v83, s78, -v26
    v_exp_f32 v80, v80
    v_exp_f32 v81, v81
    v_exp_f32 v82, v82
    v_exp_f32 v83, v83
    s_waitcnt lgkmcnt(0)
    v_mul_f32 v180, v80, v160
    v_mul_f32 v181, v80, v161
    v_mul_f32 v182, v80, v162
    v_mul_f32 v183, v80, v163
    v_mul_f32 v178, v80, v16
    v_fmac_f32 v180, v81, v164
    v_fmac_f32 v181, v81, v165
    v_fmac_f32 v182, v81, v166
    v_fmac_f32 v183, v81, v167
    v_fmac_f32 v178, v81, v17
    v_fmac_f32 v180, v82, v168
    v_fmac_f32 v181, v82, v169
    v_fmac_f32 v182, v82, v170
    v_fmac_f32 v183, v82, v171
    v_fmac_f32 v178, v82, v18
    v_fmac_f32 v180, v83, v172
    v_fmac_f32 v181, v83, v173
    v_fmac_f32 v182, v83, v174
    v_fmac_f32 v183, v83, v175
    v_fmac_f32 v178, v83, v19
    s_mov_b32 exec_hi, 0
    ds_write_b128 v8, v[180:183] offset:33792
    s_mov_b64 exec, 1
    ds_write_b32 v9, v176 offset:256
    ds_write_b32 v9, v178 offset:768
    s_mov_b64 exec, -1
    ds_read_b128 v[80:83], v9 offset:384
    ds_read_b128 v[16:19], v9 offset:896
    ds_read_b128 v[160:163], v8 offset:35904
    ds_read_b128 v[164:167], v8 offset:40128
    ds_read_b128 v[168:171], v8 offset:44352
    ds_read_b128 v[172:175], v8 offset:48576
    s_waitcnt lgkmcnt(5)
    v_max3_f32 v176, v80, v81, v82
    v_max_f32 v176, v176, v83
    v_mul_f32 v26, s78, v176
    v_fma_f32 v80, v80, s78, -v26
    v_fma_f32 v81, v81, s78, -v26
    v_fma_f32 v82, v82, s78, -v26
    v_fma_f32 v83, v83, s78, -v26
    v_exp_f32 v80, v80
    v_exp_f32 v81, v81
    v_exp_f32 v82, v82
    v_exp_f32 v83, v83
    s_waitcnt lgkmcnt(0)
    v_mul_f32 v180, v80, v160
    v_mul_f32 v181, v80, v161
    v_mul_f32 v182, v80, v162
    v_mul_f32 v183, v80, v163
    v_mul_f32 v178, v80, v16
    v_fmac_f32 v180, v81, v164
    v_fmac_f32 v181, v81, v165
    v_fmac_f32 v182, v81, v166
    v_fmac_f32 v183, v81, v167
    v_fmac_f32 v178, v81, v17
    v_fmac_f32 v180, v82, v168
    v_fmac_f32 v181, v82, v169
    v_fmac_f32 v182, v82, v170
    v_fmac_f32 v183, v82, v171
    v_fmac_f32 v178, v82, v18
    v_fmac_f32 v180, v83, v172
    v_fmac_f32 v181, v83, v173
    v_fmac_f32 v182, v83, v174
    v_fmac_f32 v183, v83, v175
    v_fmac_f32 v178, v83, v19
    s_mov_b32 exec_hi, 0
    ds_write_b128 v8, v[180:183] offset:35904
    s_mov_b64 exec, 1
    ds_write_b32 v9, v176 offset:384
    ds_write_b32 v9, v178 offset:896
    s_mov_b64 exec, -1
    s_mov_b32 s89, 0
L_ls74:
    ds_read_b32 v31, v10 offset:24
    s_waitcnt lgkmcnt(0)
    v_readfirstlane_b32 s88, v31
    s_add_u32 s89, s89, 1
    s_cmp_eq_u32 s88, 4
    s_cbranch_scc1 L_lsok75
    s_cmp_gt_u32 s89, 1000000
    s_cbranch_scc1 L_lsok75
    s_sleep 1
    s_branch L_ls74
L_lsok75:
    s_mov_b32 exec_hi, 0
    buffer_store_dwordx4 v[120:123], v12, s[28:31], s93 offen sc1
    buffer_store_dwordx4 v[124:127], v12, s[28:31], s94 offen sc1
    s_mov_b32 exec_hi, -1
    v_and_b32 v112, 1, v0
    v_cmp_eq_u32 vcc, 1, v112
    s_waitcnt lgkmcnt(0)
    s_barrier
    ds_read_b32 v31, v10 offset:28
    ds_read_b32 v96, v9 offset:256
    ds_read_b128 v[100:103], v9 offset:272
    ds_read_b128 v[160:163], v8 offset:33792
    ds_read_b128 v[164:167], v8 offset:50688
    ds_read_b128 v[168:171], v8 offset:54912
    ds_read_b128 v[172:175], v8 offset:59136
    ds_read_b128 v[176:179], v8 offset:63360
    ds_read_b32 v104, v9 offset:768
    ds_read_b128 v[108:111], v9 offset:784
    s_waitcnt lgkmcnt(7)
    v_max3_f32 v114, v96, v100, v101
    v_max3_f32 v114, v114, v102, v103
    v_mul_f32 v26, s78, v114
    v_fma_f32 v96, v96, s78, -v26
    v_fma_f32 v100, v100, s78, -v26
    v_fma_f32 v101, v101, s78, -v26
    v_fma_f32 v102, v102, s78, -v26
    v_fma_f32 v103, v103, s78, -v26
    v_exp_f32 v96, v96
    v_exp_f32 v100, v100
    v_exp_f32 v101, v101
    v_exp_f32 v102, v102
    v_exp_f32 v103, v103
    s_waitcnt lgkmcnt(2)
    v_pk_mul_f32 v[116:117], v[160:161], v[96:97] op_sel:[0,0] op_sel_hi:[1,0]
    v_pk_mul_f32 v[118:119], v[162:163], v[96:97] op_sel:[0,0] op_sel_hi:[1,0]
    v_pk_fma_f32 v[116:117], v[164:165], v[100:101], v[116:117] op_sel:[0,0,0] op_sel_hi:[1,0,1]
    v_pk_fma_f32 v[118:119], v[166:167], v[100:101], v[118:119] op_sel:[0,0,0] op_sel_hi:[1,0,1]
    v_pk_fma_f32 v[116:117], v[168:169], v[100:101], v[116:117] op_sel:[0,1,0] op_sel_hi:[1,1,1]
    v_pk_fma_f32 v[118:119], v[170:171], v[100:101], v[118:119] op_sel:[0,1,0] op_sel_hi:[1,1,1]
    v_pk_fma_f32 v[116:117], v[172:173], v[102:103], v[116:117] op_sel:[0,0,0] op_sel_hi:[1,0,1]
    v_pk_fma_f32 v[118:119], v[174:175], v[102:103], v[118:119] op_sel:[0,0,0] op_sel_hi:[1,0,1]
    v_pk_fma_f32 v[116:117], v[176:177], v[102:103], v[116:117] op_sel:[0,1,0] op_sel_hi:[1,1,1]
    v_pk_fma_f32 v[118:119], v[178:179], v[102:103], v[118:119] op_sel:[0,1,0] op_sel_hi:[1,1,1]
    s_waitcnt lgkmcnt(0)
    v_mul_f32 v97, v96, v104
    v_fmac_f32 v97, v100, v108
    v_fmac_f32 v97, v101, v109
    v_fmac_f32 v97, v102, v110
    v_fmac_f32 v97, v103, v111
    v_cvt_pk_bf16_f32 v112, v116, v117
    v_cvt_pk_bf16_f32 v113, v118, v119
    v_cndmask_b32 v114, v114, v97, vcc
    s_mov_b32 exec_hi, 0
    buffer_store_dwordx4 v[112:115], v12, s[28:31], s92 offen sc1
    s_mov_b32 exec_hi, -1
    v_mov_b32 v35, 0
    v_mov_b32 v39, 0
    v_mov_b32 v43, 0
    v_mov_b32 v47, 0
    v_readfirstlane_b32 s73, v31
    s_cmp_ge_u32 s3, 2
    s_cbranch_scc1 L_ga76
    s_add_u32 s72, s72, 0x100000
    s_mov_b32 s89, 0
    s_mov_b32 s12, 0
    s_cmp_ge_u32 s73, 56
    s_cselect_b32 s12, 0x1000, 0
L_pm78:
    s_waitcnt vmcnt(0)
L_pmchk80:
    v_cmp_ne_u32 s[4:5], s79, v35
    v_cmp_ne_u32 s[6:7], s79, v39
    v_cmp_ne_u32 s[8:9], s79, v43
    v_cmp_ne_u32 s[10:11], s79, v47
    s_or_b64 vcc, s[4:5], s[6:7]
    s_or_b64 vcc, vcc, s[8:9]
    s_or_b64 vcc, vcc, s[10:11]
    s_cbranch_scc0 L_pmdone79
    s_add_u32 s89, s89, 1
    s_cmp_gt_u32 s89, 20000
    s_cbranch_scc1 L_pmdone79
    s_bcnt1_i32_b64 s13, s[4:5]
    s_bcnt1_i32_b64 s88, s[6:7]
    s_add_u32 s13, s13, s88
    s_bcnt1_i32_b64 s88, s[8:9]
    s_add_u32 s13, s13, s88
    s_bcnt1_i32_b64 s88, s[10:11]
    s_add_u32 s13, s13, s88
    s_cmp_le_u32 s13, 64
    s_cbranch_scc1 L_pmfull81
    s_cmp_lt_u32 s13, s12
    s_cbranch_scc1 L_pmfull81
    s_mov_b32 s12, s13
    s_sleep 6
    s_ff1_i32_b64 s88, s[4:5]
    s_cmp_lt_i32 s88, 0
    s_cbranch_scc1 L_pmw82
    s_and_b32 s88, s88, 56
    s_lshl_b64 exec, 0xff, s88
    buffer_load_dwordx4 v[32:35], v3, s[28:31], s72 offen offset:0 sc1
    s_mov_b64 exec, -1
    s_branch L_pm78
L_pmw82:
    s_ff1_i32_b64 s88, s[6:7]
    s_cmp_lt_i32 s88, 0
    s_cbranch_scc1 L_pmw83
    s_and_b32 s88, s88, 56
    s_lshl_b64 exec, 0xff, s88
    buffer_load_dwordx4 v[36:39], v3, s[28:31], s72 offen offset:1024 sc1
    s_mov_b64 exec, -1
    s_branch L_pm78
L_pmw83:
    s_ff1_i32_b64 s88, s[8:9]
    s_cmp_lt_i32 s88, 0
    s_cbranch_scc1 L_pmw84
    s_and_b32 s88, s88, 56
    s_lshl_b64 exec, 0xff, s88
    buffer_load_dwordx4 v[40:43], v3, s[28:31], s72 offen offset:2048 sc1
    s_mov_b64 exec, -1
    s_branch L_pm78
L_pmw84:
    s_ff1_i32_b64 s88, s[10:11]
    s_cmp_lt_i32 s88, 0
    s_cbranch_scc1 L_pmw85
    s_and_b32 s88, s88, 56
    s_lshl_b64 exec, 0xff, s88
    buffer_load_dwordx4 v[44:47], v3, s[28:31], s72 offen offset:3072 sc1
    s_mov_b64 exec, -1
    s_branch L_pm78
L_pmw85:
L_pmfull81:
    s_mov_b32 s12, 0
    s_mov_b64 exec, s[4:5]
    s_cbranch_execz L_pms86
    buffer_load_dwordx4 v[32:35], v3, s[28:31], s72 offen offset:0 sc1
L_pms86:
    s_mov_b64 exec, s[6:7]
    s_cbranch_execz L_pms87
    buffer_load_dwordx4 v[36:39], v3, s[28:31], s72 offen offset:1024 sc1
L_pms87:
    s_mov_b64 exec, s[8:9]
    s_cbranch_execz L_pms88
    buffer_load_dwordx4 v[40:43], v3, s[28:31], s72 offen offset:2048 sc1
L_pms88:
    s_mov_b64 exec, s[10:11]
    s_cbranch_execz L_pms89
    buffer_load_dwordx4 v[44:47], v3, s[28:31], s72 offen offset:3072 sc1
L_pms89:
    s_mov_b64 exec, -1
    s_branch L_pm78
L_pmdone79:
    s_mov_b32 s85, 0xffff0000
    v_mov_b32_dpp v128, v34 quad_perm:[0,0,2,2] row_mask:0xf bank_mask:0xf
    v_mov_b32_dpp v132, v38 quad_perm:[0,0,2,2] row_mask:0xf bank_mask:0xf
    v_mov_b32_dpp v136, v42 quad_perm:[0,0,2,2] row_mask:0xf bank_mask:0xf
    v_mov_b32_dpp v140, v46 quad_perm:[0,0,2,2] row_mask:0xf bank_mask:0xf
    v_max3_f32 v24, v128, v132, v136
    v_max_f32 v24, v24, v140
    v_lshlrev_b32 v144, 16, v32
    v_and_b32 v145, s85, v32
    v_max_f32_dpp v24, v24, v24 row_ror:8 row_mask:0xf bank_mask:0xf
    v_mov_b32 v25, v24
    v_lshlrev_b32 v146, 16, v33
    v_and_b32 v147, s85, v33
    v_permlane16_swap_b32 v24, v25
    v_max_f32 v24, v24, v25
    v_mov_b32 v25, v24
    v_lshlrev_b32 v148, 16, v36
    v_and_b32 v149, s85, v36
    v_permlane32_swap_b32 v24, v25
    v_max_f32 v24, v24, v25
    v_mul_f32 v26, s78, v24
    v_fma_f32 v128, v128, s78, -v26
    v_fma_f32 v132, v132, s78, -v26
    v_fma_f32 v136, v136, s78, -v26
    v_fma_f32 v140, v140, s78, -v26
    v_exp_f32 v128, v128
    v_exp_f32 v132, v132
    v_exp_f32 v136, v136
    v_exp_f32 v140, v140
    v_lshlrev_b32 v150, 16, v37
    v_and_b32 v151, s85, v37
    v_lshlrev_b32 v152, 16, v40
    v_and_b32 v153, s85, v40
    v_lshlrev_b32 v154, 16, v41
    v_and_b32 v155, s85, v41
    v_lshlrev_b32 v156, 16, v44
    v_and_b32 v157, s85, v44
    v_lshlrev_b32 v158, 16, v45
    v_and_b32 v159, s85, v45
    v_mov_b32_dpp v130, v34 quad_perm:[1,1,3,3] row_mask:0xf bank_mask:0xf
    v_mov_b32_dpp v134, v38 quad_perm:[1,1,3,3] row_mask:0xf bank_mask:0xf
    v_mov_b32_dpp v138, v42 quad_perm:[1,1,3,3] row_mask:0xf bank_mask:0xf
    v_mov_b32_dpp v142, v46 quad_perm:[1,1,3,3] row_mask:0xf bank_mask:0xf
    v_pk_mul_f32 v[16:17], v[144:145], v[128:129] op_sel_hi:[1,0]
    v_pk_mul_f32 v[18:19], v[146:147], v[128:129] op_sel_hi:[1,0]
    v_mul_f32 v27, v130, v128
    v_pk_fma_f32 v[16:17], v[148:149], v[132:133], v[16:17] op_sel_hi:[1,0,1]
    v_pk_fma_f32 v[18:19], v[150:151], v[132:133], v[18:19] op_sel_hi:[1,0,1]
    v_fmac_f32 v27, v134, v132
    v_pk_fma_f32 v[16:17], v[152:153], v[136:137], v[16:17] op_sel_hi:[1,0,1]
    v_pk_fma_f32 v[18:19], v[154:155], v[136:137], v[18:19] op_sel_hi:[1,0,1]
    v_fmac_f32 v27, v138, v136
    v_pk_fma_f32 v[16:17], v[156:157], v[140:141], v[16:17] op_sel_hi:[1,0,1]
    v_pk_fma_f32 v[18:19], v[158:159], v[140:141], v[18:19] op_sel_hi:[1,0,1]
    v_fmac_f32 v27, v142, v140
    v_add_f32_dpp v16, v16, v16 row_ror:8 row_mask:0xf bank_mask:0xf
    v_add_f32_dpp v17, v17, v17 row_ror:8 row_mask:0xf bank_mask:0xf
    v_add_f32_dpp v18, v18, v18 row_ror:8 row_mask:0xf bank_mask:0xf
    v_add_f32_dpp v19, v19, v19 row_ror:8 row_mask:0xf bank_mask:0xf
    v_add_f32_dpp v27, v27, v27 row_ror:8 row_mask:0xf bank_mask:0xf
    v_mov_b32 v25, v27
    v_permlane16_swap_b32 v16, v17
    v_permlane16_swap_b32 v18, v19
    v_permlane16_swap_b32 v27, v25
    v_add_f32 v27, v27, v25
    v_add_f32 v16, v16, v17
    v_add_f32 v18, v18, v19
    v_mov_b32 v25, v27
    s_nop 0
    v_permlane32_swap_b32 v16, v18
    v_permlane32_swap_b32 v27, v25
    v_add_f32 v27, v27, v25
    v_add_f32 v16, v16, v18
    v_rcp_f32 v27, v27
    v_mul_f32 v16, v16, v15
    v_mul_f32 v16, v16, v27
    v_cvt_pk_bf16_f32 v16, v16, v16
    s_mov_b32 exec_lo, 0x00ff00ff
    s_mov_b32 exec_hi, 0x00ff00ff
    ds_write_b16 v1, v16 offset:1152
    s_mov_b64 exec, -1
    s_branch L_gj77
L_ga76:
    s_mov_b32 s89, 0
    s_mov_b32 s12, 0
    s_cmp_ge_u32 s73, 56
    s_cselect_b32 s12, 0x1000, 0
L_pm90:
    s_waitcnt vmcnt(0)
L_pmchk92:
    v_cmp_ne_u32 s[4:5], s79, v35
    v_cmp_ne_u32 s[6:7], s79, v39
    s_or_b64 vcc, s[4:5], s[6:7]
    s_cbranch_scc0 L_pmdone91
    s_add_u32 s89, s89, 1
    s_cmp_gt_u32 s89, 20000
    s_cbranch_scc1 L_pmdone91
    s_bcnt1_i32_b64 s13, s[4:5]
    s_bcnt1_i32_b64 s88, s[6:7]
    s_add_u32 s13, s13, s88
    s_cmp_le_u32 s13, 64
    s_cbranch_scc1 L_pmfull93
    s_cmp_lt_u32 s13, s12
    s_cbranch_scc1 L_pmfull93
    s_mov_b32 s12, s13
    s_sleep 6
    s_ff1_i32_b64 s88, s[4:5]
    s_cmp_lt_i32 s88, 0
    s_cbranch_scc1 L_pmw94
    s_and_b32 s88, s88, 56
    s_lshl_b64 exec, 0xff, s88
    buffer_load_dwordx4 v[32:35], v3, s[28:31], s72 offen offset:0 sc1
    s_mov_b64 exec, -1
    s_branch L_pm90
L_pmw94:
    s_ff1_i32_b64 s88, s[6:7]
    s_cmp_lt_i32 s88, 0
    s_cbranch_scc1 L_pmw95
    s_and_b32 s88, s88, 56
    s_lshl_b64 exec, 0xff, s88
    buffer_load_dwordx4 v[36:39], v3, s[28:31], s72 offen offset:1024 sc1
    s_mov_b64 exec, -1
    s_branch L_pm90
L_pmw95:
L_pmfull93:
    s_mov_b32 s12, 0
    s_mov_b64 exec, s[4:5]
    s_cbranch_execz L_pms96
    buffer_load_dwordx4 v[32:35], v3, s[28:31], s72 offen offset:0 sc1
L_pms96:
    s_mov_b64 exec, s[6:7]
    s_cbranch_execz L_pms97
    buffer_load_dwordx4 v[36:39], v3, s[28:31], s72 offen offset:1024 sc1
L_pms97:
    s_mov_b64 exec, -1
    s_branch L_pm90
L_pmdone91:
    s_mov_b32 s85, 0xffff0000
    v_mov_b32_dpp v128, v34 quad_perm:[0,0,2,2] row_mask:0xf bank_mask:0xf
    v_mov_b32_dpp v132, v38 quad_perm:[0,0,2,2] row_mask:0xf bank_mask:0xf
    v_max_f32 v24, v128, v132
    v_lshlrev_b32 v144, 16, v32
    v_and_b32 v145, s85, v32
    v_max_f32_dpp v24, v24, v24 row_ror:8 row_mask:0xf bank_mask:0xf
    v_mov_b32 v25, v24
    v_lshlrev_b32 v146, 16, v33
    v_and_b32 v147, s85, v33
    v_permlane16_swap_b32 v24, v25
    v_max_f32 v24, v24, v25
    v_mov_b32 v25, v24
    v_lshlrev_b32 v148, 16, v36
    v_and_b32 v149, s85, v36
    v_permlane32_swap_b32 v24, v25
    v_max_f32 v24, v24, v25
    v_mul_f32 v26, s78, v24
    v_fma_f32 v128, v128, s78, -v26
    v_fma_f32 v132, v132, s78, -v26
    v_exp_f32 v128, v128
    v_exp_f32 v132, v132
    v_lshlrev_b32 v150, 16, v37
    v_and_b32 v151, s85, v37
    v_mov_b32_dpp v130, v34 quad_perm:[1,1,3,3] row_mask:0xf bank_mask:0xf
    v_mov_b32_dpp v134, v38 quad_perm:[1,1,3,3] row_mask:0xf bank_mask:0xf
    v_pk_mul_f32 v[16:17], v[144:145], v[128:129] op_sel_hi:[1,0]
    v_pk_mul_f32 v[18:19], v[146:147], v[128:129] op_sel_hi:[1,0]
    v_mul_f32 v27, v130, v128
    v_pk_fma_f32 v[16:17], v[148:149], v[132:133], v[16:17] op_sel_hi:[1,0,1]
    v_pk_fma_f32 v[18:19], v[150:151], v[132:133], v[18:19] op_sel_hi:[1,0,1]
    v_fmac_f32 v27, v134, v132
    v_add_f32_dpp v16, v16, v16 row_ror:8 row_mask:0xf bank_mask:0xf
    v_add_f32_dpp v17, v17, v17 row_ror:8 row_mask:0xf bank_mask:0xf
    v_add_f32_dpp v18, v18, v18 row_ror:8 row_mask:0xf bank_mask:0xf
    v_add_f32_dpp v19, v19, v19 row_ror:8 row_mask:0xf bank_mask:0xf
    v_add_f32_dpp v27, v27, v27 row_ror:8 row_mask:0xf bank_mask:0xf
    v_mov_b32 v25, v27
    v_permlane16_swap_b32 v16, v17
    v_permlane16_swap_b32 v18, v19
    v_permlane16_swap_b32 v27, v25
    v_add_f32 v27, v27, v25
    v_add_f32 v16, v16, v17
    v_add_f32 v18, v18, v19
    v_mov_b32 v25, v27
    s_nop 0
    v_permlane32_swap_b32 v16, v18
    v_permlane32_swap_b32 v27, v25
    v_add_f32 v27, v27, v25
    v_add_f32 v16, v16, v18
    v_rcp_f32 v27, v27
    v_mul_f32 v16, v16, v14
    v_mul_f32 v16, v16, v27
    v_cvt_pk_bf16_f32 v16, v16, v16
    s_mov_b32 exec_lo, 0x00ff00ff
    s_mov_b32 exec_hi, 0x00ff00ff
    ds_write_b16 v1, v16 offset:1024
    s_mov_b64 exec, -1
    v_mov_b32 v25, 1
    s_mov_b64 exec, 1
    ds_add_u32 v10, v25 offset:16
    s_mov_b64 exec, -1
L_gj77:
    s_waitcnt lgkmcnt(0)
    s_barrier
    s_endpgm
L_o_y:
    s_lshl_b32 s100, s80, 12
    s_and_b32 s86, s3, 3
    s_lshl_b32 s87, s86, 10
    s_add_u32 s100, s100, s87
    s_add_u32 s101, s100, 32768
    s_mul_i32 s86, s86, 544
    v_add_u32 v11, s86, v11
    s_mov_b32 s99, 0
    buffer_load_dwordx4 v[96:99], v1, s[12:15], s84 offen offset:0 nt
    buffer_load_dwordx4 v[100:103], v1, s[12:15], s84 offen offset:64 nt
    buffer_load_dwordx4 v[104:107], v1, s[12:15], s84 offen offset:128 nt
    buffer_load_dwordx4 v[108:111], v1, s[12:15], s84 offen offset:192 nt
    buffer_load_dwordx4 v[112:115], v2, s[12:15], s84 offen offset:0 nt
    buffer_load_dwordx4 v[116:119], v2, s[12:15], s84 offen offset:64 nt
    buffer_load_dwordx4 v[120:123], v2, s[12:15], s84 offen offset:128 nt
    buffer_load_dwordx4 v[124:127], v2, s[12:15], s84 offen offset:192 nt
    buffer_load_dwordx4 v[128:131], v3, s[16:19], s84 offen offset:0 nt
    buffer_load_dwordx4 v[132:135], v3, s[16:19], s84 offen offset:1024 nt
    buffer_load_dwordx4 v[136:139], v3, s[16:19], s84 offen offset:2048 nt
    buffer_load_dwordx4 v[140:143], v3, s[16:19], s84 offen offset:3072 nt
    buffer_load_dwordx4 v[144:147], v4, s[16:19], s84 offen offset:0 nt
    buffer_load_dwordx4 v[148:151], v4, s[16:19], s84 offen offset:1024 nt
    buffer_load_dwordx4 v[152:155], v4, s[16:19], s84 offen offset:2048 nt
    buffer_load_dwordx4 v[156:159], v4, s[16:19], s84 offen offset:3072 nt
    buffer_load_dword v95, off, s[44:47], 0 sc1
    buffer_load_dwordx4 v[32:35], v3, s[28:31], s101 offen sc1
    buffer_load_dwordx4 v[36:39], v3, s[28:31], s100 offen sc1
L_qps98:
    s_add_u32 s85, s83, 0x0
    buffer_load_dwordx4 v[160:163], v1, s[4:7], s85 offen offset:0 nt
    buffer_load_dwordx4 v[164:167], v1, s[4:7], s85 offen offset:64 nt
    buffer_load_dwordx4 v[168:171], v1, s[4:7], s85 offen offset:128 nt
    buffer_load_dwordx4 v[172:175], v1, s[4:7], s85 offen offset:192 nt
    buffer_load_dwordx4 v[176:179], v2, s[4:7], s85 offen offset:0 nt
    buffer_load_dwordx4 v[180:183], v2, s[4:7], s85 offen offset:64 nt
    buffer_load_dwordx4 v[184:187], v2, s[4:7], s85 offen offset:128 nt
    buffer_load_dwordx4 v[188:191], v2, s[4:7], s85 offen offset:192 nt
    s_waitcnt vmcnt(8)
    s_mov_b32 s89, 0
L_nn100:
    v_readfirstlane_b32 s79, v95
    s_add_u32 s89, s89, 1
    s_cmp_lg_u32 s79, 0
    s_cbranch_scc1 L_nnok101
    s_cmp_gt_u32 s89, 20000
    s_cbranch_scc1 L_nnok101
    buffer_load_dword v95, off, s[44:47], 0 sc1
    s_waitcnt vmcnt(0)
    s_branch L_nn100
L_nnok101:
    v_xor_b32 v30, s79, v33
    v_xor_b32 v31, s79, v35
    v_or_b32 v30, v30, v31
    v_cmp_ne_u32 s[72:73], 0, v30
    v_xor_b32 v30, s79, v37
    v_xor_b32 v31, s79, v39
    v_or_b32 v30, v30, v31
    v_cmp_ne_u32 s[74:75], 0, v30
    s_or_b64 vcc, s[72:73], s[74:75]
    s_cbranch_scc1 L_qskip99
    v_mov_b32 v33, v34
    v_mov_b32 v37, v38
    v_mov_b32 v24, s79
    v_mov_b32 v25, 1
    ds_write_b64 v11, v[32:33] offset:2176
    ds_write_b64 v11, v[36:37]
    s_mov_b64 exec, 1
    ds_write_b32 v10, v24 offset:8
    ds_add_u32 v10, v25 offset:4
    s_mov_b64 exec, -1
    s_mov_b32 s99, 1
L_qskip99:
    s_cmp_eq_u32 s99, 1
    s_cbranch_scc1 L_qps102
    s_mov_b64 exec, s[72:73]
    s_cbranch_execz L_qpm103
    buffer_load_dwordx4 v[32:35], v3, s[28:31], s101 offen sc1
L_qpm103:
    s_mov_b64 exec, s[74:75]
    s_cbranch_execz L_qpm104
    buffer_load_dwordx4 v[36:39], v3, s[28:31], s100 offen sc1
L_qpm104:
    s_mov_b64 exec, -1
L_qps102:
    s_add_u32 s85, s83, 0x0
    buffer_load_dwordx4 v[192:195], v3, s[8:11], s85 offen offset:0 nt
    buffer_load_dwordx4 v[196:199], v3, s[8:11], s85 offen offset:1024 nt
    buffer_load_dwordx4 v[200:203], v3, s[8:11], s85 offen offset:2048 nt
    buffer_load_dwordx4 v[204:207], v3, s[8:11], s85 offen offset:3072 nt
    buffer_load_dwordx4 v[208:211], v4, s[8:11], s85 offen offset:0 nt
    buffer_load_dwordx4 v[212:215], v4, s[8:11], s85 offen offset:1024 nt
    buffer_load_dwordx4 v[216:219], v4, s[8:11], s85 offen offset:2048 nt
    buffer_load_dwordx4 v[220:223], v4, s[8:11], s85 offen offset:3072 nt
    s_cmp_eq_u32 s99, 1
    s_cbranch_scc1 L_qskip105
    s_waitcnt vmcnt(8)
    v_xor_b32 v30, s79, v33
    v_xor_b32 v31, s79, v35
    v_or_b32 v30, v30, v31
    v_cmp_ne_u32 s[72:73], 0, v30
    v_xor_b32 v30, s79, v37
    v_xor_b32 v31, s79, v39
    v_or_b32 v30, v30, v31
    v_cmp_ne_u32 s[74:75], 0, v30
    s_or_b64 vcc, s[72:73], s[74:75]
    s_cbranch_scc1 L_qskip105
    v_mov_b32 v33, v34
    v_mov_b32 v37, v38
    v_mov_b32 v24, s79
    v_mov_b32 v25, 1
    ds_write_b64 v11, v[32:33] offset:2176
    ds_write_b64 v11, v[36:37]
    s_mov_b64 exec, 1
    ds_write_b32 v10, v24 offset:8
    ds_add_u32 v10, v25 offset:4
    s_mov_b64 exec, -1
    s_mov_b32 s99, 1
L_qskip105:
    s_cmp_eq_u32 s99, 1
    s_cbranch_scc1 L_qps106
    s_mov_b64 exec, s[72:73]
    s_cbranch_execz L_qpm107
    buffer_load_dwordx4 v[32:35], v3, s[28:31], s101 offen sc1
L_qpm107:
    s_mov_b64 exec, s[74:75]
    s_cbranch_execz L_qpm108
    buffer_load_dwordx4 v[36:39], v3, s[28:31], s100 offen sc1
L_qpm108:
    s_mov_b64 exec, -1
L_qps106:
    s_add_u32 s85, s83, 0x200000
    buffer_load_dwordx4 v[224:227], v1, s[4:7], s85 offen offset:0 nt
    buffer_load_dwordx4 v[228:231], v1, s[4:7], s85 offen offset:64 nt
    buffer_load_dwordx4 v[232:235], v1, s[4:7], s85 offen offset:128 nt
    buffer_load_dwordx4 v[236:239], v1, s[4:7], s85 offen offset:192 nt
    buffer_load_dwordx4 v[240:243], v2, s[4:7], s85 offen offset:0 nt
    buffer_load_dwordx4 v[244:247], v2, s[4:7], s85 offen offset:64 nt
    buffer_load_dwordx4 v[248:251], v2, s[4:7], s85 offen offset:128 nt
    buffer_load_dwordx4 v[252:255], v2, s[4:7], s85 offen offset:192 nt
    s_cmp_eq_u32 s99, 1
    s_cbranch_scc1 L_qskip109
    s_waitcnt vmcnt(8)
    v_xor_b32 v30, s79, v33
    v_xor_b32 v31, s79, v35
    v_or_b32 v30, v30, v31
    v_cmp_ne_u32 s[72:73], 0, v30
    v_xor_b32 v30, s79, v37
    v_xor_b32 v31, s79, v39
    v_or_b32 v30, v30, v31
    v_cmp_ne_u32 s[74:75], 0, v30
    s_or_b64 vcc, s[72:73], s[74:75]
    s_cbranch_scc1 L_qskip109
    v_mov_b32 v33, v34
    v_mov_b32 v37, v38
    v_mov_b32 v24, s79
    v_mov_b32 v25, 1
    ds_write_b64 v11, v[32:33] offset:2176
    ds_write_b64 v11, v[36:37]
    s_mov_b64 exec, 1
    ds_write_b32 v10, v24 offset:8
    ds_add_u32 v10, v25 offset:4
    s_mov_b64 exec, -1
    s_mov_b32 s99, 1
L_qskip109:
    s_cmp_eq_u32 s99, 1
    s_cbranch_scc1 L_qd110
    s_mov_b32 s89, 0
L_poll111:
    buffer_load_dwordx4 v[32:35], v3, s[28:31], s101 offen sc1
    buffer_load_dwordx4 v[36:39], v3, s[28:31], s100 offen sc1
    s_waitcnt vmcnt(0)
    v_xor_b32 v31, s79, v33
    v_xor_b32 v30, s79, v35
    v_or_b32 v31, v31, v30
    v_xor_b32 v30, s79, v37
    v_or_b32 v31, v31, v30
    v_xor_b32 v30, s79, v39
    v_or_b32 v31, v31, v30
    v_cmp_ne_u32 vcc, 0, v31
    s_add_u32 s89, s89, 1
    s_cbranch_vccz L_ok112
    s_cmp_gt_u32 s89, 20000
    s_cbranch_scc1 L_ok112
    s_sleep 1
    s_branch L_poll111
L_ok112:
    v_mov_b32 v33, v34
    v_mov_b32 v37, v38
    v_mov_b32 v24, s79
    v_mov_b32 v25, 1
    ds_write_b64 v11, v[32:33] offset:2176
    ds_write_b64 v11, v[36:37]
    s_mov_b64 exec, 1
    ds_write_b32 v10, v24 offset:8
    ds_add_u32 v10, v25 offset:4
    s_mov_b64 exec, -1
    s_mov_b32 s99, 1
L_qd110:
    s_mov_b32 s89, 0
L_ls113:
    ds_read_b32 v31, v10 offset:4
    s_waitcnt lgkmcnt(0)
    v_readfirstlane_b32 s88, v31
    s_add_u32 s89, s89, 1
    s_cmp_eq_u32 s88, 4
    s_cbranch_scc1 L_lsok114
    s_cmp_gt_u32 s89, 1000000
    s_cbranch_scc1 L_lsok114
    s_sleep 1
    s_branch L_ls113
L_lsok114:
    ds_read_b32 v31, v10 offset:8
    s_waitcnt lgkmcnt(0)
    v_readfirstlane_b32 s79, v31
    ds_read_b128 v[64:67], v7 offset:2176
    ds_read_b128 v[68:71], v7 offset:2240
    ds_read_b128 v[72:75], v7 offset:2304
    ds_read_b128 v[76:79], v7 offset:2368
    v_lshrrev_b32 v24, 3, v0
    v_lshlrev_b32 v12, 12, v24
    v_and_b32 v24, 7, v0
    v_lshl_add_u32 v12, v24, 4, v12
    v_lshrrev_b32 v24, 4, v0
    v_lshlrev_b32 v13, 12, v24
    v_and_b32 v24, 15, v0
    v_lshl_add_u32 v13, v24, 4, v13
    s_lshl_b32 s91, s90, 16
    s_and_b32 s86, s3, 3
    s_lshl_b32 s86, s86, 8
    s_add_u32 s91, s91, s86
    s_add_u32 s91, s91, 1024
    s_waitcnt lgkmcnt(0)
    ds_read_b128 v[64:67], v7 offset:0
    ds_read_b128 v[68:71], v7 offset:64
    ds_read_b128 v[72:75], v7 offset:128
    ds_read_b128 v[76:79], v7 offset:192
    s_waitcnt vmcnt(32)
    s_waitcnt lgkmcnt(0)
    v_mfma_f32_16x16x32_bf16 v[80:83], v[96:99], v[64:67], 0
    v_mfma_f32_16x16x32_bf16 v[84:87], v[112:115], v[64:67], 0
    v_mfma_f32_16x16x32_bf16 v[80:83], v[100:103], v[68:71], v[80:83]
    v_mfma_f32_16x16x32_bf16 v[84:87], v[116:119], v[68:71], v[84:87]
    v_mfma_f32_16x16x32_bf16 v[80:83], v[104:107], v[72:75], v[80:83]
    v_mfma_f32_16x16x32_bf16 v[84:87], v[120:123], v[72:75], v[84:87]
    v_mfma_f32_16x16x32_bf16 v[80:83], v[108:111], v[76:79], v[80:83]
    v_mfma_f32_16x16x32_bf16 v[84:87], v[124:127], v[76:79], v[84:87]
    ds_read_b128 v[64:67], v7 offset:2176
    ds_read_b128 v[68:71], v7 offset:2240
    ds_read_b128 v[72:75], v7 offset:2304
    ds_read_b128 v[76:79], v7 offset:2368
    s_nop 3
    v_max3_f32 v24, v80, v81, v82
    v_max3_f32 v24, v24, v83, v84
    v_max3_f32 v24, v24, v85, v86
    v_max_f32 v24, v24, v87
    v_mov_b32 v25, v24
    s_nop 1
    v_permlane16_swap_b32 v24, v25
    v_max_f32 v24, v24, v25
    v_mov_b32 v25, v24
    s_nop 1
    v_permlane32_swap_b32 v24, v25
    v_max_f32 v24, v24, v25
    v_mul_f32 v26, s78, v24
    v_mov_b32 v29, v24
    v_fma_f32 v80, v80, s78, -v26
    v_fma_f32 v81, v81, s78, -v26
    v_fma_f32 v82, v82, s78, -v26
    v_fma_f32 v83, v83, s78, -v26
    v_fma_f32 v84, v84, s78, -v26
    v_fma_f32 v85, v85, s78, -v26
    v_fma_f32 v86, v86, s78, -v26
    v_fma_f32 v87, v87, s78, -v26
    v_exp_f32 v80, v80
    v_exp_f32 v81, v81
    v_exp_f32 v82, v82
    v_exp_f32 v83, v83
    v_exp_f32 v84, v84
    v_exp_f32 v85, v85
    v_exp_f32 v86, v86
    v_exp_f32 v87, v87
    s_nop 0
    v_add_f32 v24, v80, v81
    v_add_f32 v25, v82, v83
    v_add_f32 v24, v24, v84
    v_add_f32 v25, v25, v85
    v_add_f32 v24, v24, v86
    v_add_f32 v25, v25, v87
    v_cvt_pk_bf16_f32 v88, v80, v81
    v_cvt_pk_bf16_f32 v89, v82, v83
    v_cvt_pk_bf16_f32 v90, v84, v85
    v_cvt_pk_bf16_f32 v91, v86, v87
    v_add_f32 v24, v24, v25
    v_mov_b32 v30, v24
    v_mov_b32 v25, v30
    s_nop 1
    v_permlane16_swap_b32 v30, v25
    v_add_f32 v30, v30, v25
    v_mov_b32 v25, v30
    s_nop 1
    v_permlane32_swap_b32 v30, v25
    v_add_f32 v30, v30, v25
    s_mov_b64 exec, 0xff
    ds_write_b32 v6, v29 offset:0
    ds_write_b32 v6, v30 offset:512
    s_mov_b64 exec, -1
    s_waitcnt vmcnt(24)
    v_perm_b32 v16, v132, v128, s76
    v_perm_b32 v17, v140, v136, s76
    v_perm_b32 v18, v148, v144, s76
    v_perm_b32 v19, v156, v152, s76
    v_perm_b32 v20, v132, v128, s77
    v_perm_b32 v21, v140, v136, s77
    v_perm_b32 v22, v148, v144, s77
    v_perm_b32 v23, v156, v152, s77
    v_mfma_f32_16x16x32_bf16 v[96:99], v[16:19], v[88:91], 0
    v_perm_b32 v16, v133, v129, s76
    v_perm_b32 v17, v141, v137, s76
    v_perm_b32 v18, v149, v145, s76
    v_perm_b32 v19, v157, v153, s76
    v_mfma_f32_16x16x32_bf16 v[100:103], v[20:23], v[88:91], 0
    v_perm_b32 v20, v133, v129, s77
    v_perm_b32 v21, v141, v137, s77
    v_perm_b32 v22, v149, v145, s77
    v_perm_b32 v23, v157, v153, s77
    v_mfma_f32_16x16x32_bf16 v[104:107], v[16:19], v[88:91], 0
    v_perm_b32 v16, v134, v130, s76
    v_perm_b32 v17, v142, v138, s76
    v_perm_b32 v18, v150, v146, s76
    v_perm_b32 v19, v158, v154, s76
    v_mfma_f32_16x16x32_bf16 v[108:111], v[20:23], v[88:91], 0
    v_perm_b32 v20, v134, v130, s77
    v_perm_b32 v21, v142, v138, s77
    v_perm_b32 v22, v150, v146, s77
    v_perm_b32 v23, v158, v154, s77
    v_mfma_f32_16x16x32_bf16 v[112:115], v[16:19], v[88:91], 0
    v_perm_b32 v16, v135, v131, s76
    v_perm_b32 v17, v143, v139, s76
    v_perm_b32 v18, v151, v147, s76
    v_perm_b32 v19, v159, v155, s76
    v_mfma_f32_16x16x32_bf16 v[116:119], v[20:23], v[88:91], 0
    v_perm_b32 v20, v135, v131, s77
    v_perm_b32 v21, v143, v139, s77
    v_perm_b32 v22, v151, v147, s77
    v_perm_b32 v23, v159, v155, s77
    v_mfma_f32_16x16x32_bf16 v[120:123], v[16:19], v[88:91], 0
    s_nop 0
    v_mfma_f32_16x16x32_bf16 v[124:127], v[20:23], v[88:91], 0
    s_add_u32 s85, s83, 0x200000
    buffer_load_dwordx4 v[128:131], v3, s[8:11], s85 offen offset:0 nt
    buffer_load_dwordx4 v[132:135], v3, s[8:11], s85 offen offset:1024 nt
    buffer_load_dwordx4 v[136:139], v3, s[8:11], s85 offen offset:2048 nt
    buffer_load_dwordx4 v[140:143], v3, s[8:11], s85 offen offset:3072 nt
    buffer_load_dwordx4 v[144:147], v4, s[8:11], s85 offen offset:0 nt
    buffer_load_dwordx4 v[148:151], v4, s[8:11], s85 offen offset:1024 nt
    buffer_load_dwordx4 v[152:155], v4, s[8:11], s85 offen offset:2048 nt
    buffer_load_dwordx4 v[156:159], v4, s[8:11], s85 offen offset:3072 nt
    s_mov_b32 exec_lo, 0x00ff00ff
    s_mov_b32 exec_hi, 0x00ff00ff
    ds_write_b128 v5, v[96:99] offset:0
    ds_write_b128 v5, v[100:103] offset:16
    ds_write_b128 v5, v[104:107] offset:32
    ds_write_b128 v5, v[108:111] offset:48
    ds_write_b128 v5, v[112:115] offset:64
    ds_write_b128 v5, v[116:119] offset:80
    ds_write_b128 v5, v[120:123] offset:96
    ds_write_b128 v5, v[124:127] offset:112
    s_mov_b64 exec, -1
    v_mov_b32 v25, 1
    s_mov_b64 exec, 1
    ds_add_u32 v10, v25 offset:12
    s_mov_b64 exec, -1
    s_waitcnt lgkmcnt(0)
    s_add_u32 s85, s83, 0x400000
    buffer_load_dwordx4 v[96:99], v1, s[4:7], s85 offen offset:0 nt
    buffer_load_dwordx4 v[100:103], v1, s[4:7], s85 offen offset:64 nt
    buffer_load_dwordx4 v[104:107], v1, s[4:7], s85 offen offset:128 nt
    buffer_load_dwordx4 v[108:111], v1, s[4:7], s85 offen offset:192 nt
    buffer_load_dwordx4 v[112:115], v2, s[4:7], s85 offen offset:0 nt
    buffer_load_dwordx4 v[116:119], v2, s[4:7], s85 offen offset:64 nt
    buffer_load_dwordx4 v[120:123], v2, s[4:7], s85 offen offset:128 nt
    buffer_load_dwordx4 v[124:127], v2, s[4:7], s85 offen offset:192 nt
    s_lshl_b32 s100, s80, 23
    s_lshl_b32 s85, s3, 13
    s_add_u32 s100, s100, s85
    s_add_u32 s100, s100, 0x600000
    s_lshl_b32 s101, s80, 2
    s_and_b32 s85, s3, 3
    s_add_u32 s101, s101, s85
    s_lshl_b32 s101, s101, 8
    s_add_u32 s101, s101, 0x50000
    s_waitcnt vmcnt(32)
    v_mfma_f32_16x16x32_bf16 v[80:83], v[160:163], v[64:67], 0
    v_mfma_f32_16x16x32_bf16 v[84:87], v[176:179], v[64:67], 0
    v_mfma_f32_16x16x32_bf16 v[80:83], v[164:167], v[68:71], v[80:83]
    v_mfma_f32_16x16x32_bf16 v[84:87], v[180:183], v[68:71], v[84:87]
    v_mfma_f32_16x16x32_bf16 v[80:83], v[168:171], v[72:75], v[80:83]
    v_mfma_f32_16x16x32_bf16 v[84:87], v[184:187], v[72:75], v[84:87]
    v_mfma_f32_16x16x32_bf16 v[80:83], v[172:175], v[76:79], v[80:83]
    v_mfma_f32_16x16x32_bf16 v[84:87], v[188:191], v[76:79], v[84:87]
    s_add_u32 s85, s83, 0x400000
    buffer_load_dwordx4 v[160:163], v3, s[8:11], s85 offen offset:0 nt
    buffer_load_dwordx4 v[164:167], v3, s[8:11], s85 offen offset:1024 nt
    buffer_load_dwordx4 v[168:171], v3, s[8:11], s85 offen offset:2048 nt
    buffer_load_dwordx4 v[172:175], v3, s[8:11], s85 offen offset:3072 nt
    buffer_load_dwordx4 v[176:179], v4, s[8:11], s85 offen offset:0 nt
    buffer_load_dwordx4 v[180:183], v4, s[8:11], s85 offen offset:1024 nt
    buffer_load_dwordx4 v[184:187], v4, s[8:11], s85 offen offset:2048 nt
    buffer_load_dwordx4 v[188:191], v4, s[8:11], s85 offen offset:3072 nt
    v_max3_f32 v24, v80, v81, v82
    v_max3_f32 v24, v24, v83, v84
    v_max3_f32 v24, v24, v85, v86
    v_max_f32 v24, v24, v87
    v_mov_b32 v25, v24
    s_nop 1
    v_permlane16_swap_b32 v24, v25
    v_max_f32 v24, v24, v25
    v_mov_b32 v25, v24
    s_nop 1
    v_permlane32_swap_b32 v24, v25
    v_max_f32 v24, v24, v25
    v_mul_f32 v26, s78, v24
    v_mov_b32 v92, v24
    v_fma_f32 v80, v80, s78, -v26
    v_fma_f32 v81, v81, s78, -v26
    v_fma_f32 v82, v82, s78, -v26
    v_fma_f32 v83, v83, s78, -v26
    v_fma_f32 v84, v84, s78, -v26
    v_fma_f32 v85, v85, s78, -v26
    v_fma_f32 v86, v86, s78, -v26
    v_fma_f32 v87, v87, s78, -v26
    v_exp_f32 v80, v80
    v_exp_f32 v81, v81
    v_exp_f32 v82, v82
    v_exp_f32 v83, v83
    v_exp_f32 v84, v84
    v_exp_f32 v85, v85
    v_exp_f32 v86, v86
    v_exp_f32 v87, v87
    s_nop 0
    v_add_f32 v24, v80, v81
    v_add_f32 v25, v82, v83
    v_add_f32 v24, v24, v84
    v_add_f32 v25, v25, v85
    v_add_f32 v24, v24, v86
    v_add_f32 v25, v25, v87
    v_cvt_pk_bf16_f32 v88, v80, v81
    v_cvt_pk_bf16_f32 v89, v82, v83
    v_cvt_pk_bf16_f32 v90, v84, v85
    v_cvt_pk_bf16_f32 v91, v86, v87
    v_add_f32 v24, v24, v25
    v_mov_b32 v93, v24
    s_waitcnt vmcnt(32)
    v_perm_b32 v16, v196, v192, s76
    v_perm_b32 v17, v204, v200, s76
    v_perm_b32 v18, v212, v208, s76
    v_perm_b32 v19, v220, v216, s76
    v_perm_b32 v20, v196, v192, s77
    v_perm_b32 v21, v204, v200, s77
    v_perm_b32 v22, v212, v208, s77
    v_perm_b32 v23, v220, v216, s77
    v_mfma_f32_16x16x32_bf16 v[32:35], v[16:19], v[88:91], 0
    v_perm_b32 v16, v197, v193, s76
    v_perm_b32 v17, v205, v201, s76
    v_perm_b32 v18, v213, v209, s76
    v_perm_b32 v19, v221, v217, s76
    v_mfma_f32_16x16x32_bf16 v[36:39], v[20:23], v[88:91], 0
    v_perm_b32 v20, v197, v193, s77
    v_perm_b32 v21, v205, v201, s77
    v_perm_b32 v22, v213, v209, s77
    v_perm_b32 v23, v221, v217, s77
    v_mfma_f32_16x16x32_bf16 v[40:43], v[16:19], v[88:91], 0
    v_perm_b32 v16, v198, v194, s76
    v_perm_b32 v17, v206, v202, s76
    v_perm_b32 v18, v214, v210, s76
    v_perm_b32 v19, v222, v218, s76
    v_mfma_f32_16x16x32_bf16 v[44:47], v[20:23], v[88:91], 0
    v_perm_b32 v20, v198, v194, s77
    v_perm_b32 v21, v206, v202, s77
    v_perm_b32 v22, v214, v210, s77
    v_perm_b32 v23, v222, v218, s77
    v_mfma_f32_16x16x32_bf16 v[48:51], v[16:19], v[88:91], 0
    v_perm_b32 v16, v199, v195, s76
    v_perm_b32 v17, v207, v203, s76
    v_perm_b32 v18, v215, v211, s76
    v_perm_b32 v19, v223, v219, s76
    v_mfma_f32_16x16x32_bf16 v[52:55], v[20:23], v[88:91], 0
    v_perm_b32 v20, v199, v195, s77
    v_perm_b32 v21, v207, v203, s77
    v_perm_b32 v22, v215, v211, s77
    v_perm_b32 v23, v223, v219, s77
    v_mfma_f32_16x16x32_bf16 v[56:59], v[16:19], v[88:91], 0
    s_nop 0
    v_mfma_f32_16x16x32_bf16 v[60:63], v[20:23], v[88:91], 0
    v_mov_b32 v95, 1
    s_mov_b64 exec, 1
    buffer_atomic_add v95, off, s[28:31], s101 sc0
    s_mov_b64 exec, -1
    s_waitcnt vmcnt(25)
    v_mfma_f32_16x16x32_bf16 v[80:83], v[224:227], v[64:67], 0
    v_mfma_f32_16x16x32_bf16 v[84:87], v[240:243], v[64:67], 0
    v_mfma_f32_16x16x32_bf16 v[80:83], v[228:231], v[68:71], v[80:83]
    v_mfma_f32_16x16x32_bf16 v[84:87], v[244:247], v[68:71], v[84:87]
    v_mfma_f32_16x16x32_bf16 v[80:83], v[232:235], v[72:75], v[80:83]
    v_mfma_f32_16x16x32_bf16 v[84:87], v[248:251], v[72:75], v[84:87]
    v_mfma_f32_16x16x32_bf16 v[80:83], v[236:239], v[76:79], v[80:83]
    v_mfma_f32_16x16x32_bf16 v[84:87], v[252:255], v[76:79], v[84:87]
    s_nop 7
    v_max3_f32 v24, v80, v81, v82
    v_max3_f32 v24, v24, v83, v84
    v_max3_f32 v24, v24, v85, v86
    v_max3_f32 v24, v24, v87, v92
    v_mov_b32 v25, v24
    s_nop 1
    v_permlane16_swap_b32 v24, v25
    v_max_f32 v24, v24, v25
    v_mov_b32 v25, v24
    s_nop 1
    v_permlane32_swap_b32 v24, v25
    v_max_f32 v24, v24, v25
    v_mul_f32 v26, s78, v24
    v_fma_f32 v28, v92, s78, -v26
    v_exp_f32 v28, v28
    v_mov_b32 v92, v24
    v_fma_f32 v80, v80, s78, -v26
    v_fma_f32 v81, v81, s78, -v26
    v_fma_f32 v82, v82, s78, -v26
    v_fma_f32 v83, v83, s78, -v26
    v_fma_f32 v84, v84, s78, -v26
    v_fma_f32 v85, v85, s78, -v26
    v_fma_f32 v86, v86, s78, -v26
    v_fma_f32 v87, v87, s78, -v26
    v_exp_f32 v80, v80
    v_exp_f32 v81, v81
    v_exp_f32 v82, v82
    v_exp_f32 v83, v83
    v_exp_f32 v84, v84
    v_exp_f32 v85, v85
    v_exp_f32 v86, v86
    v_exp_f32 v87, v87
    v_pk_mul_f32 v[32:33], v[32:33], v[28:29] op_sel_hi:[1,0]
    v_pk_mul_f32 v[34:35], v[34:35], v[28:29] op_sel_hi:[1,0]
    v_pk_mul_f32 v[36:37], v[36:37], v[28:29] op_sel_hi:[1,0]
    v_pk_mul_f32 v[38:39], v[38:39], v[28:29] op_sel_hi:[1,0]
    v_pk_mul_f32 v[40:41], v[40:41], v[28:29] op_sel_hi:[1,0]
    v_pk_mul_f32 v[42:43], v[42:43], v[28:29] op_sel_hi:[1,0]
    v_pk_mul_f32 v[44:45], v[44:45], v[28:29] op_sel_hi:[1,0]
    v_pk_mul_f32 v[46:47], v[46:47], v[28:29] op_sel_hi:[1,0]
    v_pk_mul_f32 v[48:49], v[48:49], v[28:29] op_sel_hi:[1,0]
    v_pk_mul_f32 v[50:51], v[50:51], v[28:29] op_sel_hi:[1,0]
    v_pk_mul_f32 v[52:53], v[52:53], v[28:29] op_sel_hi:[1,0]
    v_pk_mul_f32 v[54:55], v[54:55], v[28:29] op_sel_hi:[1,0]
    v_pk_mul_f32 v[56:57], v[56:57], v[28:29] op_sel_hi:[1,0]
    v_pk_mul_f32 v[58:59], v[58:59], v[28:29] op_sel_hi:[1,0]
    v_pk_mul_f32 v[60:61], v[60:61], v[28:29] op_sel_hi:[1,0]
    v_pk_mul_f32 v[62:63], v[62:63], v[28:29] op_sel_hi:[1,0]
    v_add_f32 v24, v80, v81
    v_add_f32 v25, v82, v83
    v_add_f32 v24, v24, v84
    v_add_f32 v25, v25, v85
    v_add_f32 v24, v24, v86
    v_add_f32 v25, v25, v87
    v_cvt_pk_bf16_f32 v88, v80, v81
    v_cvt_pk_bf16_f32 v89, v82, v83
    v_cvt_pk_bf16_f32 v90, v84, v85
    v_cvt_pk_bf16_f32 v91, v86, v87
    v_add_f32 v24, v24, v25
    v_fma_f32 v93, v93, v28, v24
    s_waitcnt vmcnt(17)
    v_perm_b32 v16, v132, v128, s76
    v_perm_b32 v17, v140, v136, s76
    v_perm_b32 v18, v148, v144, s76
    v_perm_b32 v19, v156, v152, s76
    v_perm_b32 v20, v132, v128, s77
    v_perm_b32 v21, v140, v136, s77
    v_perm_b32 v22, v148, v144, s77
    v_perm_b32 v23, v156, v152, s77
    v_mfma_f32_16x16x32_bf16 v[32:35], v[16:19], v[88:91], v[32:35]
    v_perm_b32 v16, v133, v129, s76
    v_perm_b32 v17, v141, v137, s76
    v_perm_b32 v18, v149, v145, s76
    v_perm_b32 v19, v157, v153, s76
    v_mfma_f32_16x16x32_bf16 v[36:39], v[20:23], v[88:91], v[36:39]
    v_perm_b32 v20, v133, v129, s77
    v_perm_b32 v21, v141, v137, s77
    v_perm_b32 v22, v149, v145, s77
    v_perm_b32 v23, v157, v153, s77
    v_mfma_f32_16x16x32_bf16 v[40:43], v[16:19], v[88:91], v[40:43]
    v_perm_b32 v16, v134, v130, s76
    v_perm_b32 v17, v142, v138, s76
    v_perm_b32 v18, v150, v146, s76
    v_perm_b32 v19, v158, v154, s76
    v_mfma_f32_16x16x32_bf16 v[44:47], v[20:23], v[88:91], v[44:47]
    v_perm_b32 v20, v134, v130, s77
    v_perm_b32 v21, v142, v138, s77
    v_perm_b32 v22, v150, v146, s77
    v_perm_b32 v23, v158, v154, s77
    v_mfma_f32_16x16x32_bf16 v[48:51], v[16:19], v[88:91], v[48:51]
    v_perm_b32 v16, v135, v131, s76
    v_perm_b32 v17, v143, v139, s76
    v_perm_b32 v18, v151, v147, s76
    v_perm_b32 v19, v159, v155, s76
    v_mfma_f32_16x16x32_bf16 v[52:55], v[20:23], v[88:91], v[52:55]
    v_perm_b32 v20, v135, v131, s77
    v_perm_b32 v21, v143, v139, s77
    v_perm_b32 v22, v151, v147, s77
    v_perm_b32 v23, v159, v155, s77
    v_mfma_f32_16x16x32_bf16 v[56:59], v[16:19], v[88:91], v[56:59]
    s_nop 0
    v_mfma_f32_16x16x32_bf16 v[60:63], v[20:23], v[88:91], v[60:63]
    s_waitcnt vmcnt(0)
    v_readfirstlane_b32 s99, v95
    s_nop 0
    s_cmp_ge_u32 s99, 44
    s_cbranch_scc1 L_dend115
    s_sub_u32 s85, s99, 20
    s_lshr_b32 s86, s85, 1
    s_add_u32 s86, s86, 20
    s_lshl_b32 s86, s86, 16
    s_and_b32 s85, s85, 1
    s_lshl_b32 s85, s85, 12
    s_add_u32 s86, s86, s85
    s_lshl_b32 s85, s99, 16
    s_cmp_lt_u32 s99, 20
    s_cselect_b32 s99, s85, s86
    s_cselect_b32 s70, 0, 0xff7fffff
    s_cselect_b32 s85, 0, 0x40000000
    s_add_u32 s99, s99, s100
    v_add_u32 v14, s85, v2
    v_add_u32 v15, s85, v4
    buffer_load_dwordx4 v[192:195], v1, s[4:7], s99 offen offset:0 nt
    buffer_load_dwordx4 v[196:199], v1, s[4:7], s99 offen offset:64 nt
    buffer_load_dwordx4 v[200:203], v1, s[4:7], s99 offen offset:128 nt
    buffer_load_dwordx4 v[204:207], v1, s[4:7], s99 offen offset:192 nt
    buffer_load_dwordx4 v[208:211], v14, s[4:7], s99 offen offset:0 nt
    buffer_load_dwordx4 v[212:215], v14, s[4:7], s99 offen offset:64 nt
    buffer_load_dwordx4 v[216:219], v14, s[4:7], s99 offen offset:128 nt
    buffer_load_dwordx4 v[220:223], v14, s[4:7], s99 offen offset:192 nt
    v_mov_b32 v95, 1
    s_mov_b64 exec, 1
    buffer_atomic_add v95, off, s[28:31], s101 sc0
    s_mov_b64 exec, -1
    v_mfma_f32_16x16x32_bf16 v[80:83], v[96:99], v[64:67], 0
    v_mfma_f32_16x16x32_bf16 v[84:87], v[112:115], v[64:67], 0
    v_mfma_f32_16x16x32_bf16 v[80:83], v[100:103], v[68:71], v[80:83]
    v_mfma_f32_16x16x32_bf16 v[84:87], v[116:119], v[68:71], v[84:87]
    v_mfma_f32_16x16x32_bf16 v[80:83], v[104:107], v[72:75], v[80:83]
    v_mfma_f32_16x16x32_bf16 v[84:87], v[120:123], v[72:75], v[84:87]
    v_mfma_f32_16x16x32_bf16 v[80:83], v[108:111], v[76:79], v[80:83]
    v_mfma_f32_16x16x32_bf16 v[84:87], v[124:127], v[76:79], v[84:87]
    buffer_load_dwordx4 v[224:227], v3, s[8:11], s99 offen offset:0 nt
    buffer_load_dwordx4 v[228:231], v3, s[8:11], s99 offen offset:1024 nt
    buffer_load_dwordx4 v[232:235], v3, s[8:11], s99 offen offset:2048 nt
    buffer_load_dwordx4 v[236:239], v3, s[8:11], s99 offen offset:3072 nt
    buffer_load_dwordx4 v[240:243], v15, s[8:11], s99 offen offset:0 nt
    buffer_load_dwordx4 v[244:247], v15, s[8:11], s99 offen offset:1024 nt
    buffer_load_dwordx4 v[248:251], v15, s[8:11], s99 offen offset:2048 nt
    buffer_load_dwordx4 v[252:255], v15, s[8:11], s99 offen offset:3072 nt
    v_max3_f32 v24, v80, v81, v82
    v_max3_f32 v24, v24, v83, v84
    v_max3_f32 v24, v24, v85, v86
    v_max3_f32 v24, v24, v87, v92
    v_mov_b32 v25, v24
    s_nop 1
    v_permlane16_swap_b32 v24, v25
    v_max_f32 v24, v24, v25
    v_mov_b32 v25, v24
    s_nop 1
    v_permlane32_swap_b32 v24, v25
    v_max_f32 v24, v24, v25
    v_mul_f32 v26, s78, v24
    v_fma_f32 v28, v92, s78, -v26
    v_exp_f32 v28, v28
    v_mov_b32 v92, v24
    v_fma_f32 v80, v80, s78, -v26
    v_fma_f32 v81, v81, s78, -v26
    v_fma_f32 v82, v82, s78, -v26
    v_fma_f32 v83, v83, s78, -v26
    v_fma_f32 v84, v84, s78, -v26
    v_fma_f32 v85, v85, s78, -v26
    v_fma_f32 v86, v86, s78, -v26
    v_fma_f32 v87, v87, s78, -v26
    v_exp_f32 v80, v80
    v_exp_f32 v81, v81
    v_exp_f32 v82, v82
    v_exp_f32 v83, v83
    v_exp_f32 v84, v84
    v_exp_f32 v85, v85
    v_exp_f32 v86, v86
    v_exp_f32 v87, v87
    v_pk_mul_f32 v[32:33], v[32:33], v[28:29] op_sel_hi:[1,0]
    v_pk_mul_f32 v[34:35], v[34:35], v[28:29] op_sel_hi:[1,0]
    v_pk_mul_f32 v[36:37], v[36:37], v[28:29] op_sel_hi:[1,0]
    v_pk_mul_f32 v[38:39], v[38:39], v[28:29] op_sel_hi:[1,0]
    v_pk_mul_f32 v[40:41], v[40:41], v[28:29] op_sel_hi:[1,0]
    v_pk_mul_f32 v[42:43], v[42:43], v[28:29] op_sel_hi:[1,0]
    v_pk_mul_f32 v[44:45], v[44:45], v[28:29] op_sel_hi:[1,0]
    v_pk_mul_f32 v[46:47], v[46:47], v[28:29] op_sel_hi:[1,0]
    v_pk_mul_f32 v[48:49], v[48:49], v[28:29] op_sel_hi:[1,0]
    v_pk_mul_f32 v[50:51], v[50:51], v[28:29] op_sel_hi:[1,0]
    v_pk_mul_f32 v[52:53], v[52:53], v[28:29] op_sel_hi:[1,0]
    v_pk_mul_f32 v[54:55], v[54:55], v[28:29] op_sel_hi:[1,0]
    v_pk_mul_f32 v[56:57], v[56:57], v[28:29] op_sel_hi:[1,0]
    v_pk_mul_f32 v[58:59], v[58:59], v[28:29] op_sel_hi:[1,0]
    v_pk_mul_f32 v[60:61], v[60:61], v[28:29] op_sel_hi:[1,0]
    v_pk_mul_f32 v[62:63], v[62:63], v[28:29] op_sel_hi:[1,0]
    v_add_f32 v24, v80, v81
    v_add_f32 v25, v82, v83
    v_add_f32 v24, v24, v84
    v_add_f32 v25, v25, v85
    v_add_f32 v24, v24, v86
    v_add_f32 v25, v25, v87
    v_cvt_pk_bf16_f32 v88, v80, v81
    v_cvt_pk_bf16_f32 v89, v82, v83
    v_cvt_pk_bf16_f32 v90, v84, v85
    v_cvt_pk_bf16_f32 v91, v86, v87
    v_add_f32 v24, v24, v25
    v_fma_f32 v93, v93, v28, v24
    v_perm_b32 v16, v164, v160, s76
    v_perm_b32 v17, v172, v168, s76
    v_perm_b32 v18, v180, v176, s76
    v_perm_b32 v19, v188, v184, s76
    v_perm_b32 v20, v164, v160, s77
    v_perm_b32 v21, v172, v168, s77
    v_perm_b32 v22, v180, v176, s77
    v_perm_b32 v23, v188, v184, s77
    v_mfma_f32_16x16x32_bf16 v[32:35], v[16:19], v[88:91], v[32:35]
    v_perm_b32 v16, v165, v161, s76
    v_perm_b32 v17, v173, v169, s76
    v_perm_b32 v18, v181, v177, s76
    v_perm_b32 v19, v189, v185, s76
    v_mfma_f32_16x16x32_bf16 v[36:39], v[20:23], v[88:91], v[36:39]
    v_perm_b32 v20, v165, v161, s77
    v_perm_b32 v21, v173, v169, s77
    v_perm_b32 v22, v181, v177, s77
    v_perm_b32 v23, v189, v185, s77
    v_mfma_f32_16x16x32_bf16 v[40:43], v[16:19], v[88:91], v[40:43]
    v_perm_b32 v16, v166, v162, s76
    v_perm_b32 v17, v174, v170, s76
    v_perm_b32 v18, v182, v178, s76
    v_perm_b32 v19, v190, v186, s76
    v_mfma_f32_16x16x32_bf16 v[44:47], v[20:23], v[88:91], v[44:47]
    v_perm_b32 v20, v166, v162, s77
    v_perm_b32 v21, v174, v170, s77
    v_perm_b32 v22, v182, v178, s77
    v_perm_b32 v23, v190, v186, s77
    v_mfma_f32_16x16x32_bf16 v[48:51], v[16:19], v[88:91], v[48:51]
    v_perm_b32 v16, v167, v163, s76
    v_perm_b32 v17, v175, v171, s76
    v_perm_b32 v18, v183, v179, s76
    v_perm_b32 v19, v191, v187, s76
    v_mfma_f32_16x16x32_bf16 v[52:55], v[20:23], v[88:91], v[52:55]
    v_perm_b32 v20, v167, v163, s77
    v_perm_b32 v21, v175, v171, s77
    v_perm_b32 v22, v183, v179, s77
    v_perm_b32 v23, v191, v187, s77
    v_mfma_f32_16x16x32_bf16 v[56:59], v[16:19], v[88:91], v[56:59]
    s_nop 0
    v_mfma_f32_16x16x32_bf16 v[60:63], v[20:23], v[88:91], v[60:63]
    s_waitcnt vmcnt(8)
    v_readfirstlane_b32 s99, v95
    s_nop 0
    s_cmp_ge_u32 s99, 44
    s_cbranch_scc1 L_dend116
    s_sub_u32 s85, s99, 20
    s_lshr_b32 s86, s85, 1
    s_add_u32 s86, s86, 20
    s_lshl_b32 s86, s86, 16
    s_and_b32 s85, s85, 1
    s_lshl_b32 s85, s85, 12
    s_add_u32 s86, s86, s85
    s_lshl_b32 s85, s99, 16
    s_cmp_lt_u32 s99, 20
    s_cselect_b32 s99, s85, s86
    s_cselect_b32 s71, 0, 0xff7fffff
    s_cselect_b32 s85, 0, 0x40000000
    s_add_u32 s99, s99, s100
    v_add_u32 v14, s85, v2
    v_add_u32 v15, s85, v4
    buffer_load_dwordx4 v[128:131], v1, s[4:7], s99 offen offset:0 nt
    buffer_load_dwordx4 v[132:135], v1, s[4:7], s99 offen offset:64 nt
    buffer_load_dwordx4 v[136:139], v1, s[4:7], s99 offen offset:128 nt
    buffer_load_dwordx4 v[140:143], v1, s[4:7], s99 offen offset:192 nt
    buffer_load_dwordx4 v[144:147], v14, s[4:7], s99 offen offset:0 nt
    buffer_load_dwordx4 v[148:151], v14, s[4:7], s99 offen offset:64 nt
    buffer_load_dwordx4 v[152:155], v14, s[4:7], s99 offen offset:128 nt
    buffer_load_dwordx4 v[156:159], v14, s[4:7], s99 offen offset:192 nt
    v_mov_b32 v95, 1
    s_mov_b64 exec, 1
    buffer_atomic_add v95, off, s[28:31], s101 sc0
    s_mov_b64 exec, -1
    v_mov_b32 v84, s70
    v_mov_b32 v85, s70
    v_mov_b32 v86, s70
    v_mov_b32 v87, s70
    s_nop 0
    v_mfma_f32_16x16x32_bf16 v[80:83], v[192:195], v[64:67], 0
    v_mfma_f32_16x16x32_bf16 v[84:87], v[208:211], v[64:67], v[84:87]
    v_mfma_f32_16x16x32_bf16 v[80:83], v[196:199], v[68:71], v[80:83]
    v_mfma_f32_16x16x32_bf16 v[84:87], v[212:215], v[68:71], v[84:87]
    v_mfma_f32_16x16x32_bf16 v[80:83], v[200:203], v[72:75], v[80:83]
    v_mfma_f32_16x16x32_bf16 v[84:87], v[216:219], v[72:75], v[84:87]
    v_mfma_f32_16x16x32_bf16 v[80:83], v[204:207], v[76:79], v[80:83]
    v_mfma_f32_16x16x32_bf16 v[84:87], v[220:223], v[76:79], v[84:87]
    buffer_load_dwordx4 v[96:99], v3, s[8:11], s99 offen offset:0 nt
    buffer_load_dwordx4 v[100:103], v3, s[8:11], s99 offen offset:1024 nt
    buffer_load_dwordx4 v[104:107], v3, s[8:11], s99 offen offset:2048 nt
    buffer_load_dwordx4 v[108:111], v3, s[8:11], s99 offen offset:3072 nt
    buffer_load_dwordx4 v[112:115], v15, s[8:11], s99 offen offset:0 nt
    buffer_load_dwordx4 v[116:119], v15, s[8:11], s99 offen offset:1024 nt
    buffer_load_dwordx4 v[120:123], v15, s[8:11], s99 offen offset:2048 nt
    buffer_load_dwordx4 v[124:127], v15, s[8:11], s99 offen offset:3072 nt
    v_max3_f32 v24, v80, v81, v82
    v_max3_f32 v24, v24, v83, v84
    v_max3_f32 v24, v24, v85, v86
    v_max3_f32 v24, v24, v87, v92
    v_mov_b32 v25, v24
    s_nop 1
    v_permlane16_swap_b32 v24, v25
    v_max_f32 v24, v24, v25
    v_mov_b32 v25, v24
    s_nop 1
    v_permlane32_swap_b32 v24, v25
    v_max_f32 v24, v24, v25
    v_mul_f32 v26, s78, v24
    v_fma_f32 v28, v92, s78, -v26
    v_exp_f32 v28, v28
    v_mov_b32 v92, v24
    v_fma_f32 v80, v80, s78, -v26
    v_fma_f32 v81, v81, s78, -v26
    v_fma_f32 v82, v82, s78, -v26
    v_fma_f32 v83, v83, s78, -v26
    v_fma_f32 v84, v84, s78, -v26
    v_fma_f32 v85, v85, s78, -v26
    v_fma_f32 v86, v86, s78, -v26
    v_fma_f32 v87, v87, s78, -v26
    v_exp_f32 v80, v80
    v_exp_f32 v81, v81
    v_exp_f32 v82, v82
    v_exp_f32 v83, v83
    v_exp_f32 v84, v84
    v_exp_f32 v85, v85
    v_exp_f32 v86, v86
    v_exp_f32 v87, v87
    v_pk_mul_f32 v[32:33], v[32:33], v[28:29] op_sel_hi:[1,0]
    v_pk_mul_f32 v[34:35], v[34:35], v[28:29] op_sel_hi:[1,0]
    v_pk_mul_f32 v[36:37], v[36:37], v[28:29] op_sel_hi:[1,0]
    v_pk_mul_f32 v[38:39], v[38:39], v[28:29] op_sel_hi:[1,0]
    v_pk_mul_f32 v[40:41], v[40:41], v[28:29] op_sel_hi:[1,0]
    v_pk_mul_f32 v[42:43], v[42:43], v[28:29] op_sel_hi:[1,0]
    v_pk_mul_f32 v[44:45], v[44:45], v[28:29] op_sel_hi:[1,0]
    v_pk_mul_f32 v[46:47], v[46:47], v[28:29] op_sel_hi:[1,0]
    v_pk_mul_f32 v[48:49], v[48:49], v[28:29] op_sel_hi:[1,0]
    v_pk_mul_f32 v[50:51], v[50:51], v[28:29] op_sel_hi:[1,0]
    v_pk_mul_f32 v[52:53], v[52:53], v[28:29] op_sel_hi:[1,0]
    v_pk_mul_f32 v[54:55], v[54:55], v[28:29] op_sel_hi:[1,0]
    v_pk_mul_f32 v[56:57], v[56:57], v[28:29] op_sel_hi:[1,0]
    v_pk_mul_f32 v[58:59], v[58:59], v[28:29] op_sel_hi:[1,0]
    v_pk_mul_f32 v[60:61], v[60:61], v[28:29] op_sel_hi:[1,0]
    v_pk_mul_f32 v[62:63], v[62:63], v[28:29] op_sel_hi:[1,0]
    v_add_f32 v24, v80, v81
    v_add_f32 v25, v82, v83
    v_add_f32 v24, v24, v84
    v_add_f32 v25, v25, v85
    v_add_f32 v24, v24, v86
    v_add_f32 v25, v25, v87
    v_cvt_pk_bf16_f32 v88, v80, v81
    v_cvt_pk_bf16_f32 v89, v82, v83
    v_cvt_pk_bf16_f32 v90, v84, v85
    v_cvt_pk_bf16_f32 v91, v86, v87
    v_add_f32 v24, v24, v25
    v_fma_f32 v93, v93, v28, v24
    s_waitcnt vmcnt(17)
    v_perm_b32 v16, v228, v224, s76
    v_perm_b32 v17, v236, v232, s76
    v_perm_b32 v18, v244, v240, s76
    v_perm_b32 v19, v252, v248, s76
    v_perm_b32 v20, v228, v224, s77
    v_perm_b32 v21, v236, v232, s77
    v_perm_b32 v22, v244, v240, s77
    v_perm_b32 v23, v252, v248, s77
    v_mfma_f32_16x16x32_bf16 v[32:35], v[16:19], v[88:91], v[32:35]
    v_perm_b32 v16, v229, v225, s76
    v_perm_b32 v17, v237, v233, s76
    v_perm_b32 v18, v245, v241, s76
    v_perm_b32 v19, v253, v249, s76
    v_mfma_f32_16x16x32_bf16 v[36:39], v[20:23], v[88:91], v[36:39]
    v_perm_b32 v20, v229, v225, s77
    v_perm_b32 v21, v237, v233, s77
    v_perm_b32 v22, v245, v241, s77
    v_perm_b32 v23, v253, v249, s77
    v_mfma_f32_16x16x32_bf16 v[40:43], v[16:19], v[88:91], v[40:43]
    v_perm_b32 v16, v230, v226, s76
    v_perm_b32 v17, v238, v234, s76
    v_perm_b32 v18, v246, v242, s76
    v_perm_b32 v19, v254, v250, s76
    v_mfma_f32_16x16x32_bf16 v[44:47], v[20:23], v[88:91], v[44:47]
    v_perm_b32 v20, v230, v226, s77
    v_perm_b32 v21, v238, v234, s77
    v_perm_b32 v22, v246, v242, s77
    v_perm_b32 v23, v254, v250, s77
    v_mfma_f32_16x16x32_bf16 v[48:51], v[16:19], v[88:91], v[48:51]
    v_perm_b32 v16, v231, v227, s76
    v_perm_b32 v17, v239, v235, s76
    v_perm_b32 v18, v247, v243, s76
    v_perm_b32 v19, v255, v251, s76
    v_mfma_f32_16x16x32_bf16 v[52:55], v[20:23], v[88:91], v[52:55]
    v_perm_b32 v20, v231, v227, s77
    v_perm_b32 v21, v239, v235, s77
    v_perm_b32 v22, v247, v243, s77
    v_perm_b32 v23, v255, v251, s77
    v_mfma_f32_16x16x32_bf16 v[56:59], v[16:19], v[88:91], v[56:59]
    s_nop 0
    v_mfma_f32_16x16x32_bf16 v[60:63], v[20:23], v[88:91], v[60:63]
    s_waitcnt vmcnt(8)
    v_readfirstlane_b32 s99, v95
    s_nop 0
    s_cmp_ge_u32 s99, 44
    s_cbranch_scc1 L_dend117
    s_sub_u32 s85, s99, 20
    s_lshr_b32 s86, s85, 1
    s_add_u32 s86, s86, 20
    s_lshl_b32 s86, s86, 16
    s_and_b32 s85, s85, 1
    s_lshl_b32 s85, s85, 12
    s_add_u32 s86, s86, s85
    s_lshl_b32 s85, s99, 16
    s_cmp_lt_u32 s99, 20
    s_cselect_b32 s99, s85, s86
    s_cselect_b32 s75, 0, 0xff7fffff
    s_cselect_b32 s85, 0, 0x40000000
    s_add_u32 s99, s99, s100
    v_add_u32 v14, s85, v2
    v_add_u32 v15, s85, v4
    buffer_load_dwordx4 v[160:163], v1, s[4:7], s99 offen offset:0 nt
    buffer_load_dwordx4 v[164:167], v1, s[4:7], s99 offen offset:64 nt
    buffer_load_dwordx4 v[168:171], v1, s[4:7], s99 offen offset:128 nt
    buffer_load_dwordx4 v[172:175], v1, s[4:7], s99 offen offset:192 nt
    buffer_load_dwordx4 v[176:179], v14, s[4:7], s99 offen offset:0 nt
    buffer_load_dwordx4 v[180:183], v14, s[4:7], s99 offen offset:64 nt
    buffer_load_dwordx4 v[184:187], v14, s[4:7], s99 offen offset:128 nt
    buffer_load_dwordx4 v[188:191], v14, s[4:7], s99 offen offset:192 nt
    v_mov_b32 v84, s71
    v_mov_b32 v85, s71
    v_mov_b32 v86, s71
    v_mov_b32 v87, s71
    s_nop 0
    v_mfma_f32_16x16x32_bf16 v[80:83], v[128:131], v[64:67], 0
    v_mfma_f32_16x16x32_bf16 v[84:87], v[144:147], v[64:67], v[84:87]
    v_mfma_f32_16x16x32_bf16 v[80:83], v[132:135], v[68:71], v[80:83]
    v_mfma_f32_16x16x32_bf16 v[84:87], v[148:151], v[68:71], v[84:87]
    v_mfma_f32_16x16x32_bf16 v[80:83], v[136:139], v[72:75], v[80:83]
    v_mfma_f32_16x16x32_bf16 v[84:87], v[152:155], v[72:75], v[84:87]
    v_mfma_f32_16x16x32_bf16 v[80:83], v[140:143], v[76:79], v[80:83]
    v_mfma_f32_16x16x32_bf16 v[84:87], v[156:159], v[76:79], v[84:87]
    buffer_load_dwordx4 v[192:195], v3, s[8:11], s99 offen offset:0 nt
    buffer_load_dwordx4 v[196:199], v3, s[8:11], s99 offen offset:1024 nt
    buffer_load_dwordx4 v[200:203], v3, s[8:11], s99 offen offset:2048 nt
    buffer_load_dwordx4 v[204:207], v3, s[8:11], s99 offen offset:3072 nt
    buffer_load_dwordx4 v[208:211], v15, s[8:11], s99 offen offset:0 nt
    buffer_load_dwordx4 v[212:215], v15, s[8:11], s99 offen offset:1024 nt
    buffer_load_dwordx4 v[216:219], v15, s[8:11], s99 offen offset:2048 nt
    buffer_load_dwordx4 v[220:223], v15, s[8:11], s99 offen offset:3072 nt
    v_max3_f32 v24, v80, v81, v82
    v_max3_f32 v24, v24, v83, v84
    v_max3_f32 v24, v24, v85, v86
    v_max3_f32 v24, v24, v87, v92
    v_mov_b32 v25, v24
    s_nop 1
    v_permlane16_swap_b32 v24, v25
    v_max_f32 v24, v24, v25
    v_mov_b32 v25, v24
    s_nop 1
    v_permlane32_swap_b32 v24, v25
    v_max_f32 v24, v24, v25
    v_mul_f32 v26, s78, v24
    v_fma_f32 v28, v92, s78, -v26
    v_exp_f32 v28, v28
    v_mov_b32 v92, v24
    v_fma_f32 v80, v80, s78, -v26
    v_fma_f32 v81, v81, s78, -v26
    v_fma_f32 v82, v82, s78, -v26
    v_fma_f32 v83, v83, s78, -v26
    v_fma_f32 v84, v84, s78, -v26
    v_fma_f32 v85, v85, s78, -v26
    v_fma_f32 v86, v86, s78, -v26
    v_fma_f32 v87, v87, s78, -v26
    v_exp_f32 v80, v80
    v_exp_f32 v81, v81
    v_exp_f32 v82, v82
    v_exp_f32 v83, v83
    v_exp_f32 v84, v84
    v_exp_f32 v85, v85
    v_exp_f32 v86, v86
    v_exp_f32 v87, v87
    v_pk_mul_f32 v[32:33], v[32:33], v[28:29] op_sel_hi:[1,0]
    v_pk_mul_f32 v[34:35], v[34:35], v[28:29] op_sel_hi:[1,0]
    v_pk_mul_f32 v[36:37], v[36:37], v[28:29] op_sel_hi:[1,0]
    v_pk_mul_f32 v[38:39], v[38:39], v[28:29] op_sel_hi:[1,0]
    v_pk_mul_f32 v[40:41], v[40:41], v[28:29] op_sel_hi:[1,0]
    v_pk_mul_f32 v[42:43], v[42:43], v[28:29] op_sel_hi:[1,0]
    v_pk_mul_f32 v[44:45], v[44:45], v[28:29] op_sel_hi:[1,0]
    v_pk_mul_f32 v[46:47], v[46:47], v[28:29] op_sel_hi:[1,0]
    v_pk_mul_f32 v[48:49], v[48:49], v[28:29] op_sel_hi:[1,0]
    v_pk_mul_f32 v[50:51], v[50:51], v[28:29] op_sel_hi:[1,0]
    v_pk_mul_f32 v[52:53], v[52:53], v[28:29] op_sel_hi:[1,0]
    v_pk_mul_f32 v[54:55], v[54:55], v[28:29] op_sel_hi:[1,0]
    v_pk_mul_f32 v[56:57], v[56:57], v[28:29] op_sel_hi:[1,0]
    v_pk_mul_f32 v[58:59], v[58:59], v[28:29] op_sel_hi:[1,0]
    v_pk_mul_f32 v[60:61], v[60:61], v[28:29] op_sel_hi:[1,0]
    v_pk_mul_f32 v[62:63], v[62:63], v[28:29] op_sel_hi:[1,0]
    v_add_f32 v24, v80, v81
    v_add_f32 v25, v82, v83
    v_add_f32 v24, v24, v84
    v_add_f32 v25, v25, v85
    v_add_f32 v24, v24, v86
    v_add_f32 v25, v25, v87
    v_cvt_pk_bf16_f32 v88, v80, v81
    v_cvt_pk_bf16_f32 v89, v82, v83
    v_cvt_pk_bf16_f32 v90, v84, v85
    v_cvt_pk_bf16_f32 v91, v86, v87
    v_add_f32 v24, v24, v25
    v_fma_f32 v93, v93, v28, v24
    s_waitcnt vmcnt(16)
    v_perm_b32 v16, v100, v96, s76
    v_perm_b32 v17, v108, v104, s76
    v_perm_b32 v18, v116, v112, s76
    v_perm_b32 v19, v124, v120, s76
    v_perm_b32 v20, v100, v96, s77
    v_perm_b32 v21, v108, v104, s77
    v_perm_b32 v22, v116, v112, s77
    v_perm_b32 v23, v124, v120, s77
    v_mfma_f32_16x16x32_bf16 v[32:35], v[16:19], v[88:91], v[32:35]
    v_perm_b32 v16, v101, v97, s76
    v_perm_b32 v17, v109, v105, s76
    v_perm_b32 v18, v117, v113, s76
    v_perm_b32 v19, v125, v121, s76
    v_mfma_f32_16x16x32_bf16 v[36:39], v[20:23], v[88:91], v[36:39]
    v_perm_b32 v20, v101, v97, s77
    v_perm_b32 v21, v109, v105, s77
    v_perm_b32 v22, v117, v113, s77
    v_perm_b32 v23, v125, v121, s77
    v_mfma_f32_16x16x32_bf16 v[40:43], v[16:19], v[88:91], v[40:43]
    v_perm_b32 v16, v102, v98, s76
    v_perm_b32 v17, v110, v106, s76
    v_perm_b32 v18, v118, v114, s76
    v_perm_b32 v19, v126, v122, s76
    v_mfma_f32_16x16x32_bf16 v[44:47], v[20:23], v[88:91], v[44:47]
    v_perm_b32 v20, v102, v98, s77
    v_perm_b32 v21, v110, v106, s77
    v_perm_b32 v22, v118, v114, s77
    v_perm_b32 v23, v126, v122, s77
    v_mfma_f32_16x16x32_bf16 v[48:51], v[16:19], v[88:91], v[48:51]
    v_perm_b32 v16, v103, v99, s76
    v_perm_b32 v17, v111, v107, s76
    v_perm_b32 v18, v119, v115, s76
    v_perm_b32 v19, v127, v123, s76
    v_mfma_f32_16x16x32_bf16 v[52:55], v[20:23], v[88:91], v[52:55]
    v_perm_b32 v20, v103, v99, s77
    v_perm_b32 v21, v111, v107, s77
    v_perm_b32 v22, v119, v115, s77
    v_perm_b32 v23, v127, v123, s77
    v_mfma_f32_16x16x32_bf16 v[56:59], v[16:19], v[88:91], v[56:59]
    s_nop 0
    v_mfma_f32_16x16x32_bf16 v[60:63], v[20:23], v[88:91], v[60:63]
    s_mov_b32 s101, 255
    s_add_u32 s85, s91, 0
    buffer_load_dwordx4 v[224:227], v13, s[20:23], s85 offen offset:0 nt
    s_add_u32 s85, s91, 16384
    buffer_load_dwordx4 v[228:231], v13, s[20:23], s85 offen offset:0 nt
    s_add_u32 s85, s91, 32768
    buffer_load_dwordx4 v[232:235], v13, s[20:23], s85 offen offset:0 nt
    s_add_u32 s85, s91, 49152
    buffer_load_dwordx4 v[236:239], v13, s[20:23], s85 offen offset:0 nt
    s_add_u32 s85, s91, 0
    buffer_load_dwordx4 v[240:243], v13, s[20:23], s85 offen offset:2048 nt
    s_add_u32 s85, s91, 16384
    buffer_load_dwordx4 v[244:247], v13, s[20:23], s85 offen offset:2048 nt
    s_add_u32 s85, s91, 32768
    buffer_load_dwordx4 v[248:251], v13, s[20:23], s85 offen offset:2048 nt
    s_add_u32 s85, s91, 49152
    buffer_load_dwordx4 v[252:255], v13, s[20:23], s85 offen offset:2048 nt
    s_mov_b32 s73, s101
    v_bfe_u32 v26, v0, 2, 1
    v_lshlrev_b32 v2, 6, v26
    v_lshrrev_b32 v26, 4, v0
    v_lshl_add_u32 v2, v26, 4, v2
    v_bfe_u32 v26, v0, 4, 1
    v_lshlrev_b32 v4, 19, v26
    v_bfe_u32 v26, v0, 3, 1
    v_lshl_add_u32 v4, v26, 14, v4
    v_and_b32 v26, 7, v0
    v_lshl_add_u32 v4, v26, 4, v4
    v_lshrrev_b32 v26, 5, v0
    v_lshl_add_u32 v4, v26, 15, v4
    s_and_b32 s98, s3, 3
    s_lshl_b32 s98, s98, 16
    s_lshl_b32 s86, s90, 7
    s_add_u32 s98, s98, s86
    s_add_u32 s98, s98, 0x640000
    s_mov_b32 s100, 0
    s_mov_b32 s101, -1
    s_mov_b32 s4, 0x7060500
    s_mov_b32 s5, 0x7060501
    s_mov_b32 s6, 0x7060502
    s_mov_b32 s7, 0x7060503
    s_waitcnt vmcnt(16)
    v_mov_b32 v84, s75
    v_mov_b32 v85, s75
    v_mov_b32 v86, s75
    v_mov_b32 v87, s75
    s_nop 0
    v_mfma_f32_16x16x32_bf16 v[80:83], v[160:163], v[64:67], 0
    v_mfma_f32_16x16x32_bf16 v[84:87], v[176:179], v[64:67], v[84:87]
    v_mfma_f32_16x16x32_bf16 v[80:83], v[164:167], v[68:71], v[80:83]
    v_mfma_f32_16x16x32_bf16 v[84:87], v[180:183], v[68:71], v[84:87]
    v_mfma_f32_16x16x32_bf16 v[80:83], v[168:171], v[72:75], v[80:83]
    v_mfma_f32_16x16x32_bf16 v[84:87], v[184:187], v[72:75], v[84:87]
    v_mfma_f32_16x16x32_bf16 v[80:83], v[172:175], v[76:79], v[80:83]
    v_mfma_f32_16x16x32_bf16 v[84:87], v[188:191], v[76:79], v[84:87]
    v_mov_b32 v25, s73
    s_mov_b64 exec, 1
    ds_max_u32 v10, v25 offset:28
    s_mov_b64 exec, -1
    v_mov_b32 v25, 1
    s_mov_b64 exec, 1
    ds_add_u32 v10, v25 offset:24
    s_mov_b64 exec, -1
    s_nop 3
    v_max3_f32 v24, v80, v81, v82
    v_max3_f32 v24, v24, v83, v84
    v_max3_f32 v24, v24, v85, v86
    v_max3_f32 v24, v24, v87, v92
    v_mov_b32 v25, v24
    s_nop 1
    v_permlane16_swap_b32 v24, v25
    v_max_f32 v24, v24, v25
    v_mov_b32 v25, v24
    s_nop 1
    v_permlane32_swap_b32 v24, v25
    v_max_f32 v24, v24, v25
    s_setprio 2
    v_mul_f32 v26, s78, v24
    v_fma_f32 v28, v92, s78, -v26
    v_exp_f32 v28, v28
    v_mov_b32 v92, v24
    v_fma_f32 v80, v80, s78, -v26
    v_fma_f32 v81, v81, s78, -v26
    v_fma_f32 v82, v82, s78, -v26
    v_fma_f32 v83, v83, s78, -v26
    v_fma_f32 v84, v84, s78, -v26
    v_fma_f32 v85, v85, s78, -v26
    v_fma_f32 v86, v86, s78, -v26
    v_fma_f32 v87, v87, s78, -v26
    v_exp_f32 v80, v80
    v_exp_f32 v81, v81
    v_exp_f32 v82, v82
    v_exp_f32 v83, v83
    v_exp_f32 v84, v84
    v_exp_f32 v85, v85
    v_exp_f32 v86, v86
    v_exp_f32 v87, v87
    v_pk_mul_f32 v[32:33], v[32:33], v[28:29] op_sel_hi:[1,0]
    v_pk_mul_f32 v[34:35], v[34:35], v[28:29] op_sel_hi:[1,0]
    v_pk_mul_f32 v[36:37], v[36:37], v[28:29] op_sel_hi:[1,0]
    v_pk_mul_f32 v[38:39], v[38:39], v[28:29] op_sel_hi:[1,0]
    v_pk_mul_f32 v[40:41], v[40:41], v[28:29] op_sel_hi:[1,0]
    v_pk_mul_f32 v[42:43], v[42:43], v[28:29] op_sel_hi:[1,0]
    v_pk_mul_f32 v[44:45], v[44:45], v[28:29] op_sel_hi:[1,0]
    v_pk_mul_f32 v[46:47], v[46:47], v[28:29] op_sel_hi:[1,0]
    v_pk_mul_f32 v[48:49], v[48:49], v[28:29] op_sel_hi:[1,0]
    v_pk_mul_f32 v[50:51], v[50:51], v[28:29] op_sel_hi:[1,0]
    v_pk_mul_f32 v[52:53], v[52:53], v[28:29] op_sel_hi:[1,0]
    v_pk_mul_f32 v[54:55], v[54:55], v[28:29] op_sel_hi:[1,0]
    v_pk_mul_f32 v[56:57], v[56:57], v[28:29] op_sel_hi:[1,0]
    v_pk_mul_f32 v[58:59], v[58:59], v[28:29] op_sel_hi:[1,0]
    v_pk_mul_f32 v[60:61], v[60:61], v[28:29] op_sel_hi:[1,0]
    v_pk_mul_f32 v[62:63], v[62:63], v[28:29] op_sel_hi:[1,0]
    v_add_f32 v24, v80, v81
    v_add_f32 v25, v82, v83
    v_add_f32 v24, v24, v84
    v_add_f32 v25, v25, v85
    v_add_f32 v24, v24, v86
    v_add_f32 v25, v25, v87
    v_cvt_pk_bf16_f32 v88, v80, v81
    v_cvt_pk_bf16_f32 v89, v82, v83
    v_cvt_pk_bf16_f32 v90, v84, v85
    v_cvt_pk_bf16_f32 v91, v86, v87
    v_add_f32 v24, v24, v25
    v_fma_f32 v93, v93, v28, v24
    v_mov_b32 v25, v93
    s_nop 1
    v_permlane16_swap_b32 v93, v25
    v_add_f32 v93, v93, v25
    v_mov_b32 v25, v93
    s_nop 1
    v_permlane32_swap_b32 v93, v25
    v_add_f32 v93, v93, v25
    s_mov_b64 exec, 0xff
    ds_write_b32 v6, v92 offset:256
    ds_write_b32 v6, v93 offset:768
    s_mov_b64 exec, -1
    v_mov_b32 v147, s79
    s_waitcnt vmcnt(10)
    s_add_u32 s85, s91, 0
    buffer_load_dwordx4 v[160:163], v13, s[24:27], s85 offen offset:0 nt
    s_add_u32 s85, s91, 16384
    buffer_load_dwordx4 v[164:167], v13, s[24:27], s85 offen offset:0 nt
    s_add_u32 s85, s91, 32768
    buffer_load_dwordx4 v[168:171], v13, s[24:27], s85 offen offset:0 nt
    s_add_u32 s85, s91, 49152
    buffer_load_dwordx4 v[172:175], v13, s[24:27], s85 offen offset:0 nt
    v_perm_b32 v96, v196, v192, s76
    v_perm_b32 v100, v196, v192, s77
    v_perm_b32 v104, v197, v193, s76
    v_perm_b32 v108, v197, v193, s77
    v_perm_b32 v112, v198, v194, s76
    v_perm_b32 v116, v198, v194, s77
    v_perm_b32 v120, v199, v195, s76
    v_perm_b32 v124, v199, v195, s77
    v_perm_b32 v97, v204, v200, s76
    v_perm_b32 v101, v204, v200, s77
    v_perm_b32 v105, v205, v201, s76
    v_perm_b32 v109, v205, v201, s77
    v_perm_b32 v113, v206, v202, s76
    v_perm_b32 v117, v206, v202, s77
    v_perm_b32 v121, v207, v203, s76
    v_perm_b32 v125, v207, v203, s77
    v_perm_b32 v98, v212, v208, s76
    v_perm_b32 v102, v212, v208, s77
    v_perm_b32 v106, v213, v209, s76
    v_perm_b32 v110, v213, v209, s77
    v_perm_b32 v114, v214, v210, s76
    v_perm_b32 v118, v214, v210, s77
    v_perm_b32 v122, v215, v211, s76
    v_perm_b32 v126, v215, v211, s77
    s_waitcnt vmcnt(12)
    v_perm_b32 v99, v220, v216, s76
    v_perm_b32 v103, v220, v216, s77
    v_perm_b32 v107, v221, v217, s76
    v_mfma_f32_16x16x32_bf16 v[32:35], v[96:99], v[88:91], v[32:35]
    v_perm_b32 v111, v221, v217, s77
    v_mfma_f32_16x16x32_bf16 v[36:39], v[100:103], v[88:91], v[36:39]
    v_perm_b32 v115, v222, v218, s76
    v_mfma_f32_16x16x32_bf16 v[40:43], v[104:107], v[88:91], v[40:43]
    v_perm_b32 v119, v222, v218, s77
    v_mfma_f32_16x16x32_bf16 v[44:47], v[108:111], v[88:91], v[44:47]
    v_perm_b32 v123, v223, v219, s76
    v_mfma_f32_16x16x32_bf16 v[48:51], v[112:115], v[88:91], v[48:51]
    v_perm_b32 v127, v223, v219, s77
    v_mfma_f32_16x16x32_bf16 v[52:55], v[116:119], v[88:91], v[52:55]
    s_nop 0
    v_mfma_f32_16x16x32_bf16 v[56:59], v[120:123], v[88:91], v[56:59]
    v_mfma_f32_16x16x32_bf16 v[60:63], v[124:127], v[88:91], v[60:63]
    s_mov_b32 exec_lo, 0x00ff00ff
    s_mov_b32 exec_hi, 0x00ff00ff
    ds_write_b128 v5, v[32:35] offset:33792
    ds_write_b128 v5, v[36:39] offset:33808
    ds_write_b128 v5, v[40:43] offset:33824
    ds_write_b128 v5, v[44:47] offset:33840
    ds_write_b128 v5, v[48:51] offset:33856
    ds_write_b128 v5, v[52:55] offset:33872
    ds_write_b128 v5, v[56:59] offset:33888
    ds_write_b128 v5, v[60:63] offset:33904
    s_mov_b64 exec, -1
    v_and_b32 v144, 1, v0
    v_cmp_eq_u32 vcc, 1, v144
    s_setprio 0
    s_waitcnt lgkmcnt(0)
    s_barrier
    ds_read_b32 v128, v9 offset:256
    ds_read_b128 v[132:135], v9 offset:272
    ds_read_b128 v[96:99], v8 offset:33792
    ds_read_b128 v[100:103], v8 offset:50688
    ds_read_b128 v[104:107], v8 offset:54912
    ds_read_b128 v[108:111], v8 offset:59136
    ds_read_b128 v[112:115], v8 offset:63360
    ds_read_b32 v136, v9 offset:768
    ds_read_b128 v[140:143], v9 offset:784
    s_waitcnt lgkmcnt(7)
    v_max3_f32 v146, v128, v132, v133
    v_max3_f32 v146, v146, v134, v135
    v_mul_f32 v26, s78, v146
    v_fma_f32 v128, v128, s78, -v26
    v_fma_f32 v132, v132, s78, -v26
    v_fma_f32 v133, v133, s78, -v26
    v_fma_f32 v134, v134, s78, -v26
    v_fma_f32 v135, v135, s78, -v26
    v_exp_f32 v128, v128
    v_exp_f32 v132, v132
    v_exp_f32 v133, v133
    v_exp_f32 v134, v134
    v_exp_f32 v135, v135
    s_waitcnt lgkmcnt(2)
    v_pk_mul_f32 v[148:149], v[96:97], v[128:129] op_sel:[0,0] op_sel_hi:[1,0]
    v_pk_mul_f32 v[150:151], v[98:99], v[128:129] op_sel:[0,0] op_sel_hi:[1,0]
    v_pk_fma_f32 v[148:149], v[100:101], v[132:133], v[148:149] op_sel:[0,0,0] op_sel_hi:[1,0,1]
    v_pk_fma_f32 v[150:151], v[102:103], v[132:133], v[150:151] op_sel:[0,0,0] op_sel_hi:[1,0,1]
    v_pk_fma_f32 v[148:149], v[104:105], v[132:133], v[148:149] op_sel:[0,1,0] op_sel_hi:[1,1,1]
    v_pk_fma_f32 v[150:151], v[106:107], v[132:133], v[150:151] op_sel:[0,1,0] op_sel_hi:[1,1,1]
    v_pk_fma_f32 v[148:149], v[108:109], v[134:135], v[148:149] op_sel:[0,0,0] op_sel_hi:[1,0,1]
    v_pk_fma_f32 v[150:151], v[110:111], v[134:135], v[150:151] op_sel:[0,0,0] op_sel_hi:[1,0,1]
    v_pk_fma_f32 v[148:149], v[112:113], v[134:135], v[148:149] op_sel:[0,1,0] op_sel_hi:[1,1,1]
    v_pk_fma_f32 v[150:151], v[114:115], v[134:135], v[150:151] op_sel:[0,1,0] op_sel_hi:[1,1,1]
    s_waitcnt lgkmcnt(0)
    v_mul_f32 v129, v128, v136
    v_fmac_f32 v129, v132, v140
    v_fmac_f32 v129, v133, v141
    v_fmac_f32 v129, v134, v142
    v_fmac_f32 v129, v135, v143
    v_cvt_pk_bf16_f32 v144, v148, v149
    v_cvt_pk_bf16_f32 v145, v150, v151
    v_cndmask_b32 v146, v146, v129, vcc
    s_mov_b32 exec_hi, 0
    buffer_store_dwordx4 v[144:147], v12, s[28:31], s92 offen sc1
    s_mov_b32 exec_hi, -1
    s_add_u32 s85, s91, 0
    buffer_load_dwordx4 v[176:179], v13, s[24:27], s85 offen offset:2048 nt
    s_add_u32 s85, s91, 16384
    buffer_load_dwordx4 v[180:183], v13, s[24:27], s85 offen offset:2048 nt
    s_add_u32 s85, s91, 32768
    buffer_load_dwordx4 v[184:187], v13, s[24:27], s85 offen offset:2048 nt
    s_add_u32 s85, s91, 49152
    buffer_load_dwordx4 v[188:191], v13, s[24:27], s85 offen offset:2048 nt
    s_setprio 2
    v_mov_b32 v84, s79
    s_waitcnt vmcnt(9)
    v_perm_b32 v96, v228, v224, s76
    v_perm_b32 v97, v236, v232, s76
    v_perm_b32 v98, v244, v240, s76
    v_perm_b32 v99, v252, v248, s76
    v_perm_b32 v100, v228, v224, s77
    v_perm_b32 v101, v236, v232, s77
    v_perm_b32 v102, v244, v240, s77
    v_perm_b32 v103, v252, v248, s77
    v_perm_b32 v104, v229, v225, s76
    v_perm_b32 v105, v237, v233, s76
    v_perm_b32 v106, v245, v241, s76
    v_perm_b32 v107, v253, v249, s76
    v_perm_b32 v108, v229, v225, s77
    v_perm_b32 v109, v237, v233, s77
    v_perm_b32 v110, v245, v241, s77
    v_perm_b32 v111, v253, v249, s77
    v_perm_b32 v112, v230, v226, s76
    v_perm_b32 v113, v238, v234, s76
    v_perm_b32 v114, v246, v242, s76
    v_perm_b32 v115, v254, v250, s76
    v_perm_b32 v116, v230, v226, s77
    v_perm_b32 v117, v238, v234, s77
    v_perm_b32 v118, v246, v242, s77
    v_perm_b32 v119, v254, v250, s77
    v_perm_b32 v120, v231, v227, s76
    v_perm_b32 v121, v239, v235, s76
    v_perm_b32 v122, v247, v243, s76
    v_perm_b32 v123, v255, v251, s76
    v_perm_b32 v124, v231, v227, s77
    v_perm_b32 v125, v239, v235, s77
    v_perm_b32 v126, v247, v243, s77
    v_perm_b32 v127, v255, v251, s77
    s_waitcnt vmcnt(0)
    v_perm_b32 v192, v164, v160, s76
    v_perm_b32 v193, v172, v168, s76
    v_perm_b32 v194, v180, v176, s76
    v_perm_b32 v195, v188, v184, s76
    v_perm_b32 v196, v164, v160, s77
    v_perm_b32 v197, v172, v168, s77
    v_perm_b32 v198, v180, v176, s77
    v_perm_b32 v199, v188, v184, s77
    v_perm_b32 v200, v165, v161, s76
    v_perm_b32 v201, v173, v169, s76
    v_perm_b32 v202, v181, v177, s76
    v_perm_b32 v203, v189, v185, s76
    v_perm_b32 v204, v165, v161, s77
    v_perm_b32 v205, v173, v169, s77
    v_perm_b32 v206, v181, v177, s77
    v_perm_b32 v207, v189, v185, s77
    v_perm_b32 v208, v166, v162, s76
    v_perm_b32 v209, v174, v170, s76
    v_perm_b32 v210, v182, v178, s76
    v_perm_b32 v211, v190, v186, s76
    v_perm_b32 v212, v166, v162, s77
    v_perm_b32 v213, v174, v170, s77
    v_perm_b32 v214, v182, v178, s77
    v_perm_b32 v215, v190, v186, s77
    v_perm_b32 v216, v167, v163, s76
    v_perm_b32 v217, v175, v171, s76
    v_perm_b32 v218, v183, v179, s76
    v_perm_b32 v219, v191, v187, s76
    v_perm_b32 v220, v167, v163, s77
    v_perm_b32 v221, v175, v171, s77
    v_perm_b32 v222, v183, v179, s77
    v_perm_b32 v223, v191, v187, s77
    s_mov_b32 s89, 0
L_ls118:
    ds_read_b32 v31, v10 offset:16
    s_waitcnt lgkmcnt(0)
    v_readfirstlane_b32 s88, v31
    s_add_u32 s89, s89, 1
    s_cmp_eq_u32 s88, 2
    s_cbranch_scc1 L_lsok119
    s_cmp_gt_u32 s89, 1000000
    s_cbranch_scc1 L_lsok119
    s_sleep 1
    s_branch L_ls118
L_lsok119:
    ds_read_b128 v[72:75], v2 offset:1024
    s_waitcnt lgkmcnt(0)
    v_mfma_f32_16x16x32_bf16 v[32:35], v[72:75], v[96:99], 0
    v_mfma_f32_16x16x32_bf16 v[36:39], v[72:75], v[100:103], 0
    v_mfma_f32_16x16x32_bf16 v[40:43], v[72:75], v[104:107], 0
    v_mfma_f32_16x16x32_bf16 v[44:47], v[72:75], v[108:111], 0
    v_mfma_f32_16x16x32_bf16 v[48:51], v[72:75], v[112:115], 0
    v_mfma_f32_16x16x32_bf16 v[52:55], v[72:75], v[116:119], 0
    v_mfma_f32_16x16x32_bf16 v[56:59], v[72:75], v[120:123], 0
    v_mfma_f32_16x16x32_bf16 v[60:63], v[72:75], v[124:127], 0
    s_barrier
    ds_read_b128 v[76:79], v2 offset:1152
    s_waitcnt lgkmcnt(0)
    v_mfma_f32_16x16x32_bf16 v[32:35], v[76:79], v[192:195], v[32:35]
    v_mfma_f32_16x16x32_bf16 v[48:51], v[76:79], v[208:211], v[48:51]
    v_mfma_f32_16x16x32_bf16 v[36:39], v[76:79], v[196:199], v[36:39]
    v_mfma_f32_16x16x32_bf16 v[52:55], v[76:79], v[212:215], v[52:55]
    v_mfma_f32_16x16x32_bf16 v[40:43], v[76:79], v[200:203], v[40:43]
    v_mfma_f32_16x16x32_bf16 v[56:59], v[76:79], v[216:219], v[56:59]
    v_mfma_f32_16x16x32_bf16 v[44:47], v[76:79], v[204:207], v[44:47]
    v_mfma_f32_16x16x32_bf16 v[60:63], v[76:79], v[220:223], v[60:63]
    s_nop 4
    v_cndmask_b32 v80, v32, v48, s[100:101]
    v_cndmask_b32 v81, v36, v52, s[100:101]
    v_cndmask_b32 v82, v40, v56, s[100:101]
    v_cndmask_b32 v83, v44, v60, s[100:101]
    v_perm_b32 v80, v80, v84, s4
    v_perm_b32 v81, v81, v84, s5
    v_perm_b32 v82, v82, v84, s6
    v_perm_b32 v83, v83, v84, s7
    buffer_store_dwordx4 v[80:83], v4, s[28:31], s98 offen sc1
    s_endpgm
L_dend115:
    s_add_u32 s101, s99, 0
    s_add_u32 s85, s91, 0
    buffer_load_dwordx4 v[192:195], v13, s[20:23], s85 offen offset:0 nt
    s_add_u32 s85, s91, 16384
    buffer_load_dwordx4 v[196:199], v13, s[20:23], s85 offen offset:0 nt
    s_add_u32 s85, s91, 32768
    buffer_load_dwordx4 v[200:203], v13, s[20:23], s85 offen offset:0 nt
    s_add_u32 s85, s91, 49152
    buffer_load_dwordx4 v[204:207], v13, s[20:23], s85 offen offset:0 nt
    s_add_u32 s85, s91, 0
    buffer_load_dwordx4 v[208:211], v13, s[20:23], s85 offen offset:2048 nt
    s_add_u32 s85, s91, 16384
    buffer_load_dwordx4 v[212:215], v13, s[20:23], s85 offen offset:2048 nt
    s_add_u32 s85, s91, 32768
    buffer_load_dwordx4 v[216:219], v13, s[20:23], s85 offen offset:2048 nt
    s_add_u32 s85, s91, 49152
    buffer_load_dwordx4 v[220:223], v13, s[20:23], s85 offen offset:2048 nt
    s_mov_b32 s73, s101
    v_bfe_u32 v26, v0, 2, 1
    v_lshlrev_b32 v2, 6, v26
    v_lshrrev_b32 v26, 4, v0
    v_lshl_add_u32 v2, v26, 4, v2
    v_bfe_u32 v26, v0, 4, 1
    v_lshlrev_b32 v4, 19, v26
    v_bfe_u32 v26, v0, 3, 1
    v_lshl_add_u32 v4, v26, 14, v4
    v_and_b32 v26, 7, v0
    v_lshl_add_u32 v4, v26, 4, v4
    v_lshrrev_b32 v26, 5, v0
    v_lshl_add_u32 v4, v26, 15, v4
    s_and_b32 s98, s3, 3
    s_lshl_b32 s98, s98, 16
    s_lshl_b32 s86, s90, 7
    s_add_u32 s98, s98, s86
    s_add_u32 s98, s98, 0x640000
    s_mov_b32 s100, 0
    s_mov_b32 s101, -1
    s_mov_b32 s4, 0x7060500
    s_mov_b32 s5, 0x7060501
    s_mov_b32 s6, 0x7060502
    s_mov_b32 s7, 0x7060503
    v_mfma_f32_16x16x32_bf16 v[80:83], v[96:99], v[64:67], 0
    v_mfma_f32_16x16x32_bf16 v[84:87], v[112:115], v[64:67], 0
    v_mfma_f32_16x16x32_bf16 v[80:83], v[100:103], v[68:71], v[80:83]
    v_mfma_f32_16x16x32_bf16 v[84:87], v[116:119], v[68:71], v[84:87]
    v_mfma_f32_16x16x32_bf16 v[80:83], v[104:107], v[72:75], v[80:83]
    v_mfma_f32_16x16x32_bf16 v[84:87], v[120:123], v[72:75], v[84:87]
    v_mfma_f32_16x16x32_bf16 v[80:83], v[108:111], v[76:79], v[80:83]
    v_mfma_f32_16x16x32_bf16 v[84:87], v[124:127], v[76:79], v[84:87]
    v_mov_b32 v25, s73
    s_mov_b64 exec, 1
    ds_max_u32 v10, v25 offset:28
    s_mov_b64 exec, -1
    v_mov_b32 v25, 1
    s_mov_b64 exec, 1
    ds_add_u32 v10, v25 offset:24
    s_mov_b64 exec, -1
    s_nop 3
    v_max3_f32 v24, v80, v81, v82
    v_max3_f32 v24, v24, v83, v84
    v_max3_f32 v24, v24, v85, v86
    v_max3_f32 v24, v24, v87, v92
    v_mov_b32 v25, v24
    s_nop 1
    v_permlane16_swap_b32 v24, v25
    v_max_f32 v24, v24, v25
    v_mov_b32 v25, v24
    s_nop 1
    v_permlane32_swap_b32 v24, v25
    v_max_f32 v24, v24, v25
    s_setprio 2
    v_mul_f32 v26, s78, v24
    v_fma_f32 v28, v92, s78, -v26
    v_exp_f32 v28, v28
    v_mov_b32 v92, v24
    v_fma_f32 v80, v80, s78, -v26
    v_fma_f32 v81, v81, s78, -v26
    v_fma_f32 v82, v82, s78, -v26
    v_fma_f32 v83, v83, s78, -v26
    v_fma_f32 v84, v84, s78, -v26
    v_fma_f32 v85, v85, s78, -v26
    v_fma_f32 v86, v86, s78, -v26
    v_fma_f32 v87, v87, s78, -v26
    v_exp_f32 v80, v80
    v_exp_f32 v81, v81
    v_exp_f32 v82, v82
    v_exp_f32 v83, v83
    v_exp_f32 v84, v84
    v_exp_f32 v85, v85
    v_exp_f32 v86, v86
    v_exp_f32 v87, v87
    v_pk_mul_f32 v[32:33], v[32:33], v[28:29] op_sel_hi:[1,0]
    v_pk_mul_f32 v[34:35], v[34:35], v[28:29] op_sel_hi:[1,0]
    v_pk_mul_f32 v[36:37], v[36:37], v[28:29] op_sel_hi:[1,0]
    v_pk_mul_f32 v[38:39], v[38:39], v[28:29] op_sel_hi:[1,0]
    v_pk_mul_f32 v[40:41], v[40:41], v[28:29] op_sel_hi:[1,0]
    v_pk_mul_f32 v[42:43], v[42:43], v[28:29] op_sel_hi:[1,0]
    v_pk_mul_f32 v[44:45], v[44:45], v[28:29] op_sel_hi:[1,0]
    v_pk_mul_f32 v[46:47], v[46:47], v[28:29] op_sel_hi:[1,0]
    v_pk_mul_f32 v[48:49], v[48:49], v[28:29] op_sel_hi:[1,0]
    v_pk_mul_f32 v[50:51], v[50:51], v[28:29] op_sel_hi:[1,0]
    v_pk_mul_f32 v[52:53], v[52:53], v[28:29] op_sel_hi:[1,0]
    v_pk_mul_f32 v[54:55], v[54:55], v[28:29] op_sel_hi:[1,0]
    v_pk_mul_f32 v[56:57], v[56:57], v[28:29] op_sel_hi:[1,0]
    v_pk_mul_f32 v[58:59], v[58:59], v[28:29] op_sel_hi:[1,0]
    v_pk_mul_f32 v[60:61], v[60:61], v[28:29] op_sel_hi:[1,0]
    v_pk_mul_f32 v[62:63], v[62:63], v[28:29] op_sel_hi:[1,0]
    v_add_f32 v24, v80, v81
    v_add_f32 v25, v82, v83
    v_add_f32 v24, v24, v84
    v_add_f32 v25, v25, v85
    v_add_f32 v24, v24, v86
    v_add_f32 v25, v25, v87
    v_cvt_pk_bf16_f32 v88, v80, v81
    v_cvt_pk_bf16_f32 v89, v82, v83
    v_cvt_pk_bf16_f32 v90, v84, v85
    v_cvt_pk_bf16_f32 v91, v86, v87
    v_add_f32 v24, v24, v25
    v_fma_f32 v93, v93, v28, v24
    v_mov_b32 v25, v93
    s_nop 1
    v_permlane16_swap_b32 v93, v25
    v_add_f32 v93, v93, v25
    v_mov_b32 v25, v93
    s_nop 1
    v_permlane32_swap_b32 v93, v25
    v_add_f32 v93, v93, v25
    s_mov_b64 exec, 0xff
    ds_write_b32 v6, v92 offset:256
    ds_write_b32 v6, v93 offset:768
    s_mov_b64 exec, -1
    v_mov_b32 v243, s79
    s_add_u32 s85, s91, 0
    buffer_load_dwordx4 v[96:99], v13, s[24:27], s85 offen offset:0 nt
    s_add_u32 s85, s91, 16384
    buffer_load_dwordx4 v[100:103], v13, s[24:27], s85 offen offset:0 nt
    s_add_u32 s85, s91, 32768
    buffer_load_dwordx4 v[104:107], v13, s[24:27], s85 offen offset:0 nt
    s_add_u32 s85, s91, 49152
    buffer_load_dwordx4 v[108:111], v13, s[24:27], s85 offen offset:0 nt
    v_perm_b32 v128, v164, v160, s76
    v_perm_b32 v132, v164, v160, s77
    v_perm_b32 v136, v165, v161, s76
    v_perm_b32 v140, v165, v161, s77
    v_perm_b32 v144, v166, v162, s76
    v_perm_b32 v148, v166, v162, s77
    v_perm_b32 v152, v167, v163, s76
    v_perm_b32 v156, v167, v163, s77
    v_perm_b32 v129, v172, v168, s76
    v_perm_b32 v133, v172, v168, s77
    v_perm_b32 v137, v173, v169, s76
    v_perm_b32 v141, v173, v169, s77
    v_perm_b32 v145, v174, v170, s76
    v_perm_b32 v149, v174, v170, s77
    v_perm_b32 v153, v175, v171, s76
    v_perm_b32 v157, v175, v171, s77
    v_perm_b32 v130, v180, v176, s76
    v_perm_b32 v134, v180, v176, s77
    v_perm_b32 v138, v181, v177, s76
    v_perm_b32 v142, v181, v177, s77
    v_perm_b32 v146, v182, v178, s76
    v_perm_b32 v150, v182, v178, s77
    v_perm_b32 v154, v183, v179, s76
    v_perm_b32 v158, v183, v179, s77
    v_perm_b32 v131, v188, v184, s76
    v_perm_b32 v135, v188, v184, s77
    v_perm_b32 v139, v189, v185, s76
    v_mfma_f32_16x16x32_bf16 v[32:35], v[128:131], v[88:91], v[32:35]
    v_perm_b32 v143, v189, v185, s77
    v_mfma_f32_16x16x32_bf16 v[36:39], v[132:135], v[88:91], v[36:39]
    v_perm_b32 v147, v190, v186, s76
    v_mfma_f32_16x16x32_bf16 v[40:43], v[136:139], v[88:91], v[40:43]
    v_perm_b32 v151, v190, v186, s77
    v_mfma_f32_16x16x32_bf16 v[44:47], v[140:143], v[88:91], v[44:47]
    v_perm_b32 v155, v191, v187, s76
    v_mfma_f32_16x16x32_bf16 v[48:51], v[144:147], v[88:91], v[48:51]
    v_perm_b32 v159, v191, v187, s77
    v_mfma_f32_16x16x32_bf16 v[52:55], v[148:151], v[88:91], v[52:55]
    s_nop 0
    v_mfma_f32_16x16x32_bf16 v[56:59], v[152:155], v[88:91], v[56:59]
    v_mfma_f32_16x16x32_bf16 v[60:63], v[156:159], v[88:91], v[60:63]
    s_mov_b32 exec_lo, 0x00ff00ff
    s_mov_b32 exec_hi, 0x00ff00ff
    ds_write_b128 v5, v[32:35] offset:33792
    ds_write_b128 v5, v[36:39] offset:33808
    ds_write_b128 v5, v[40:43] offset:33824
    ds_write_b128 v5, v[44:47] offset:33840
    ds_write_b128 v5, v[48:51] offset:33856
    ds_write_b128 v5, v[52:55] offset:33872
    ds_write_b128 v5, v[56:59] offset:33888
    ds_write_b128 v5, v[60:63] offset:33904
    s_mov_b64 exec, -1
    v_and_b32 v240, 1, v0
    v_cmp_eq_u32 vcc, 1, v240
    s_setprio 0
    s_waitcnt lgkmcnt(0)
    s_barrier
    ds_read_b32 v224, v9 offset:256
    ds_read_b128 v[228:231], v9 offset:272
    ds_read_b128 v[128:131], v8 offset:33792
    ds_read_b128 v[132:135], v8 offset:50688
    ds_read_b128 v[136:139], v8 offset:54912
    ds_read_b128 v[140:143], v8 offset:59136
    ds_read_b128 v[144:147], v8 offset:63360
    ds_read_b32 v232, v9 offset:768
    ds_read_b128 v[236:239], v9 offset:784
    s_waitcnt lgkmcnt(7)
    v_max3_f32 v242, v224, v228, v229
    v_max3_f32 v242, v242, v230, v231
    v_mul_f32 v26, s78, v242
    v_fma_f32 v224, v224, s78, -v26
    v_fma_f32 v228, v228, s78, -v26
    v_fma_f32 v229, v229, s78, -v26
    v_fma_f32 v230, v230, s78, -v26
    v_fma_f32 v231, v231, s78, -v26
    v_exp_f32 v224, v224
    v_exp_f32 v228, v228
    v_exp_f32 v229, v229
    v_exp_f32 v230, v230
    v_exp_f32 v231, v231
    s_waitcnt lgkmcnt(2)
    v_pk_mul_f32 v[244:245], v[128:129], v[224:225] op_sel:[0,0] op_sel_hi:[1,0]
    v_pk_mul_f32 v[246:247], v[130:131], v[224:225] op_sel:[0,0] op_sel_hi:[1,0]
    v_pk_fma_f32 v[244:245], v[132:133], v[228:229], v[244:245] op_sel:[0,0,0] op_sel_hi:[1,0,1]
    v_pk_fma_f32 v[246:247], v[134:135], v[228:229], v[246:247] op_sel:[0,0,0] op_sel_hi:[1,0,1]
    v_pk_fma_f32 v[244:245], v[136:137], v[228:229], v[244:245] op_sel:[0,1,0] op_sel_hi:[1,1,1]
    v_pk_fma_f32 v[246:247], v[138:139], v[228:229], v[246:247] op_sel:[0,1,0] op_sel_hi:[1,1,1]
    v_pk_fma_f32 v[244:245], v[140:141], v[230:231], v[244:245] op_sel:[0,0,0] op_sel_hi:[1,0,1]
    v_pk_fma_f32 v[246:247], v[142:143], v[230:231], v[246:247] op_sel:[0,0,0] op_sel_hi:[1,0,1]
    v_pk_fma_f32 v[244:245], v[144:145], v[230:231], v[244:245] op_sel:[0,1,0] op_sel_hi:[1,1,1]
    v_pk_fma_f32 v[246:247], v[146:147], v[230:231], v[246:247] op_sel:[0,1,0] op_sel_hi:[1,1,1]
    s_waitcnt lgkmcnt(0)
    v_mul_f32 v225, v224, v232
    v_fmac_f32 v225, v228, v236
    v_fmac_f32 v225, v229, v237
    v_fmac_f32 v225, v230, v238
    v_fmac_f32 v225, v231, v239
    v_cvt_pk_bf16_f32 v240, v244, v245
    v_cvt_pk_bf16_f32 v241, v246, v247
    v_cndmask_b32 v242, v242, v225, vcc
    s_mov_b32 exec_hi, 0
    buffer_store_dwordx4 v[240:243], v12, s[28:31], s92 offen sc1
    s_mov_b32 exec_hi, -1
    s_add_u32 s85, s91, 0
    buffer_load_dwordx4 v[112:115], v13, s[24:27], s85 offen offset:2048 nt
    s_add_u32 s85, s91, 16384
    buffer_load_dwordx4 v[116:119], v13, s[24:27], s85 offen offset:2048 nt
    s_add_u32 s85, s91, 32768
    buffer_load_dwordx4 v[120:123], v13, s[24:27], s85 offen offset:2048 nt
    s_add_u32 s85, s91, 49152
    buffer_load_dwordx4 v[124:127], v13, s[24:27], s85 offen offset:2048 nt
    s_setprio 2
    v_mov_b32 v84, s79
    s_waitcnt vmcnt(9)
    v_perm_b32 v128, v196, v192, s76
    v_perm_b32 v129, v204, v200, s76
    v_perm_b32 v130, v212, v208, s76
    v_perm_b32 v131, v220, v216, s76
    v_perm_b32 v132, v196, v192, s77
    v_perm_b32 v133, v204, v200, s77
    v_perm_b32 v134, v212, v208, s77
    v_perm_b32 v135, v220, v216, s77
    v_perm_b32 v136, v197, v193, s76
    v_perm_b32 v137, v205, v201, s76
    v_perm_b32 v138, v213, v209, s76
    v_perm_b32 v139, v221, v217, s76
    v_perm_b32 v140, v197, v193, s77
    v_perm_b32 v141, v205, v201, s77
    v_perm_b32 v142, v213, v209, s77
    v_perm_b32 v143, v221, v217, s77
    v_perm_b32 v144, v198, v194, s76
    v_perm_b32 v145, v206, v202, s76
    v_perm_b32 v146, v214, v210, s76
    v_perm_b32 v147, v222, v218, s76
    v_perm_b32 v148, v198, v194, s77
    v_perm_b32 v149, v206, v202, s77
    v_perm_b32 v150, v214, v210, s77
    v_perm_b32 v151, v222, v218, s77
    v_perm_b32 v152, v199, v195, s76
    v_perm_b32 v153, v207, v203, s76
    v_perm_b32 v154, v215, v211, s76
    v_perm_b32 v155, v223, v219, s76
    v_perm_b32 v156, v199, v195, s77
    v_perm_b32 v157, v207, v203, s77
    v_perm_b32 v158, v215, v211, s77
    v_perm_b32 v159, v223, v219, s77
    s_waitcnt vmcnt(0)
    v_perm_b32 v160, v100, v96, s76
    v_perm_b32 v161, v108, v104, s76
    v_perm_b32 v162, v116, v112, s76
    v_perm_b32 v163, v124, v120, s76
    v_perm_b32 v164, v100, v96, s77
    v_perm_b32 v165, v108, v104, s77
    v_perm_b32 v166, v116, v112, s77
    v_perm_b32 v167, v124, v120, s77
    v_perm_b32 v168, v101, v97, s76
    v_perm_b32 v169, v109, v105, s76
    v_perm_b32 v170, v117, v113, s76
    v_perm_b32 v171, v125, v121, s76
    v_perm_b32 v172, v101, v97, s77
    v_perm_b32 v173, v109, v105, s77
    v_perm_b32 v174, v117, v113, s77
    v_perm_b32 v175, v125, v121, s77
    v_perm_b32 v176, v102, v98, s76
    v_perm_b32 v177, v110, v106, s76
    v_perm_b32 v178, v118, v114, s76
    v_perm_b32 v179, v126, v122, s76
    v_perm_b32 v180, v102, v98, s77
    v_perm_b32 v181, v110, v106, s77
    v_perm_b32 v182, v118, v114, s77
    v_perm_b32 v183, v126, v122, s77
    v_perm_b32 v184, v103, v99, s76
    v_perm_b32 v185, v111, v107, s76
    v_perm_b32 v186, v119, v115, s76
    v_perm_b32 v187, v127, v123, s76
    v_perm_b32 v188, v103, v99, s77
    v_perm_b32 v189, v111, v107, s77
    v_perm_b32 v190, v119, v115, s77
    v_perm_b32 v191, v127, v123, s77
    s_mov_b32 s89, 0
L_ls120:
    ds_read_b32 v31, v10 offset:16
    s_waitcnt lgkmcnt(0)
    v_readfirstlane_b32 s88, v31
    s_add_u32 s89, s89, 1
    s_cmp_eq_u32 s88, 2
    s_cbranch_scc1 L_lsok121
    s_cmp_gt_u32 s89, 1000000
    s_cbranch_scc1 L_lsok121
    s_sleep 1
    s_branch L_ls120
L_lsok121:
    ds_read_b128 v[72:75], v2 offset:1024
    s_waitcnt lgkmcnt(0)
    v_mfma_f32_16x16x32_bf16 v[32:35], v[72:75], v[128:131], 0
    v_mfma_f32_16x16x32_bf16 v[36:39], v[72:75], v[132:135], 0
    v_mfma_f32_16x16x32_bf16 v[40:43], v[72:75], v[136:139], 0
    v_mfma_f32_16x16x32_bf16 v[44:47], v[72:75], v[140:143], 0
    v_mfma_f32_16x16x32_bf16 v[48:51], v[72:75], v[144:147], 0
    v_mfma_f32_16x16x32_bf16 v[52:55], v[72:75], v[148:151], 0
    v_mfma_f32_16x16x32_bf16 v[56:59], v[72:75], v[152:155], 0
    v_mfma_f32_16x16x32_bf16 v[60:63], v[72:75], v[156:159], 0
    s_barrier
    ds_read_b128 v[76:79], v2 offset:1152
    s_waitcnt lgkmcnt(0)
    v_mfma_f32_16x16x32_bf16 v[32:35], v[76:79], v[160:163], v[32:35]
    v_mfma_f32_16x16x32_bf16 v[48:51], v[76:79], v[176:179], v[48:51]
    v_mfma_f32_16x16x32_bf16 v[36:39], v[76:79], v[164:167], v[36:39]
    v_mfma_f32_16x16x32_bf16 v[52:55], v[76:79], v[180:183], v[52:55]
    v_mfma_f32_16x16x32_bf16 v[40:43], v[76:79], v[168:171], v[40:43]
    v_mfma_f32_16x16x32_bf16 v[56:59], v[76:79], v[184:187], v[56:59]
    v_mfma_f32_16x16x32_bf16 v[44:47], v[76:79], v[172:175], v[44:47]
    v_mfma_f32_16x16x32_bf16 v[60:63], v[76:79], v[188:191], v[60:63]
    s_nop 4
    v_cndmask_b32 v80, v32, v48, s[100:101]
    v_cndmask_b32 v81, v36, v52, s[100:101]
    v_cndmask_b32 v82, v40, v56, s[100:101]
    v_cndmask_b32 v83, v44, v60, s[100:101]
    v_perm_b32 v80, v80, v84, s4
    v_perm_b32 v81, v81, v84, s5
    v_perm_b32 v82, v82, v84, s6
    v_perm_b32 v83, v83, v84, s7
    buffer_store_dwordx4 v[80:83], v4, s[28:31], s98 offen sc1
    s_endpgm
L_dend116:
    s_add_u32 s101, s99, 0
    s_add_u32 s85, s91, 0
    buffer_load_dwordx4 v[128:131], v13, s[20:23], s85 offen offset:0 nt
    s_add_u32 s85, s91, 16384
    buffer_load_dwordx4 v[132:135], v13, s[20:23], s85 offen offset:0 nt
    s_add_u32 s85, s91, 32768
    buffer_load_dwordx4 v[136:139], v13, s[20:23], s85 offen offset:0 nt
    s_add_u32 s85, s91, 49152
    buffer_load_dwordx4 v[140:143], v13, s[20:23], s85 offen offset:0 nt
    s_add_u32 s85, s91, 0
    buffer_load_dwordx4 v[144:147], v13, s[20:23], s85 offen offset:2048 nt
    s_add_u32 s85, s91, 16384
    buffer_load_dwordx4 v[148:151], v13, s[20:23], s85 offen offset:2048 nt
    s_add_u32 s85, s91, 32768
    buffer_load_dwordx4 v[152:155], v13, s[20:23], s85 offen offset:2048 nt
    s_add_u32 s85, s91, 49152
    buffer_load_dwordx4 v[156:159], v13, s[20:23], s85 offen offset:2048 nt
    s_mov_b32 s73, s101
    v_bfe_u32 v26, v0, 2, 1
    v_lshlrev_b32 v2, 6, v26
    v_lshrrev_b32 v26, 4, v0
    v_lshl_add_u32 v2, v26, 4, v2
    v_bfe_u32 v26, v0, 4, 1
    v_lshlrev_b32 v4, 19, v26
    v_bfe_u32 v26, v0, 3, 1
    v_lshl_add_u32 v4, v26, 14, v4
    v_and_b32 v26, 7, v0
    v_lshl_add_u32 v4, v26, 4, v4
    v_lshrrev_b32 v26, 5, v0
    v_lshl_add_u32 v4, v26, 15, v4
    s_and_b32 s98, s3, 3
    s_lshl_b32 s98, s98, 16
    s_lshl_b32 s86, s90, 7
    s_add_u32 s98, s98, s86
    s_add_u32 s98, s98, 0x640000
    s_mov_b32 s100, 0
    s_mov_b32 s101, -1
    s_mov_b32 s4, 0x7060500
    s_mov_b32 s5, 0x7060501
    s_mov_b32 s6, 0x7060502
    s_mov_b32 s7, 0x7060503
    v_mov_b32 v84, s70
    v_mov_b32 v85, s70
    v_mov_b32 v86, s70
    v_mov_b32 v87, s70
    s_nop 0
    v_mfma_f32_16x16x32_bf16 v[80:83], v[192:195], v[64:67], 0
    v_mfma_f32_16x16x32_bf16 v[84:87], v[208:211], v[64:67], v[84:87]
    v_mfma_f32_16x16x32_bf16 v[80:83], v[196:199], v[68:71], v[80:83]
    v_mfma_f32_16x16x32_bf16 v[84:87], v[212:215], v[68:71], v[84:87]
    v_mfma_f32_16x16x32_bf16 v[80:83], v[200:203], v[72:75], v[80:83]
    v_mfma_f32_16x16x32_bf16 v[84:87], v[216:219], v[72:75], v[84:87]
    v_mfma_f32_16x16x32_bf16 v[80:83], v[204:207], v[76:79], v[80:83]
    v_mfma_f32_16x16x32_bf16 v[84:87], v[220:223], v[76:79], v[84:87]
    v_mov_b32 v25, s73
    s_mov_b64 exec, 1
    ds_max_u32 v10, v25 offset:28
    s_mov_b64 exec, -1
    v_mov_b32 v25, 1
    s_mov_b64 exec, 1
    ds_add_u32 v10, v25 offset:24
    s_mov_b64 exec, -1
    s_nop 3
    v_max3_f32 v24, v80, v81, v82
    v_max3_f32 v24, v24, v83, v84
    v_max3_f32 v24, v24, v85, v86
    v_max3_f32 v24, v24, v87, v92
    v_mov_b32 v25, v24
    s_nop 1
    v_permlane16_swap_b32 v24, v25
    v_max_f32 v24, v24, v25
    v_mov_b32 v25, v24
    s_nop 1
    v_permlane32_swap_b32 v24, v25
    v_max_f32 v24, v24, v25
    s_setprio 2
    v_mul_f32 v26, s78, v24
    v_fma_f32 v28, v92, s78, -v26
    v_exp_f32 v28, v28
    v_mov_b32 v92, v24
    v_fma_f32 v80, v80, s78, -v26
    v_fma_f32 v81, v81, s78, -v26
    v_fma_f32 v82, v82, s78, -v26
    v_fma_f32 v83, v83, s78, -v26
    v_fma_f32 v84, v84, s78, -v26
    v_fma_f32 v85, v85, s78, -v26
    v_fma_f32 v86, v86, s78, -v26
    v_fma_f32 v87, v87, s78, -v26
    v_exp_f32 v80, v80
    v_exp_f32 v81, v81
    v_exp_f32 v82, v82
    v_exp_f32 v83, v83
    v_exp_f32 v84, v84
    v_exp_f32 v85, v85
    v_exp_f32 v86, v86
    v_exp_f32 v87, v87
    v_pk_mul_f32 v[32:33], v[32:33], v[28:29] op_sel_hi:[1,0]
    v_pk_mul_f32 v[34:35], v[34:35], v[28:29] op_sel_hi:[1,0]
    v_pk_mul_f32 v[36:37], v[36:37], v[28:29] op_sel_hi:[1,0]
    v_pk_mul_f32 v[38:39], v[38:39], v[28:29] op_sel_hi:[1,0]
    v_pk_mul_f32 v[40:41], v[40:41], v[28:29] op_sel_hi:[1,0]
    v_pk_mul_f32 v[42:43], v[42:43], v[28:29] op_sel_hi:[1,0]
    v_pk_mul_f32 v[44:45], v[44:45], v[28:29] op_sel_hi:[1,0]
    v_pk_mul_f32 v[46:47], v[46:47], v[28:29] op_sel_hi:[1,0]
    v_pk_mul_f32 v[48:49], v[48:49], v[28:29] op_sel_hi:[1,0]
    v_pk_mul_f32 v[50:51], v[50:51], v[28:29] op_sel_hi:[1,0]
    v_pk_mul_f32 v[52:53], v[52:53], v[28:29] op_sel_hi:[1,0]
    v_pk_mul_f32 v[54:55], v[54:55], v[28:29] op_sel_hi:[1,0]
    v_pk_mul_f32 v[56:57], v[56:57], v[28:29] op_sel_hi:[1,0]
    v_pk_mul_f32 v[58:59], v[58:59], v[28:29] op_sel_hi:[1,0]
    v_pk_mul_f32 v[60:61], v[60:61], v[28:29] op_sel_hi:[1,0]
    v_pk_mul_f32 v[62:63], v[62:63], v[28:29] op_sel_hi:[1,0]
    v_add_f32 v24, v80, v81
    v_add_f32 v25, v82, v83
    v_add_f32 v24, v24, v84
    v_add_f32 v25, v25, v85
    v_add_f32 v24, v24, v86
    v_add_f32 v25, v25, v87
    v_cvt_pk_bf16_f32 v88, v80, v81
    v_cvt_pk_bf16_f32 v89, v82, v83
    v_cvt_pk_bf16_f32 v90, v84, v85
    v_cvt_pk_bf16_f32 v91, v86, v87
    v_add_f32 v24, v24, v25
    v_fma_f32 v93, v93, v28, v24
    v_mov_b32 v25, v93
    s_nop 1
    v_permlane16_swap_b32 v93, v25
    v_add_f32 v93, v93, v25
    v_mov_b32 v25, v93
    s_nop 1
    v_permlane32_swap_b32 v93, v25
    v_add_f32 v93, v93, v25
    s_mov_b64 exec, 0xff
    ds_write_b32 v6, v92 offset:256
    ds_write_b32 v6, v93 offset:768
    s_mov_b64 exec, -1
    v_mov_b32 v115, s79
    s_waitcnt vmcnt(10)
    s_add_u32 s85, s91, 0
    buffer_load_dwordx4 v[192:195], v13, s[24:27], s85 offen offset:0 nt
    s_add_u32 s85, s91, 16384
    buffer_load_dwordx4 v[196:199], v13, s[24:27], s85 offen offset:0 nt
    s_add_u32 s85, s91, 32768
    buffer_load_dwordx4 v[200:203], v13, s[24:27], s85 offen offset:0 nt
    s_add_u32 s85, s91, 49152
    buffer_load_dwordx4 v[204:207], v13, s[24:27], s85 offen offset:0 nt
    v_perm_b32 v160, v228, v224, s76
    v_perm_b32 v164, v228, v224, s77
    v_perm_b32 v168, v229, v225, s76
    v_perm_b32 v172, v229, v225, s77
    v_perm_b32 v176, v230, v226, s76
    v_perm_b32 v180, v230, v226, s77
    v_perm_b32 v184, v231, v227, s76
    v_perm_b32 v188, v231, v227, s77
    v_perm_b32 v161, v236, v232, s76
    v_perm_b32 v165, v236, v232, s77
    v_perm_b32 v169, v237, v233, s76
    v_perm_b32 v173, v237, v233, s77
    v_perm_b32 v177, v238, v234, s76
    v_perm_b32 v181, v238, v234, s77
    v_perm_b32 v185, v239, v235, s76
    v_perm_b32 v189, v239, v235, s77
    v_perm_b32 v162, v244, v240, s76
    v_perm_b32 v166, v244, v240, s77
    v_perm_b32 v170, v245, v241, s76
    v_perm_b32 v174, v245, v241, s77
    v_perm_b32 v178, v246, v242, s76
    v_perm_b32 v182, v246, v242, s77
    v_perm_b32 v186, v247, v243, s76
    v_perm_b32 v190, v247, v243, s77
    s_waitcnt vmcnt(12)
    v_perm_b32 v163, v252, v248, s76
    v_perm_b32 v167, v252, v248, s77
    v_perm_b32 v171, v253, v249, s76
    v_mfma_f32_16x16x32_bf16 v[32:35], v[160:163], v[88:91], v[32:35]
    v_perm_b32 v175, v253, v249, s77
    v_mfma_f32_16x16x32_bf16 v[36:39], v[164:167], v[88:91], v[36:39]
    v_perm_b32 v179, v254, v250, s76
    v_mfma_f32_16x16x32_bf16 v[40:43], v[168:171], v[88:91], v[40:43]
    v_perm_b32 v183, v254, v250, s77
    v_mfma_f32_16x16x32_bf16 v[44:47], v[172:175], v[88:91], v[44:47]
    v_perm_b32 v187, v255, v251, s76
    v_mfma_f32_16x16x32_bf16 v[48:51], v[176:179], v[88:91], v[48:51]
    v_perm_b32 v191, v255, v251, s77
    v_mfma_f32_16x16x32_bf16 v[52:55], v[180:183], v[88:91], v[52:55]
    s_nop 0
    v_mfma_f32_16x16x32_bf16 v[56:59], v[184:187], v[88:91], v[56:59]
    v_mfma_f32_16x16x32_bf16 v[60:63], v[188:191], v[88:91], v[60:63]
    s_mov_b32 exec_lo, 0x00ff00ff
    s_mov_b32 exec_hi, 0x00ff00ff
    ds_write_b128 v5, v[32:35] offset:33792
    ds_write_b128 v5, v[36:39] offset:33808
    ds_write_b128 v5, v[40:43] offset:33824
    ds_write_b128 v5, v[44:47] offset:33840
    ds_write_b128 v5, v[48:51] offset:33856
    ds_write_b128 v5, v[52:55] offset:33872
    ds_write_b128 v5, v[56:59] offset:33888
    ds_write_b128 v5, v[60:63] offset:33904
    s_mov_b64 exec, -1
    v_and_b32 v112, 1, v0
    v_cmp_eq_u32 vcc, 1, v112
    s_setprio 0
    s_waitcnt lgkmcnt(0)
    s_barrier
    ds_read_b32 v96, v9 offset:256
    ds_read_b128 v[100:103], v9 offset:272
    ds_read_b128 v[160:163], v8 offset:33792
    ds_read_b128 v[164:167], v8 offset:50688
    ds_read_b128 v[168:171], v8 offset:54912
    ds_read_b128 v[172:175], v8 offset:59136
    ds_read_b128 v[176:179], v8 offset:63360
    ds_read_b32 v104, v9 offset:768
    ds_read_b128 v[108:111], v9 offset:784
    s_waitcnt lgkmcnt(7)
    v_max3_f32 v114, v96, v100, v101
    v_max3_f32 v114, v114, v102, v103
    v_mul_f32 v26, s78, v114
    v_fma_f32 v96, v96, s78, -v26
    v_fma_f32 v100, v100, s78, -v26
    v_fma_f32 v101, v101, s78, -v26
    v_fma_f32 v102, v102, s78, -v26
    v_fma_f32 v103, v103, s78, -v26
    v_exp_f32 v96, v96
    v_exp_f32 v100, v100
    v_exp_f32 v101, v101
    v_exp_f32 v102, v102
    v_exp_f32 v103, v103
    s_waitcnt lgkmcnt(2)
    v_pk_mul_f32 v[116:117], v[160:161], v[96:97] op_sel:[0,0] op_sel_hi:[1,0]
    v_pk_mul_f32 v[118:119], v[162:163], v[96:97] op_sel:[0,0] op_sel_hi:[1,0]
    v_pk_fma_f32 v[116:117], v[164:165], v[100:101], v[116:117] op_sel:[0,0,0] op_sel_hi:[1,0,1]
    v_pk_fma_f32 v[118:119], v[166:167], v[100:101], v[118:119] op_sel:[0,0,0] op_sel_hi:[1,0,1]
    v_pk_fma_f32 v[116:117], v[168:169], v[100:101], v[116:117] op_sel:[0,1,0] op_sel_hi:[1,1,1]
    v_pk_fma_f32 v[118:119], v[170:171], v[100:101], v[118:119] op_sel:[0,1,0] op_sel_hi:[1,1,1]
    v_pk_fma_f32 v[116:117], v[172:173], v[102:103], v[116:117] op_sel:[0,0,0] op_sel_hi:[1,0,1]
    v_pk_fma_f32 v[118:119], v[174:175], v[102:103], v[118:119] op_sel:[0,0,0] op_sel_hi:[1,0,1]
    v_pk_fma_f32 v[116:117], v[176:177], v[102:103], v[116:117] op_sel:[0,1,0] op_sel_hi:[1,1,1]
    v_pk_fma_f32 v[118:119], v[178:179], v[102:103], v[118:119] op_sel:[0,1,0] op_sel_hi:[1,1,1]
    s_waitcnt lgkmcnt(0)
    v_mul_f32 v97, v96, v104
    v_fmac_f32 v97, v100, v108
    v_fmac_f32 v97, v101, v109
    v_fmac_f32 v97, v102, v110
    v_fmac_f32 v97, v103, v111
    v_cvt_pk_bf16_f32 v112, v116, v117
    v_cvt_pk_bf16_f32 v113, v118, v119
    v_cndmask_b32 v114, v114, v97, vcc
    s_mov_b32 exec_hi, 0
    buffer_store_dwordx4 v[112:115], v12, s[28:31], s92 offen sc1
    s_mov_b32 exec_hi, -1
    s_add_u32 s85, s91, 0
    buffer_load_dwordx4 v[208:211], v13, s[24:27], s85 offen offset:2048 nt
    s_add_u32 s85, s91, 16384
    buffer_load_dwordx4 v[212:215], v13, s[24:27], s85 offen offset:2048 nt
    s_add_u32 s85, s91, 32768
    buffer_load_dwordx4 v[216:219], v13, s[24:27], s85 offen offset:2048 nt
    s_add_u32 s85, s91, 49152
    buffer_load_dwordx4 v[220:223], v13, s[24:27], s85 offen offset:2048 nt
    s_setprio 2
    v_mov_b32 v84, s79
    s_waitcnt vmcnt(9)
    v_perm_b32 v160, v132, v128, s76
    v_perm_b32 v161, v140, v136, s76
    v_perm_b32 v162, v148, v144, s76
    v_perm_b32 v163, v156, v152, s76
    v_perm_b32 v164, v132, v128, s77
    v_perm_b32 v165, v140, v136, s77
    v_perm_b32 v166, v148, v144, s77
    v_perm_b32 v167, v156, v152, s77
    v_perm_b32 v168, v133, v129, s76
    v_perm_b32 v169, v141, v137, s76
    v_perm_b32 v170, v149, v145, s76
    v_perm_b32 v171, v157, v153, s76
    v_perm_b32 v172, v133, v129, s77
    v_perm_b32 v173, v141, v137, s77
    v_perm_b32 v174, v149, v145, s77
    v_perm_b32 v175, v157, v153, s77
    v_perm_b32 v176, v134, v130, s76
    v_perm_b32 v177, v142, v138, s76
    v_perm_b32 v178, v150, v146, s76
    v_perm_b32 v179, v158, v154, s76
    v_perm_b32 v180, v134, v130, s77
    v_perm_b32 v181, v142, v138, s77
    v_perm_b32 v182, v150, v146, s77
    v_perm_b32 v183, v158, v154, s77
    v_perm_b32 v184, v135, v131, s76
    v_perm_b32 v185, v143, v139, s76
    v_perm_b32 v186, v151, v147, s76
    v_perm_b32 v187, v159, v155, s76
    v_perm_b32 v188, v135, v131, s77
    v_perm_b32 v189, v143, v139, s77
    v_perm_b32 v190, v151, v147, s77
    v_perm_b32 v191, v159, v155, s77
    s_waitcnt vmcnt(0)
    v_perm_b32 v224, v196, v192, s76
    v_perm_b32 v225, v204, v200, s76
    v_perm_b32 v226, v212, v208, s76
    v_perm_b32 v227, v220, v216, s76
    v_perm_b32 v228, v196, v192, s77
    v_perm_b32 v229, v204, v200, s77
    v_perm_b32 v230, v212, v208, s77
    v_perm_b32 v231, v220, v216, s77
    v_perm_b32 v232, v197, v193, s76
    v_perm_b32 v233, v205, v201, s76
    v_perm_b32 v234, v213, v209, s76
    v_perm_b32 v235, v221, v217, s76
    v_perm_b32 v236, v197, v193, s77
    v_perm_b32 v237, v205, v201, s77
    v_perm_b32 v238, v213, v209, s77
    v_perm_b32 v239, v221, v217, s77
    v_perm_b32 v240, v198, v194, s76
    v_perm_b32 v241, v206, v202, s76
    v_perm_b32 v242, v214, v210, s76
    v_perm_b32 v243, v222, v218, s76
    v_perm_b32 v244, v198, v194, s77
    v_perm_b32 v245, v206, v202, s77
    v_perm_b32 v246, v214, v210, s77
    v_perm_b32 v247, v222, v218, s77
    v_perm_b32 v248, v199, v195, s76
    v_perm_b32 v249, v207, v203, s76
    v_perm_b32 v250, v215, v211, s76
    v_perm_b32 v251, v223, v219, s76
    v_perm_b32 v252, v199, v195, s77
    v_perm_b32 v253, v207, v203, s77
    v_perm_b32 v254, v215, v211, s77
    v_perm_b32 v255, v223, v219, s77
    s_mov_b32 s89, 0
L_ls122:
    ds_read_b32 v31, v10 offset:16
    s_waitcnt lgkmcnt(0)
    v_readfirstlane_b32 s88, v31
    s_add_u32 s89, s89, 1
    s_cmp_eq_u32 s88, 2
    s_cbranch_scc1 L_lsok123
    s_cmp_gt_u32 s89, 1000000
    s_cbranch_scc1 L_lsok123
    s_sleep 1
    s_branch L_ls122
L_lsok123:
    ds_read_b128 v[72:75], v2 offset:1024
    s_waitcnt lgkmcnt(0)
    v_mfma_f32_16x16x32_bf16 v[32:35], v[72:75], v[160:163], 0
    v_mfma_f32_16x16x32_bf16 v[36:39], v[72:75], v[164:167], 0
    v_mfma_f32_16x16x32_bf16 v[40:43], v[72:75], v[168:171], 0
    v_mfma_f32_16x16x32_bf16 v[44:47], v[72:75], v[172:175], 0
    v_mfma_f32_16x16x32_bf16 v[48:51], v[72:75], v[176:179], 0
    v_mfma_f32_16x16x32_bf16 v[52:55], v[72:75], v[180:183], 0
    v_mfma_f32_16x16x32_bf16 v[56:59], v[72:75], v[184:187], 0
    v_mfma_f32_16x16x32_bf16 v[60:63], v[72:75], v[188:191], 0
    s_barrier
    ds_read_b128 v[76:79], v2 offset:1152
    s_waitcnt lgkmcnt(0)
    v_mfma_f32_16x16x32_bf16 v[32:35], v[76:79], v[224:227], v[32:35]
    v_mfma_f32_16x16x32_bf16 v[48:51], v[76:79], v[240:243], v[48:51]
    v_mfma_f32_16x16x32_bf16 v[36:39], v[76:79], v[228:231], v[36:39]
    v_mfma_f32_16x16x32_bf16 v[52:55], v[76:79], v[244:247], v[52:55]
    v_mfma_f32_16x16x32_bf16 v[40:43], v[76:79], v[232:235], v[40:43]
    v_mfma_f32_16x16x32_bf16 v[56:59], v[76:79], v[248:251], v[56:59]
    v_mfma_f32_16x16x32_bf16 v[44:47], v[76:79], v[236:239], v[44:47]
    v_mfma_f32_16x16x32_bf16 v[60:63], v[76:79], v[252:255], v[60:63]
    s_nop 4
    v_cndmask_b32 v80, v32, v48, s[100:101]
    v_cndmask_b32 v81, v36, v52, s[100:101]
    v_cndmask_b32 v82, v40, v56, s[100:101]
    v_cndmask_b32 v83, v44, v60, s[100:101]
    v_perm_b32 v80, v80, v84, s4
    v_perm_b32 v81, v81, v84, s5
    v_perm_b32 v82, v82, v84, s6
    v_perm_b32 v83, v83, v84, s7
    buffer_store_dwordx4 v[80:83], v4, s[28:31], s98 offen sc1
    s_endpgm
L_dend117:
    s_add_u32 s101, s99, 0
    s_add_u32 s85, s91, 0
    buffer_load_dwordx4 v[160:163], v13, s[20:23], s85 offen offset:0 nt
    s_add_u32 s85, s91, 16384
    buffer_load_dwordx4 v[164:167], v13, s[20:23], s85 offen offset:0 nt
    s_add_u32 s85, s91, 32768
    buffer_load_dwordx4 v[168:171], v13, s[20:23], s85 offen offset:0 nt
    s_add_u32 s85, s91, 49152
    buffer_load_dwordx4 v[172:175], v13, s[20:23], s85 offen offset:0 nt
    s_add_u32 s85, s91, 0
    buffer_load_dwordx4 v[176:179], v13, s[20:23], s85 offen offset:2048 nt
    s_add_u32 s85, s91, 16384
    buffer_load_dwordx4 v[180:183], v13, s[20:23], s85 offen offset:2048 nt
    s_add_u32 s85, s91, 32768
    buffer_load_dwordx4 v[184:187], v13, s[20:23], s85 offen offset:2048 nt
    s_add_u32 s85, s91, 49152
    buffer_load_dwordx4 v[188:191], v13, s[20:23], s85 offen offset:2048 nt
    s_mov_b32 s73, s101
    v_bfe_u32 v26, v0, 2, 1
    v_lshlrev_b32 v2, 6, v26
    v_lshrrev_b32 v26, 4, v0
    v_lshl_add_u32 v2, v26, 4, v2
    v_bfe_u32 v26, v0, 4, 1
    v_lshlrev_b32 v4, 19, v26
    v_bfe_u32 v26, v0, 3, 1
    v_lshl_add_u32 v4, v26, 14, v4
    v_and_b32 v26, 7, v0
    v_lshl_add_u32 v4, v26, 4, v4
    v_lshrrev_b32 v26, 5, v0
    v_lshl_add_u32 v4, v26, 15, v4
    s_and_b32 s98, s3, 3
    s_lshl_b32 s98, s98, 16
    s_lshl_b32 s86, s90, 7
    s_add_u32 s98, s98, s86
    s_add_u32 s98, s98, 0x640000
    s_mov_b32 s100, 0
    s_mov_b32 s101, -1
    s_mov_b32 s4, 0x7060500
    s_mov_b32 s5, 0x7060501
    s_mov_b32 s6, 0x7060502
    s_mov_b32 s7, 0x7060503
    v_mov_b32 v84, s71
    v_mov_b32 v85, s71
    v_mov_b32 v86, s71
    v_mov_b32 v87, s71
    s_nop 0
    v_mfma_f32_16x16x32_bf16 v[80:83], v[128:131], v[64:67], 0
    v_mfma_f32_16x16x32_bf16 v[84:87], v[144:147], v[64:67], v[84:87]
    v_mfma_f32_16x16x32_bf16 v[80:83], v[132:135], v[68:71], v[80:83]
    v_mfma_f32_16x16x32_bf16 v[84:87], v[148:151], v[68:71], v[84:87]
    v_mfma_f32_16x16x32_bf16 v[80:83], v[136:139], v[72:75], v[80:83]
    v_mfma_f32_16x16x32_bf16 v[84:87], v[152:155], v[72:75], v[84:87]
    v_mfma_f32_16x16x32_bf16 v[80:83], v[140:143], v[76:79], v[80:83]
    v_mfma_f32_16x16x32_bf16 v[84:87], v[156:159], v[76:79], v[84:87]
    v_mov_b32 v25, s73
    s_mov_b64 exec, 1
    ds_max_u32 v10, v25 offset:28
    s_mov_b64 exec, -1
    v_mov_b32 v25, 1
    s_mov_b64 exec, 1
    ds_add_u32 v10, v25 offset:24
    s_mov_b64 exec, -1
    s_nop 3
    v_max3_f32 v24, v80, v81, v82
    v_max3_f32 v24, v24, v83, v84
    v_max3_f32 v24, v24, v85, v86
    v_max3_f32 v24, v24, v87, v92
    v_mov_b32 v25, v24
    s_nop 1
    v_permlane16_swap_b32 v24, v25
    v_max_f32 v24, v24, v25
    v_mov_b32 v25, v24
    s_nop 1
    v_permlane32_swap_b32 v24, v25
    v_max_f32 v24, v24, v25
    s_setprio 2
    v_mul_f32 v26, s78, v24
    v_fma_f32 v28, v92, s78, -v26
    v_exp_f32 v28, v28
    v_mov_b32 v92, v24
    v_fma_f32 v80, v80, s78, -v26
    v_fma_f32 v81, v81, s78, -v26
    v_fma_f32 v82, v82, s78, -v26
    v_fma_f32 v83, v83, s78, -v26
    v_fma_f32 v84, v84, s78, -v26
    v_fma_f32 v85, v85, s78, -v26
    v_fma_f32 v86, v86, s78, -v26
    v_fma_f32 v87, v87, s78, -v26
    v_exp_f32 v80, v80
    v_exp_f32 v81, v81
    v_exp_f32 v82, v82
    v_exp_f32 v83, v83
    v_exp_f32 v84, v84
    v_exp_f32 v85, v85
    v_exp_f32 v86, v86
    v_exp_f32 v87, v87
    v_pk_mul_f32 v[32:33], v[32:33], v[28:29] op_sel_hi:[1,0]
    v_pk_mul_f32 v[34:35], v[34:35], v[28:29] op_sel_hi:[1,0]
    v_pk_mul_f32 v[36:37], v[36:37], v[28:29] op_sel_hi:[1,0]
    v_pk_mul_f32 v[38:39], v[38:39], v[28:29] op_sel_hi:[1,0]
    v_pk_mul_f32 v[40:41], v[40:41], v[28:29] op_sel_hi:[1,0]
    v_pk_mul_f32 v[42:43], v[42:43], v[28:29] op_sel_hi:[1,0]
    v_pk_mul_f32 v[44:45], v[44:45], v[28:29] op_sel_hi:[1,0]
    v_pk_mul_f32 v[46:47], v[46:47], v[28:29] op_sel_hi:[1,0]
    v_pk_mul_f32 v[48:49], v[48:49], v[28:29] op_sel_hi:[1,0]
    v_pk_mul_f32 v[50:51], v[50:51], v[28:29] op_sel_hi:[1,0]
    v_pk_mul_f32 v[52:53], v[52:53], v[28:29] op_sel_hi:[1,0]
    v_pk_mul_f32 v[54:55], v[54:55], v[28:29] op_sel_hi:[1,0]
    v_pk_mul_f32 v[56:57], v[56:57], v[28:29] op_sel_hi:[1,0]
    v_pk_mul_f32 v[58:59], v[58:59], v[28:29] op_sel_hi:[1,0]
    v_pk_mul_f32 v[60:61], v[60:61], v[28:29] op_sel_hi:[1,0]
    v_pk_mul_f32 v[62:63], v[62:63], v[28:29] op_sel_hi:[1,0]
    v_add_f32 v24, v80, v81
    v_add_f32 v25, v82, v83
    v_add_f32 v24, v24, v84
    v_add_f32 v25, v25, v85
    v_add_f32 v24, v24, v86
    v_add_f32 v25, v25, v87
    v_cvt_pk_bf16_f32 v88, v80, v81
    v_cvt_pk_bf16_f32 v89, v82, v83
    v_cvt_pk_bf16_f32 v90, v84, v85
    v_cvt_pk_bf16_f32 v91, v86, v87
    v_add_f32 v24, v24, v25
    v_fma_f32 v93, v93, v28, v24
    v_mov_b32 v25, v93
    s_nop 1
    v_permlane16_swap_b32 v93, v25
    v_add_f32 v93, v93, v25
    v_mov_b32 v25, v93
    s_nop 1
    v_permlane32_swap_b32 v93, v25
    v_add_f32 v93, v93, v25
    s_mov_b64 exec, 0xff
    ds_write_b32 v6, v92 offset:256
    ds_write_b32 v6, v93 offset:768
    s_mov_b64 exec, -1
    v_mov_b32 v211, s79
    s_waitcnt vmcnt(10)
    s_add_u32 s85, s91, 0
    buffer_load_dwordx4 v[128:131], v13, s[24:27], s85 offen offset:0 nt
    s_add_u32 s85, s91, 16384
    buffer_load_dwordx4 v[132:135], v13, s[24:27], s85 offen offset:0 nt
    s_add_u32 s85, s91, 32768
    buffer_load_dwordx4 v[136:139], v13, s[24:27], s85 offen offset:0 nt
    s_add_u32 s85, s91, 49152
    buffer_load_dwordx4 v[140:143], v13, s[24:27], s85 offen offset:0 nt
    v_perm_b32 v224, v100, v96, s76
    v_perm_b32 v228, v100, v96, s77
    v_perm_b32 v232, v101, v97, s76
    v_perm_b32 v236, v101, v97, s77
    v_perm_b32 v240, v102, v98, s76
    v_perm_b32 v244, v102, v98, s77
    v_perm_b32 v248, v103, v99, s76
    v_perm_b32 v252, v103, v99, s77
    v_perm_b32 v225, v108, v104, s76
    v_perm_b32 v229, v108, v104, s77
    v_perm_b32 v233, v109, v105, s76
    v_perm_b32 v237, v109, v105, s77
    v_perm_b32 v241, v110, v106, s76
    v_perm_b32 v245, v110, v106, s77
    v_perm_b32 v249, v111, v107, s76
    v_perm_b32 v253, v111, v107, s77
    v_perm_b32 v226, v116, v112, s76
    v_perm_b32 v230, v116, v112, s77
    v_perm_b32 v234, v117, v113, s76
    v_perm_b32 v238, v117, v113, s77
    v_perm_b32 v242, v118, v114, s76
    v_perm_b32 v246, v118, v114, s77
    v_perm_b32 v250, v119, v115, s76
    v_perm_b32 v254, v119, v115, s77
    s_waitcnt vmcnt(12)
    v_perm_b32 v227, v124, v120, s76
    v_perm_b32 v231, v124, v120, s77
    v_perm_b32 v235, v125, v121, s76
    v_mfma_f32_16x16x32_bf16 v[32:35], v[224:227], v[88:91], v[32:35]
    v_perm_b32 v239, v125, v121, s77
    v_mfma_f32_16x16x32_bf16 v[36:39], v[228:231], v[88:91], v[36:39]
    v_perm_b32 v243, v126, v122, s76
    v_mfma_f32_16x16x32_bf16 v[40:43], v[232:235], v[88:91], v[40:43]
    v_perm_b32 v247, v126, v122, s77
    v_mfma_f32_16x16x32_bf16 v[44:47], v[236:239], v[88:91], v[44:47]
    v_perm_b32 v251, v127, v123, s76
    v_mfma_f32_16x16x32_bf16 v[48:51], v[240:243], v[88:91], v[48:51]
    v_perm_b32 v255, v127, v123, s77
    v_mfma_f32_16x16x32_bf16 v[52:55], v[244:247], v[88:91], v[52:55]
    s_nop 0
    v_mfma_f32_16x16x32_bf16 v[56:59], v[248:251], v[88:91], v[56:59]
    v_mfma_f32_16x16x32_bf16 v[60:63], v[252:255], v[88:91], v[60:63]
    s_mov_b32 exec_lo, 0x00ff00ff
    s_mov_b32 exec_hi, 0x00ff00ff
    ds_write_b128 v5, v[32:35] offset:33792
    ds_write_b128 v5, v[36:39] offset:33808
    ds_write_b128 v5, v[40:43] offset:33824
    ds_write_b128 v5, v[44:47] offset:33840
    ds_write_b128 v5, v[48:51] offset:33856
    ds_write_b128 v5, v[52:55] offset:33872
    ds_write_b128 v5, v[56:59] offset:33888
    ds_write_b128 v5, v[60:63] offset:33904
    s_mov_b64 exec, -1
    v_and_b32 v208, 1, v0
    v_cmp_eq_u32 vcc, 1, v208
    s_setprio 0
    s_waitcnt lgkmcnt(0)
    s_barrier
    ds_read_b32 v192, v9 offset:256
    ds_read_b128 v[196:199], v9 offset:272
    ds_read_b128 v[224:227], v8 offset:33792
    ds_read_b128 v[228:231], v8 offset:50688
    ds_read_b128 v[232:235], v8 offset:54912
    ds_read_b128 v[236:239], v8 offset:59136
    ds_read_b128 v[240:243], v8 offset:63360
    ds_read_b32 v200, v9 offset:768
    ds_read_b128 v[204:207], v9 offset:784
    s_waitcnt lgkmcnt(7)
    v_max3_f32 v210, v192, v196, v197
    v_max3_f32 v210, v210, v198, v199
    v_mul_f32 v26, s78, v210
    v_fma_f32 v192, v192, s78, -v26
    v_fma_f32 v196, v196, s78, -v26
    v_fma_f32 v197, v197, s78, -v26
    v_fma_f32 v198, v198, s78, -v26
    v_fma_f32 v199, v199, s78, -v26
    v_exp_f32 v192, v192
    v_exp_f32 v196, v196
    v_exp_f32 v197, v197
    v_exp_f32 v198, v198
    v_exp_f32 v199, v199
    s_waitcnt lgkmcnt(2)
    v_pk_mul_f32 v[212:213], v[224:225], v[192:193] op_sel:[0,0] op_sel_hi:[1,0]
    v_pk_mul_f32 v[214:215], v[226:227], v[192:193] op_sel:[0,0] op_sel_hi:[1,0]
    v_pk_fma_f32 v[212:213], v[228:229], v[196:197], v[212:213] op_sel:[0,0,0] op_sel_hi:[1,0,1]
    v_pk_fma_f32 v[214:215], v[230:231], v[196:197], v[214:215] op_sel:[0,0,0] op_sel_hi:[1,0,1]
    v_pk_fma_f32 v[212:213], v[232:233], v[196:197], v[212:213] op_sel:[0,1,0] op_sel_hi:[1,1,1]
    v_pk_fma_f32 v[214:215], v[234:235], v[196:197], v[214:215] op_sel:[0,1,0] op_sel_hi:[1,1,1]
    v_pk_fma_f32 v[212:213], v[236:237], v[198:199], v[212:213] op_sel:[0,0,0] op_sel_hi:[1,0,1]
    v_pk_fma_f32 v[214:215], v[238:239], v[198:199], v[214:215] op_sel:[0,0,0] op_sel_hi:[1,0,1]
    v_pk_fma_f32 v[212:213], v[240:241], v[198:199], v[212:213] op_sel:[0,1,0] op_sel_hi:[1,1,1]
    v_pk_fma_f32 v[214:215], v[242:243], v[198:199], v[214:215] op_sel:[0,1,0] op_sel_hi:[1,1,1]
    s_waitcnt lgkmcnt(0)
    v_mul_f32 v193, v192, v200
    v_fmac_f32 v193, v196, v204
    v_fmac_f32 v193, v197, v205
    v_fmac_f32 v193, v198, v206
    v_fmac_f32 v193, v199, v207
    v_cvt_pk_bf16_f32 v208, v212, v213
    v_cvt_pk_bf16_f32 v209, v214, v215
    v_cndmask_b32 v210, v210, v193, vcc
    s_mov_b32 exec_hi, 0
    buffer_store_dwordx4 v[208:211], v12, s[28:31], s92 offen sc1
    s_mov_b32 exec_hi, -1
    s_add_u32 s85, s91, 0
    buffer_load_dwordx4 v[144:147], v13, s[24:27], s85 offen offset:2048 nt
    s_add_u32 s85, s91, 16384
    buffer_load_dwordx4 v[148:151], v13, s[24:27], s85 offen offset:2048 nt
    s_add_u32 s85, s91, 32768
    buffer_load_dwordx4 v[152:155], v13, s[24:27], s85 offen offset:2048 nt
    s_add_u32 s85, s91, 49152
    buffer_load_dwordx4 v[156:159], v13, s[24:27], s85 offen offset:2048 nt
    s_setprio 2
    v_mov_b32 v84, s79
    s_waitcnt vmcnt(9)
    v_perm_b32 v224, v164, v160, s76
    v_perm_b32 v225, v172, v168, s76
    v_perm_b32 v226, v180, v176, s76
    v_perm_b32 v227, v188, v184, s76
    v_perm_b32 v228, v164, v160, s77
    v_perm_b32 v229, v172, v168, s77
    v_perm_b32 v230, v180, v176, s77
    v_perm_b32 v231, v188, v184, s77
    v_perm_b32 v232, v165, v161, s76
    v_perm_b32 v233, v173, v169, s76
    v_perm_b32 v234, v181, v177, s76
    v_perm_b32 v235, v189, v185, s76
    v_perm_b32 v236, v165, v161, s77
    v_perm_b32 v237, v173, v169, s77
    v_perm_b32 v238, v181, v177, s77
    v_perm_b32 v239, v189, v185, s77
    v_perm_b32 v240, v166, v162, s76
    v_perm_b32 v241, v174, v170, s76
    v_perm_b32 v242, v182, v178, s76
    v_perm_b32 v243, v190, v186, s76
    v_perm_b32 v244, v166, v162, s77
    v_perm_b32 v245, v174, v170, s77
    v_perm_b32 v246, v182, v178, s77
    v_perm_b32 v247, v190, v186, s77
    v_perm_b32 v248, v167, v163, s76
    v_perm_b32 v249, v175, v171, s76
    v_perm_b32 v250, v183, v179, s76
    v_perm_b32 v251, v191, v187, s76
    v_perm_b32 v252, v167, v163, s77
    v_perm_b32 v253, v175, v171, s77
    v_perm_b32 v254, v183, v179, s77
    v_perm_b32 v255, v191, v187, s77
    s_waitcnt vmcnt(0)
    v_perm_b32 v96, v132, v128, s76
    v_perm_b32 v97, v140, v136, s76
    v_perm_b32 v98, v148, v144, s76
    v_perm_b32 v99, v156, v152, s76
    v_perm_b32 v100, v132, v128, s77
    v_perm_b32 v101, v140, v136, s77
    v_perm_b32 v102, v148, v144, s77
    v_perm_b32 v103, v156, v152, s77
    v_perm_b32 v104, v133, v129, s76
    v_perm_b32 v105, v141, v137, s76
    v_perm_b32 v106, v149, v145, s76
    v_perm_b32 v107, v157, v153, s76
    v_perm_b32 v108, v133, v129, s77
    v_perm_b32 v109, v141, v137, s77
    v_perm_b32 v110, v149, v145, s77
    v_perm_b32 v111, v157, v153, s77
    v_perm_b32 v112, v134, v130, s76
    v_perm_b32 v113, v142, v138, s76
    v_perm_b32 v114, v150, v146, s76
    v_perm_b32 v115, v158, v154, s76
    v_perm_b32 v116, v134, v130, s77
    v_perm_b32 v117, v142, v138, s77
    v_perm_b32 v118, v150, v146, s77
    v_perm_b32 v119, v158, v154, s77
    v_perm_b32 v120, v135, v131, s76
    v_perm_b32 v121, v143, v139, s76
    v_perm_b32 v122, v151, v147, s76
    v_perm_b32 v123, v159, v155, s76
    v_perm_b32 v124, v135, v131, s77
    v_perm_b32 v125, v143, v139, s77
    v_perm_b32 v126, v151, v147, s77
    v_perm_b32 v127, v159, v155, s77
    s_mov_b32 s89, 0
L_ls124:
    ds_read_b32 v31, v10 offset:16
    s_waitcnt lgkmcnt(0)
    v_readfirstlane_b32 s88, v31
    s_add_u32 s89, s89, 1
    s_cmp_eq_u32 s88, 2
    s_cbranch_scc1 L_lsok125
    s_cmp_gt_u32 s89, 1000000
    s_cbranch_scc1 L_lsok125
    s_sleep 1
    s_branch L_ls124
L_lsok125:
    ds_read_b128 v[72:75], v2 offset:1024
    s_waitcnt lgkmcnt(0)
    v_mfma_f32_16x16x32_bf16 v[32:35], v[72:75], v[224:227], 0
    v_mfma_f32_16x16x32_bf16 v[36:39], v[72:75], v[228:231], 0
    v_mfma_f32_16x16x32_bf16 v[40:43], v[72:75], v[232:235], 0
    v_mfma_f32_16x16x32_bf16 v[44:47], v[72:75], v[236:239], 0
    v_mfma_f32_16x16x32_bf16 v[48:51], v[72:75], v[240:243], 0
    v_mfma_f32_16x16x32_bf16 v[52:55], v[72:75], v[244:247], 0
    v_mfma_f32_16x16x32_bf16 v[56:59], v[72:75], v[248:251], 0
    v_mfma_f32_16x16x32_bf16 v[60:63], v[72:75], v[252:255], 0
    s_barrier
    ds_read_b128 v[76:79], v2 offset:1152
    s_waitcnt lgkmcnt(0)
    v_mfma_f32_16x16x32_bf16 v[32:35], v[76:79], v[96:99], v[32:35]
    v_mfma_f32_16x16x32_bf16 v[48:51], v[76:79], v[112:115], v[48:51]
    v_mfma_f32_16x16x32_bf16 v[36:39], v[76:79], v[100:103], v[36:39]
    v_mfma_f32_16x16x32_bf16 v[52:55], v[76:79], v[116:119], v[52:55]
    v_mfma_f32_16x16x32_bf16 v[40:43], v[76:79], v[104:107], v[40:43]
    v_mfma_f32_16x16x32_bf16 v[56:59], v[76:79], v[120:123], v[56:59]
    v_mfma_f32_16x16x32_bf16 v[44:47], v[76:79], v[108:111], v[44:47]
    v_mfma_f32_16x16x32_bf16 v[60:63], v[76:79], v[124:127], v[60:63]
    s_nop 4
    v_cndmask_b32 v80, v32, v48, s[100:101]
    v_cndmask_b32 v81, v36, v52, s[100:101]
    v_cndmask_b32 v82, v40, v56, s[100:101]
    v_cndmask_b32 v83, v44, v60, s[100:101]
    v_perm_b32 v80, v80, v84, s4
    v_perm_b32 v81, v81, v84, s5
    v_perm_b32 v82, v82, v84, s6
    v_perm_b32 v83, v83, v84, s7
    buffer_store_dwordx4 v[80:83], v4, s[28:31], s98 offen sc1
    s_endpgm
L_end:
    s_endpgm
.section .rodata,"a"
.p2align 6
.amdhsa_kernel gated_mix__sliding_block_cached__gqa_block_cached__decode_kernel
  .amdhsa_next_free_vgpr 256
  .amdhsa_next_free_sgpr 102
  .amdhsa_accum_offset 256
  .amdhsa_group_segment_fixed_size 0
  .amdhsa_kernarg_size 112
  .amdhsa_user_sgpr_count 2
  .amdhsa_user_sgpr_kernarg_segment_ptr 1
  .amdhsa_system_sgpr_workgroup_id_x 1
.end_amdhsa_kernel
```
